```python
import torch

def _softmax(x, axis=-1):
    return torch.softmax(x, dim=axis)
def _gelu(x):
    return torch.nn.functional.gelu(x, approximate="tanh")
def _silu(x):
    return torch.nn.functional.silu(x)
def _sigmoid(x):
    return torch.sigmoid(x)
def _layernorm(x, axis=-1, eps=1e-5):
    m = x.mean(dim=axis, keepdim=True)
    v = x.var(dim=axis, keepdim=True, unbiased=False)
    return (x - m) / torch.sqrt(v + eps)
def _scatter_add(tgt, idx, src, axis=0):
    return tgt.clone().index_add_(axis, idx, src)
def _segment_sum(src, seg, n):
    out = torch.zeros((n,) + src.shape[1:], dtype=src.dtype)
    return out.index_add_(0, seg, src)
def _pad(x, pw):
    flat = tuple(v for pair in reversed(pw) for v in pair)
    return torch.nn.functional.pad(x, flat)

kernel_name = 'parallel_sum__linear_kernel_hedgehog__mixer_channel_mlp__prompt'

def setup_inputs():

    _w = (lambda a: (lambda t: t.to(torch.bfloat16) if t.is_floating_point() else t)(torch.as_tensor(a)))
    def _A_setup():
        B, S, D, H = 1, 2048, 640, 32
        Dh = D // H
        return {
            "x": _w((lambda *s: torch.randn(*s, dtype=torch.bfloat16) * 0.05)(B, S, D)),
            "wqkv": _w((lambda *s: torch.randn(*s, dtype=torch.bfloat16) * 0.2)(D, 3 * D)),
            "w_phi": _w((lambda *s: torch.randn(*s, dtype=torch.bfloat16) * 0.2)(H, Dh, Dh) * (Dh ** -0.5)),
            "wo": _w((lambda *s: torch.randn(*s, dtype=torch.bfloat16) * 0.05)(D, D)),
        }
    _A_in = _A_setup()

    def _B_setup():
        B, S, D, F = 1, 2048, 640, 1728
        return {
            "x": _w((lambda *s: torch.randn(*s, dtype=torch.bfloat16) * 0.05)(B, S, D)),
            "w1": _w((lambda *s: torch.randn(*s, dtype=torch.bfloat16) * 3.2)(D, F) * (D ** -0.5)),
            "b1": _w((lambda *s: torch.randn(*s, dtype=torch.bfloat16) * 1.6)(F)),
            "w2": _w((lambda *s: torch.randn(*s, dtype=torch.bfloat16) * 0.05)(F, D) * (F ** -0.5)),
            "b2": _w((lambda *s: torch.randn(*s, dtype=torch.bfloat16) * 0.05)(D)),
        }
    _B_in = _B_setup()

    return {
        "A_x": _A_in["x"],
        "A_wqkv": _A_in["wqkv"],
        "A_w_phi": _A_in["w_phi"],
        "A_wo": _A_in["wo"],
        "B_x": _B_in["x"],
        "B_w1": _B_in["w1"],
        "B_b1": _B_in["b1"],
        "B_w2": _B_in["w2"],
        "B_b2": _B_in["b2"],
    }

def reference(A_x, A_wqkv, A_w_phi, A_wo, B_x, B_w1, B_b1, B_w2, B_b2):
    def _A_ref(x, wqkv, w_phi, wo):
        B, S, D = x.shape
        H = 32; Dh = D // H
        qkv = (lambda x, *d: x.permute(*d))((x @ wqkv).reshape(B, S, 3, H, Dh), 2, 0, 3, 1, 4)
        q, k, v = qkv[0], qkv[1], qkv[2]
        pq = torch.einsum("bhsd,hdf->bhsf", q, w_phi)
        pk = torch.einsum("bhsd,hdf->bhsf", k, w_phi)
        phi_q = torch.concatenate([_softmax(pq, axis=-1), _softmax(-pq, axis=-1)], axis=-1)
        phi_k = torch.concatenate([_softmax(pk, axis=-1), _softmax(-pk, axis=-1)], axis=-1)
        kv = torch.einsum("bhsf,bhsd->bhfd", phi_k, v)
        z  = torch.einsum("bhsf->bhf", phi_k)
        num = torch.einsum("bhqf,bhfd->bhqd", phi_q, kv)
        den = torch.einsum("bhqf,bhf->bhq", phi_q, z)[..., None] + 1e-6
        o = num / den
        return (lambda x, *d: x.permute(*d))(o, 0, 2, 1, 3).reshape(B, S, D) @ wo

    def _B_ref(x, w1, b1, w2, b2):
        y = _layernorm(x, axis=-1)
        h = _gelu(torch.einsum("bsd,df->bsf", y, w1) + b1)
        return torch.einsum("bsf,fd->bsd", h, w2) + b2

    x = A_x
    xn = _layernorm(x, axis=-1)
    return x + _A_ref(xn, A_wqkv, A_w_phi, A_wo) + _B_ref(xn, B_w1, B_b1, B_w2, B_b2)
```

```asm
; @launch grid=(256,1,1) block=(512,1,1) lds=163840
.amdgcn_target "amdgcn-amd-amdhsa--gfx950"
.text
.globl parallel_sum__linear_kernel_hedgehog__mixer_channel_mlp__prompt_kernel
.p2align 8
.type parallel_sum__linear_kernel_hedgehog__mixer_channel_mlp__prompt_kernel,@function
parallel_sum__linear_kernel_hedgehog__mixer_channel_mlp__prompt_kernel:
  s_cmp_ge_u32 s2, 256
  s_cbranch_scc1 L_parallel_sum__linear_kernel_hedgehog__mixer_channel_mlp__prompt_kernel_end
  s_load_dwordx4 s[4:7], s[0:1], 0
  s_load_dwordx2 s[14:15], s[0:1], 88
  s_load_dwordx2 s[10:11], s[0:1], 40
  s_getpc_b64 s[58:59]
L_parallel_sum__linear_kernel_hedgehog__mixer_channel_mlp__prompt_kernel_pc0:
  v_lshrrev_b32 v2, 6, v0
  v_and_b32 v1, 63, v0
  v_lshlrev_b32 v4, 10, v2
  v_lshl_add_u32 v4, v1, 7, v4
  v_cmp_gt_u32 vcc, 8, v1
  v_readfirstlane_b32 s3, v2
  s_and_saveexec_b64 s[56:57], vcc
  global_load_dword v127, v4, s[58:59]
  s_mov_b64 exec, s[56:57]
  s_load_dwordx2 s[8:9], s[0:1], 16
  s_load_dwordx2 s[12:13], s[0:1], 48
  s_load_dwordx2 s[76:77], s[0:1], 24
  s_load_dwordx2 s[78:79], s[0:1], 56
  s_load_dwordx2 s[80:81], s[0:1], 64
  s_load_dwordx2 s[82:83], s[0:1], 72
  s_load_dwordx2 s[84:85], s[0:1], 80
  s_lshr_b32 s40, s2, 3
  s_lshr_b32 s36, s40, 2
  s_and_b32 s41, s2, 1
  s_lshl_b32 s41, s41, 3
  s_add_u32 s36, s36, s41
  s_and_b32 s41, s40, 3
  s_lshr_b32 s37, s41, 1
  s_and_b32 s41, s41, 1
  s_and_b32 s38, s2, 7
  s_lshr_b32 s38, s38, 1
  s_lshl_b32 s38, s38, 1
  s_add_u32 s38, s38, s41
  s_and_b32 s39, s3, 3
  s_mov_b32 s75, 0
  s_waitcnt lgkmcnt(0)
  s_mov_b32 s16, s4
  s_and_b32 s17, s5, 0xffff
  s_mov_b32 s18, 2621440
  s_mov_b32 s19, 0x20000
  s_mov_b32 s24, s14
  s_and_b32 s25, s15, 0xffff
  s_mov_b32 s26, 21073920
  s_mov_b32 s27, 0x20000
  s_mov_b32 s64, s6
  s_and_b32 s65, s7, 0xffff
  s_mov_b32 s66, 2457600
  s_mov_b32 s67, 0x20000
  s_mov_b32 s88, s10
  s_and_b32 s89, s11, 0xffff
  s_mov_b32 s90, 2211840
  s_mov_b32 s91, 0x20000
  s_cmp_lt_u32 s3, 4
  s_cbranch_scc1 L_parallel_sum__linear_kernel_hedgehog__mixer_channel_mlp__prompt_kernel_compute
  v_lshrrev_b32 v4, 3, v1
  v_lshrrev_b32 v5, 1, v4
  v_and_b32 v6, 7, v1
  v_xor_b32 v7, v6, v5
  v_mul_u32_u24 v8, 1280, v4
  v_lshl_add_u32 v10, v7, 4, v8
  v_xor_b32 v7, 4, v7
  v_lshl_add_u32 v11, v7, 4, v8
  s_mul_i32 s101, s36, 163840
  s_mul_i32 s47, s39, 40960
  s_add_u32 s101, s101, s47
  s_lshl_b32 s47, s39, 12
  v_and_b32 v5, 1, v5
  v_lshlrev_b32 v5, 2, v5
  v_xor_b32 v6, v6, v5
  s_cmp_eq_u32 s37, 0
  s_cbranch_scc1 L_parallel_sum__linear_kernel_hedgehog__mixer_channel_mlp__prompt_kernel_ld_kv
  s_lshl_b32 s48, s38, 2
  s_add_u32 s48, s48, s39
  s_cmp_lt_u32 s48, 27
  s_cbranch_scc0 L_parallel_sum__linear_kernel_hedgehog__mixer_channel_mlp__prompt_kernel_uosa
  s_mov_b32 s49, 0
  s_add_u32 s48, s48, 30
  s_branch L_parallel_sum__linear_kernel_hedgehog__mixer_channel_mlp__prompt_kernel_uosb
L_parallel_sum__linear_kernel_hedgehog__mixer_channel_mlp__prompt_kernel_uosa:
  s_mov_b32 s49, 2
  s_cmp_eq_u32 s48, 28
  s_cmov_b32 s49, 1
  s_cmp_eq_u32 s48, 30
  s_cmov_b32 s49, 1
  s_lshr_b32 s48, s48, 1
  s_sub_u32 s48, s48, 6
L_parallel_sum__linear_kernel_hedgehog__mixer_channel_mlp__prompt_kernel_uosb:
  s_cmp_eq_u32 s49, 0
  s_cselect_b32 s20, s88, s64
  s_cselect_b32 s21, s89, s65
  s_mov_b32 s44, 3840
  s_cmov_b32 s44, 3456
  s_cselect_b32 s22, s90, s66
  s_cselect_b32 s58, 30, 0
  s_sub_u32 s58, s48, s58
  s_lshl_b32 s100, s58, 7
  s_cmp_eq_u32 s49, 2
  s_cmov_b32 s22, 0
  v_lshlrev_b32 v7, 4, v6
  s_lshl_b32 s58, s48, 6
  v_add_u32 v20, s58, v1
  s_branch L_parallel_sum__linear_kernel_hedgehog__mixer_channel_mlp__prompt_kernel_ld_go
L_parallel_sum__linear_kernel_hedgehog__mixer_channel_mlp__prompt_kernel_ld_kv:
  s_mov_b32 s20, s64
  s_mov_b32 s21, s65
  s_mov_b32 s22, s66
  s_mov_b32 s44, 3840
  s_mov_b32 s100, 0
  s_lshl_b32 s58, s39, 3
  v_add_u32 v7, s58, v6
  v_mov_b32 v8, 0x9c1b39b4
  v_mov_b32 v9, 0xd8e1e472
  v_cmp_gt_u32 vcc, 16, v7
  s_nop 1
  v_cndmask_b32 v8, v9, v8, vcc
  v_and_b32 v9, 15, v7
  v_lshlrev_b32 v9, 1, v9
  v_lshrrev_b32 v8, v9, v8
  v_and_b32 v8, 3, v8
  v_and_b32 v7, 0xfc, v7
  v_or_b32 v7, v7, v8
  s_mul_i32 s58, s38, 160
  s_add_u32 s59, s58, 1280
  v_mov_b32 v8, s59
  s_add_u32 s59, s58, 2400
  v_mov_b32 v9, s59
  v_cmp_gt_u32 vcc, 10, v7
  s_nop 1
  v_cndmask_b32 v8, v9, v8, vcc
  v_mov_b32 v9, 0x7fff0000
  v_cmp_gt_u32 vcc, 20, v7
  s_nop 1
  v_cndmask_b32 v8, v9, v8, vcc
  s_lshl_b32 s59, s38, 7
  s_sub_u32 s59, s59, 384
  v_mov_b32 v9, s59
  v_cmp_gt_u32 vcc, 24, v7
  s_nop 1
  v_cndmask_b32 v8, v9, v8, vcc
  v_lshl_add_u32 v7, v7, 4, v8
L_parallel_sum__linear_kernel_hedgehog__mixer_channel_mlp__prompt_kernel_ld_kvgc:
  v_and_b32 v12, 31, v1
  v_lshrrev_b32 v13, 5, v1
  s_and_b32 s58, s39, 1
  s_lshl_b32 s58, s58, 1
  v_add_u32 v13, s58, v13
  v_lshrrev_b32 v14, 3, v12
  v_lshl_add_u32 v14, v13, 2, v14
  v_lshrrev_b32 v15, 2, v12
  v_and_b32 v15, 1, v15
  s_lshr_b32 s59, s39, 1
  s_lshl_b32 s58, s59, 1
  v_add_u32 v16, s58, v15
  v_and_b32 v17, 3, v12
  v_mul_u32_u24 v18, 20, v16
  v_lshl_add_u32 v18, v14, 2, v18
  v_add_u32 v18, v18, v17
  s_mul_i32 s58, s38, 80
  v_add_u32 v18, s58, v18
  v_add_u32 v19, 640, v18
  v_add_u32 v21, 1260, v18
  v_cmp_gt_u32 vcc, 5, v14
  s_nop 1
  v_cndmask_b32 v20, v21, v19, vcc
  s_lshl_b32 s58, s59, 3
  v_lshl_add_u32 v21, v15, 2, s58
  v_add_u32 v21, v21, v14
  v_subrev_u32 v21, 10, v21
  v_lshl_add_u32 v21, v21, 2, v17
  s_lshl_b32 s58, s38, 6
  v_add_u32 v21, s58, v21
  v_cmp_gt_u32 vcc, 10, v14
  s_nop 1
  v_cndmask_b32 v20, v21, v20, vcc
  v_cmp_gt_u32 vcc, 14, v14
  s_nop 1
  v_cndmask_b32 v20, 0, v20, vcc
L_parallel_sum__linear_kernel_hedgehog__mixer_channel_mlp__prompt_kernel_ld_go:
  s_mov_b32 s23, 0x20000
  v_mul_lo_u32 v8, v4, s44
  v_add_u32 v12, v8, v7
  s_add_u32 s48, s47, 49152
  s_lshl_b32 s49, s44, 3
  s_add_u32 m0, s47, 0
  s_add_u32 s87, s101, 0
  buffer_load_dwordx4 v10, s[16:19], s87 offen lds
  s_add_u32 m0, s47, 1024
  s_add_u32 s87, s101, 10240
  buffer_load_dwordx4 v11, s[16:19], s87 offen lds
  s_add_u32 m0, s47, 2048
  s_add_u32 s87, s101, 20480
  buffer_load_dwordx4 v10, s[16:19], s87 offen lds
  s_add_u32 m0, s47, 3072
  s_add_u32 s87, s101, 30720
  buffer_load_dwordx4 v11, s[16:19], s87 offen lds
  s_add_u32 m0, s48, 0
  s_nop 0
  buffer_load_dwordx4 v12, s[20:23], s100 offen lds
  s_add_u32 s100, s100, s49
  s_add_u32 m0, s48, 1024
  s_nop 0
  buffer_load_dwordx4 v12, s[20:23], s100 offen lds
  s_add_u32 s100, s100, s49
  s_add_u32 m0, s48, 2048
  s_nop 0
  buffer_load_dwordx4 v12, s[20:23], s100 offen lds
  s_add_u32 s100, s100, s49
  s_add_u32 m0, s48, 3072
  s_nop 0
  buffer_load_dwordx4 v12, s[20:23], s100 offen lds
  s_add_u32 s100, s100, s49
  s_add_u32 m0, s48, 16384
  s_nop 0
  buffer_load_dwordx4 v12, s[20:23], s100 offen lds
  s_add_u32 s100, s100, s49
  s_add_u32 m0, s48, 17408
  s_nop 0
  buffer_load_dwordx4 v12, s[20:23], s100 offen lds
  s_add_u32 s100, s100, s49
  s_add_u32 m0, s48, 18432
  s_nop 0
  buffer_load_dwordx4 v12, s[20:23], s100 offen lds
  s_add_u32 s100, s100, s49
  s_add_u32 m0, s48, 19456
  s_nop 0
  buffer_load_dwordx4 v12, s[20:23], s100 offen lds
  s_add_u32 s100, s100, s49
  s_cmp_eq_u32 s39, 3
  s_cbranch_scc0 L_parallel_sum__linear_kernel_hedgehog__mixer_channel_mlp__prompt_kernel_nopf
  s_getpc_b64 s[58:59]
L_parallel_sum__linear_kernel_hedgehog__mixer_channel_mlp__prompt_kernel_pc:
  s_sub_u32 s58, s58, L_parallel_sum__linear_kernel_hedgehog__mixer_channel_mlp__prompt_kernel_pc-parallel_sum__linear_kernel_hedgehog__mixer_channel_mlp__prompt_kernel
  s_subb_u32 s59, s59, 0
  s_lshr_b32 s41, s2, 3
  s_and_b32 s41, s41, 7
  s_lshl_b32 s41, s41, 13
  v_lshl_add_u32 v50, v1, 7, s41
  v_min_u32 v50, L_parallel_sum__linear_kernel_hedgehog__mixer_channel_mlp__prompt_kernel_codeend-parallel_sum__linear_kernel_hedgehog__mixer_channel_mlp__prompt_kernel-4, v50
  global_load_dword v51, v50, s[58:59]
L_parallel_sum__linear_kernel_hedgehog__mixer_channel_mlp__prompt_kernel_nopf:
  s_lshl_b32 s58, s38, 2
  s_add_u32 s58, s58, s39
  s_mul_i32 s58, s58, 800
  s_add_u32 s32, s8, s58
  s_addc_u32 s33, s9, 0
  s_and_b32 s33, s33, 0xffff
  s_mov_b32 s34, 800
  s_mov_b32 s35, 0x20000
  s_cmp_eq_u32 s37, 0
  s_cselect_b32 s34, s34, 0
  v_lshlrev_b32 v40, 4, v1
  s_lshl_b32 s58, s39, 10
  s_add_u32 m0, s58, 153600
  s_nop 0
  buffer_load_dwordx4 v40, s[32:35], 0 offen lds
  s_waitcnt vmcnt(5)
  s_barrier
  s_add_u32 m0, s47, 16384
  s_add_u32 s87, s101, 128
  buffer_load_dwordx4 v10, s[16:19], s87 offen lds
  s_add_u32 m0, s47, 17408
  s_add_u32 s87, s101, 10368
  buffer_load_dwordx4 v11, s[16:19], s87 offen lds
  s_add_u32 m0, s47, 18432
  s_add_u32 s87, s101, 20608
  buffer_load_dwordx4 v10, s[16:19], s87 offen lds
  s_add_u32 m0, s47, 19456
  s_add_u32 s87, s101, 30848
  buffer_load_dwordx4 v11, s[16:19], s87 offen lds
  s_add_u32 m0, s48, 32768
  s_nop 0
  buffer_load_dwordx4 v12, s[20:23], s100 offen lds
  s_add_u32 s100, s100, s49
  s_add_u32 m0, s48, 33792
  s_nop 0
  buffer_load_dwordx4 v12, s[20:23], s100 offen lds
  s_add_u32 s100, s100, s49
  s_add_u32 m0, s48, 34816
  s_nop 0
  buffer_load_dwordx4 v12, s[20:23], s100 offen lds
  s_add_u32 s100, s100, s49
  s_add_u32 m0, s48, 35840
  s_nop 0
  buffer_load_dwordx4 v12, s[20:23], s100 offen lds
  s_add_u32 s100, s100, s49
  s_add_u32 m0, s48, 49152
  s_nop 0
  buffer_load_dwordx4 v12, s[20:23], s100 offen lds
  s_add_u32 s100, s100, s49
  s_add_u32 m0, s48, 50176
  s_nop 0
  buffer_load_dwordx4 v12, s[20:23], s100 offen lds
  s_add_u32 s100, s100, s49
  s_add_u32 m0, s48, 51200
  s_nop 0
  buffer_load_dwordx4 v12, s[20:23], s100 offen lds
  s_add_u32 s100, s100, s49
  s_add_u32 m0, s48, 52224
  s_nop 0
  buffer_load_dwordx4 v12, s[20:23], s100 offen lds
  s_add_u32 s100, s100, s49
  s_add_u32 m0, s47, 32768
  s_add_u32 s87, s101, 256
  buffer_load_dwordx4 v10, s[16:19], s87 offen lds
  s_add_u32 m0, s47, 33792
  s_add_u32 s87, s101, 10496
  buffer_load_dwordx4 v11, s[16:19], s87 offen lds
  s_add_u32 m0, s47, 34816
  s_add_u32 s87, s101, 20736
  buffer_load_dwordx4 v10, s[16:19], s87 offen lds
  s_add_u32 m0, s47, 35840
  s_add_u32 s87, s101, 30976
  buffer_load_dwordx4 v11, s[16:19], s87 offen lds
  s_mov_b32 s28, s12
  s_and_b32 s29, s13, 0xffff
  s_mov_b32 s30, 3456
  s_mov_b32 s31, 0x20000
  s_branch L_parallel_sum__linear_kernel_hedgehog__mixer_channel_mlp__prompt_kernel_loader
L_parallel_sum__linear_kernel_hedgehog__mixer_channel_mlp__prompt_kernel_compute:
  s_mov_b32 s60, s82
  s_and_b32 s61, s83, 0xffff
  s_mov_b32 s62, 2621440
  s_mov_b32 s63, 0x20000
  s_or_b32 s41, s2, s3
  s_cmp_eq_u32 s41, 0
  s_cbranch_scc0 L_parallel_sum__linear_kernel_hedgehog__mixer_channel_mlp__prompt_kernel_nog0
  v_lshlrev_b32 v4, 7, v1
  v_add_u32 v4, 20971520, v4
  v_mov_b32 v6, 0x7fff0000
  v_cmp_gt_u32 vcc, 16, v1
  s_nop 1
  v_cndmask_b32 v4, v6, v4, vcc
  v_mov_b32 v8, 0
  v_mov_b32 v9, 0
  v_mov_b32 v10, 0
  v_mov_b32 v11, 0
  buffer_store_dwordx4 v[8:11], v4, s[24:27], 0 offen sc1
  s_waitcnt vmcnt(0)
  v_mov_b32 v4, 0
  v_mov_b32 v5, 1
  s_mov_b64 exec, 1
  global_store_dword v4, v5, s[84:85] sc1
  s_mov_b64 exec, -1
L_parallel_sum__linear_kernel_hedgehog__mixer_channel_mlp__prompt_kernel_nog0:
  s_mov_b32 s92, s78
  s_and_b32 s93, s79, 0xffff
  s_mov_b32 s94, 2211840
  s_mov_b32 s95, 0x20000
  s_mov_b32 s96, s76
  s_and_b32 s97, s77, 0xffff
  s_mov_b32 s98, 819200
  s_mov_b32 s99, 0x20000
  s_lshl_b32 s40, s2, 2
  s_add_u32 s40, s40, s39
  s_lshl_b32 s41, s36, 3
  s_add_u32 s41, s41, s38
  s_lshl_b32 s41, s41, 2
  s_add_u32 s41, s41, s39
  s_add_u32 s42, s41, 512
  s_cmp_eq_u32 s37, 1
  s_cselect_b32 s50, s41, s42
  s_cselect_b32 s51, s41, -1
  s_cselect_b32 s49, s42, -1
  s_cmp_lt_u32 s50, 570
  s_cselect_b32 s50, s50, -1
  s_cmp_lt_u32 s49, 740
  s_cselect_b32 s49, s49, -1
  s_lshl_b32 s52, s39, 13
  s_add_u32 s52, s52, 114688
  s_lshl_b32 s87, s39, 12
  s_add_u32 s87, s87, 81920
  s_add_u32 s48, s87, 16384
  v_lshrrev_b32 v36, 5, v1
  v_and_b32 v37, 31, v1
  s_lshl_b32 s41, s40, 1
  v_add_u32 v38, s41, v36
  v_mul_u32_u24 v39, 1280, v38
  v_lshl_add_u32 v39, v37, 3, v39
  buffer_load_dwordx2 v[40:41], v39, s[16:19], 0 offen offset:0
  buffer_load_dwordx2 v[42:43], v39, s[16:19], 0 offen offset:256
  buffer_load_dwordx2 v[44:45], v39, s[16:19], 0 offen offset:512
  buffer_load_dwordx2 v[46:47], v39, s[16:19], 0 offen offset:768
  buffer_load_dwordx2 v[48:49], v39, s[16:19], 0 offen offset:1024
  s_cmp_eq_u32 s50, -1
  s_cselect_b32 s53, 0, s50
  s_mul_i32 s41, s53, 6554
  s_lshr_b32 s41, s41, 16
  s_mul_i32 s42, s41, 10
  s_sub_u32 s42, s53, s42
  s_mov_b32 s54, s41
  s_mov_b32 s55, s42
  s_cmp_lt_u32 s41, 30
  s_cselect_b32 s32, s64, s88
  s_cselect_b32 s33, s65, s89
  s_cselect_b32 s34, s66, s90
  s_mov_b32 s35, 0x20000
  s_mov_b32 s43, 3456
  s_cmov_b32 s43, 3840
  s_cselect_b32 s44, 0, 30
  s_sub_u32 s44, s41, s44
  s_lshl_b32 s44, s44, 7
  s_mul_i32 s45, s42, s43
  s_lshl_b32 s45, s45, 6
  s_add_u32 s45, s45, s44
  s_lshl_b32 s46, s43, 3
  s_cmp_eq_u32 s50, -1
  s_cselect_b32 s34, 0, s34
  v_lshrrev_b32 v100, 3, v1
  v_lshrrev_b32 v101, 1, v100
  v_and_b32 v101, 1, v101
  v_lshlrev_b32 v101, 2, v101
  v_and_b32 v102, 7, v1
  v_xor_b32 v102, v102, v101
  v_mul_lo_u32 v103, v100, s43
  v_lshl_add_u32 v103, v102, 4, v103
  s_add_u32 m0, s52, 0
  s_nop 0
  buffer_load_dwordx4 v103, s[32:35], s45 offen lds
  s_add_u32 s45, s45, s46
  s_add_u32 m0, s52, 1024
  s_nop 0
  buffer_load_dwordx4 v103, s[32:35], s45 offen lds
  s_add_u32 s45, s45, s46
  s_add_u32 m0, s52, 2048
  s_nop 0
  buffer_load_dwordx4 v103, s[32:35], s45 offen lds
  s_add_u32 s45, s45, s46
  s_add_u32 m0, s52, 3072
  s_nop 0
  buffer_load_dwordx4 v103, s[32:35], s45 offen lds
  s_add_u32 s45, s45, s46
  s_add_u32 m0, s52, 4096
  s_nop 0
  buffer_load_dwordx4 v103, s[32:35], s45 offen lds
  s_add_u32 s45, s45, s46
  s_add_u32 m0, s52, 5120
  s_nop 0
  buffer_load_dwordx4 v103, s[32:35], s45 offen lds
  s_add_u32 s45, s45, s46
  s_add_u32 m0, s52, 6144
  s_nop 0
  buffer_load_dwordx4 v103, s[32:35], s45 offen lds
  s_add_u32 s45, s45, s46
  s_add_u32 m0, s52, 7168
  s_nop 0
  buffer_load_dwordx4 v103, s[32:35], s45 offen lds
  s_cmp_eq_u32 s37, 0
  s_cbranch_scc1 L_parallel_sum__linear_kernel_hedgehog__mixer_channel_mlp__prompt_kernel_nosw
  s_cmp_eq_u32 s51, -1
  s_cselect_b32 s53, 0, s51
  s_mul_i32 s41, s53, 6554
  s_lshr_b32 s41, s41, 16
  s_mul_i32 s42, s41, 10
  s_sub_u32 s42, s53, s42
  s_mov_b32 s56, s41
  s_mov_b32 s57, s42
  s_cmp_lt_u32 s41, 54
  s_cselect_b32 s32, s92, s96
  s_cselect_b32 s33, s93, s97
  s_cselect_b32 s34, s94, s98
  s_mov_b32 s35, 0x20000
  s_cmp_eq_u32 s51, -1
  s_cselect_b32 s34, 0, s34
  v_lshrrev_b32 v108, 3, v1
  v_and_b32 v109, 7, v1
  s_lshl_b32 s43, s42, 7
  v_lshl_add_u32 v109, v109, 4, s43
  s_cmp_lt_u32 s41, 54
  s_cbranch_scc0 L_parallel_sum__linear_kernel_hedgehog__mixer_channel_mlp__prompt_kernel_sw_wo0
  s_cmp_lt_u32 s41, 28
  s_cselect_b32 s44, 0, 28
  s_cselect_b32 s45, 0, 2
  s_sub_u32 s44, s41, s44
  s_lshr_b32 s46, s44, 1
  s_lshl_b32 s46, s46, 2
  s_and_b32 s44, s44, 1
  s_add_u32 s46, s46, s44
  s_add_u32 s46, s46, s45
  v_lshrrev_b32 v110, 2, v108
  v_lshlrev_b32 v110, 3, v110
  v_and_b32 v111, 3, v108
  v_add_u32 v110, v110, v111
  s_lshl_b32 s46, s46, 5
  v_add_u32 v110, s46, v110
  v_add_u32 v112, 0, v110
  v_add_u32 v113, 16, v110
  v_add_u32 v114, 4, v110
  v_add_u32 v115, 20, v110
  s_branch L_parallel_sum__linear_kernel_hedgehog__mixer_channel_mlp__prompt_kernel_sw_go0
L_parallel_sum__linear_kernel_hedgehog__mixer_channel_mlp__prompt_kernel_sw_wo0:
  s_sub_u32 s44, s41, 54
  s_mul_i32 s45, s44, 52
  s_lshr_b32 s45, s45, 8
  s_mul_i32 s46, s45, 5
  s_sub_u32 s46, s44, s46
  s_lshl_b32 s46, s46, 3
  v_add_u32 v110, s46, v108
  v_cmp_le_u32 vcc, 20, v110
  s_nop 1
  v_cndmask_b32 v111, 0, 1, vcc
  v_mul_u32_u24 v116, 20, v111
  v_sub_u32 v110, v110, v116
  s_lshl_b32 s45, s45, 1
  v_add_u32 v111, s45, v111
  v_mul_u32_u24 v111, 80, v111
  v_add_u32 v110, v110, v111
  v_add_u32 v112, 0, v110
  v_add_u32 v113, 20, v110
  v_add_u32 v114, 40, v110
  v_add_u32 v115, 60, v110
L_parallel_sum__linear_kernel_hedgehog__mixer_channel_mlp__prompt_kernel_sw_go0:
  v_mul_u32_u24 v112, 1280, v112
  v_add_u32 v112, v112, v109
  v_mul_u32_u24 v113, 1280, v113
  v_add_u32 v113, v113, v109
  v_mul_u32_u24 v114, 1280, v114
  v_add_u32 v114, v114, v109
  v_mul_u32_u24 v115, 1280, v115
  v_add_u32 v115, v115, v109
  s_add_u32 m0, s87, 0
  s_nop 0
  buffer_load_dwordx4 v112, s[32:35], 0 offen lds
  s_add_u32 m0, s87, 1024
  s_nop 0
  buffer_load_dwordx4 v113, s[32:35], 0 offen lds
  s_add_u32 m0, s87, 2048
  s_nop 0
  buffer_load_dwordx4 v114, s[32:35], 0 offen lds
  s_add_u32 m0, s87, 3072
  s_nop 0
  buffer_load_dwordx4 v115, s[32:35], 0 offen lds
  s_cmp_eq_u32 s49, -1
  s_cselect_b32 s53, 0, s49
  s_mul_i32 s41, s53, 6554
  s_lshr_b32 s41, s41, 16
  s_mul_i32 s42, s41, 10
  s_sub_u32 s42, s53, s42
  s_mov_b32 s100, s41
  s_mov_b32 s101, s42
  s_cmp_lt_u32 s41, 54
  s_cselect_b32 s32, s92, s96
  s_cselect_b32 s33, s93, s97
  s_cselect_b32 s34, s94, s98
  s_mov_b32 s35, 0x20000
  s_cmp_eq_u32 s49, -1
  s_cselect_b32 s34, 0, s34
  v_lshrrev_b32 v118, 3, v1
  v_and_b32 v119, 7, v1
  s_lshl_b32 s43, s42, 7
  v_lshl_add_u32 v119, v119, 4, s43
  s_cmp_lt_u32 s41, 54
  s_cbranch_scc0 L_parallel_sum__linear_kernel_hedgehog__mixer_channel_mlp__prompt_kernel_sw_wo1
  s_cmp_lt_u32 s41, 28
  s_cselect_b32 s44, 0, 28
  s_cselect_b32 s45, 0, 2
  s_sub_u32 s44, s41, s44
  s_lshr_b32 s46, s44, 1
  s_lshl_b32 s46, s46, 2
  s_and_b32 s44, s44, 1
  s_add_u32 s46, s46, s44
  s_add_u32 s46, s46, s45
  v_lshrrev_b32 v120, 2, v118
  v_lshlrev_b32 v120, 3, v120
  v_and_b32 v121, 3, v118
  v_add_u32 v120, v120, v121
  s_lshl_b32 s46, s46, 5
  v_add_u32 v120, s46, v120
  v_add_u32 v122, 0, v120
  v_add_u32 v123, 16, v120
  v_add_u32 v124, 4, v120
  v_add_u32 v125, 20, v120
  s_branch L_parallel_sum__linear_kernel_hedgehog__mixer_channel_mlp__prompt_kernel_sw_go1
L_parallel_sum__linear_kernel_hedgehog__mixer_channel_mlp__prompt_kernel_sw_wo1:
  s_sub_u32 s44, s41, 54
  s_mul_i32 s45, s44, 52
  s_lshr_b32 s45, s45, 8
  s_mul_i32 s46, s45, 5
  s_sub_u32 s46, s44, s46
  s_lshl_b32 s46, s46, 3
  v_add_u32 v120, s46, v118
  v_cmp_le_u32 vcc, 20, v120
  s_nop 1
  v_cndmask_b32 v121, 0, 1, vcc
  v_mul_u32_u24 v126, 20, v121
  v_sub_u32 v120, v120, v126
  s_lshl_b32 s45, s45, 1
  v_add_u32 v121, s45, v121
  v_mul_u32_u24 v121, 80, v121
  v_add_u32 v120, v120, v121
  v_add_u32 v122, 0, v120
  v_add_u32 v123, 20, v120
  v_add_u32 v124, 40, v120
  v_add_u32 v125, 60, v120
L_parallel_sum__linear_kernel_hedgehog__mixer_channel_mlp__prompt_kernel_sw_go1:
  v_mul_u32_u24 v122, 1280, v122
  v_add_u32 v122, v122, v119
  v_mul_u32_u24 v123, 1280, v123
  v_add_u32 v123, v123, v119
  v_mul_u32_u24 v124, 1280, v124
  v_add_u32 v124, v124, v119
  v_mul_u32_u24 v125, 1280, v125
  v_add_u32 v125, v125, v119
  s_add_u32 m0, s48, 0
  s_nop 0
  buffer_load_dwordx4 v122, s[32:35], 0 offen lds
  s_add_u32 m0, s48, 1024
  s_nop 0
  buffer_load_dwordx4 v123, s[32:35], 0 offen lds
  s_add_u32 m0, s48, 2048
  s_nop 0
  buffer_load_dwordx4 v124, s[32:35], 0 offen lds
  s_add_u32 m0, s48, 3072
  s_nop 0
  buffer_load_dwordx4 v125, s[32:35], 0 offen lds
L_parallel_sum__linear_kernel_hedgehog__mixer_channel_mlp__prompt_kernel_nosw:
  s_lshr_b32 s43, s39, 1
  s_and_b32 s44, s39, 1
  v_and_b32 v16, 31, v1
  v_lshrrev_b32 v17, 5, v1
  v_lshrrev_b32 v18, 1, v16
  v_and_b32 v18, 7, v18
  v_xor_b32 v18, v17, v18
  v_lshlrev_b32 v18, 4, v18
  v_lshl_add_u32 v18, v16, 7, v18
  s_lshl_b32 s45, s43, 13
  v_add_u32 v8, s45, v18
  v_xor_b32 v9, 32, v8
  v_xor_b32 v10, 64, v8
  v_xor_b32 v11, 96, v8
  v_mov_b32 v4, v8
  v_mov_b32 v5, v9
  v_mov_b32 v6, v10
  v_mov_b32 v7, v11
  s_mov_b32 s47, 16384
  v_lshrrev_b32 v18, 4, v1
  v_lshrrev_b32 v19, 2, v1
  v_and_b32 v19, 3, v19
  v_and_b32 v20, 3, v1
  v_lshrrev_b32 v21, 1, v18
  v_lshl_add_u32 v21, v21, 3, v19
  v_lshlrev_b32 v21, 7, v21
  v_add_u32 v21, 49152, v21
  v_lshrrev_b32 v22, 1, v19
  v_lshlrev_b32 v22, 2, v22
  v_and_b32 v23, 1, v18
  v_lshlrev_b32 v23, 1, v23
  v_lshrrev_b32 v24, 1, v20
  v_add_u32 v23, v23, v24
  v_and_b32 v24, 1, v20
  s_cmp_eq_u32 s37, 0
  s_cbranch_scc1 L_parallel_sum__linear_kernel_hedgehog__mixer_channel_mlp__prompt_kernel_c_kv
  v_add_u32 v25, 0, v23
  v_xor_b32 v25, v25, v22
  v_lshl_add_u32 v25, v25, 4, v21
  v_lshl_add_u32 v25, v24, 3, v25
  s_lshl_b32 s45, s44, 13
  s_add_u32 s45, s45, 0
  v_add_u32 v12, s45, v25
  v_add_u32 v25, 4, v23
  v_xor_b32 v25, v25, v22
  v_lshl_add_u32 v25, v25, 4, v21
  v_lshl_add_u32 v25, v24, 3, v25
  s_lshl_b32 s45, s44, 13
  s_add_u32 s45, s45, 0
  v_add_u32 v13, s45, v25
  v_add_u32 v25, 0, v23
  v_xor_b32 v25, v25, v22
  v_lshl_add_u32 v25, v25, 4, v21
  v_lshl_add_u32 v25, v24, 3, v25
  s_lshl_b32 s45, s44, 13
  s_add_u32 s45, s45, 4096
  v_add_u32 v14, s45, v25
  v_add_u32 v25, 4, v23
  v_xor_b32 v25, v25, v22
  v_lshl_add_u32 v25, v25, 4, v21
  v_lshl_add_u32 v25, v24, 3, v25
  s_lshl_b32 s45, s44, 13
  s_add_u32 s45, s45, 4096
  v_add_u32 v15, s45, v25
  s_branch L_parallel_sum__linear_kernel_hedgehog__mixer_channel_mlp__prompt_kernel_c_go
L_parallel_sum__linear_kernel_hedgehog__mixer_channel_mlp__prompt_kernel_c_kv:
  s_lshl_b32 s45, s44, 1
  v_add_u32 v26, s45, v24
  v_mul_u32_u24 v26, 5, v26
  v_add_u32 v27, 0, v23
  v_add_u32 v28, v26, v27
  v_add_u32 v29, 15, v28
  v_cmp_gt_u32 vcc, 5, v27
  s_nop 1
  v_cndmask_b32 v28, v29, v28, vcc
  s_lshl_b32 s45, s44, 3
  v_lshl_add_u32 v29, v24, 2, s45
  v_add_u32 v29, v29, v27
  v_add_u32 v29, 38, v29
  v_cmp_gt_u32 vcc, 10, v27
  s_nop 1
  v_cndmask_b32 v28, v29, v28, vcc
  v_cmp_gt_u32 vcc, 14, v27
  v_add_u32 v29, 42, v24
  s_nop 0
  v_cndmask_b32 v28, v29, v28, vcc
  v_lshrrev_b32 v30, 1, v28
  v_mov_b32 v29, 0x781b93b4
  v_mov_b32 v31, 0xd8e1e48d
  v_cmp_gt_u32 vcc, 16, v30
  s_nop 1
  v_cndmask_b32 v29, v31, v29, vcc
  v_and_b32 v31, 15, v30
  v_lshlrev_b32 v31, 1, v31
  v_lshrrev_b32 v29, v31, v29
  v_and_b32 v29, 3, v29
  v_and_b32 v30, 0xfc, v30
  v_or_b32 v30, v30, v29
  v_lshrrev_b32 v29, 3, v30
  v_and_b32 v30, 7, v30
  v_xor_b32 v30, v30, v22
  v_and_b32 v31, 1, v28
  v_lshl_add_u32 v30, v30, 4, v21
  v_lshl_add_u32 v30, v31, 3, v30
  v_lshl_add_u32 v12, v29, 12, v30
  v_add_u32 v27, 4, v23
  v_add_u32 v28, v26, v27
  v_add_u32 v29, 15, v28
  v_cmp_gt_u32 vcc, 5, v27
  s_nop 1
  v_cndmask_b32 v28, v29, v28, vcc
  s_lshl_b32 s45, s44, 3
  v_lshl_add_u32 v29, v24, 2, s45
  v_add_u32 v29, v29, v27
  v_add_u32 v29, 38, v29
  v_cmp_gt_u32 vcc, 10, v27
  s_nop 1
  v_cndmask_b32 v28, v29, v28, vcc
  v_cmp_gt_u32 vcc, 14, v27
  v_add_u32 v29, 42, v24
  s_nop 0
  v_cndmask_b32 v28, v29, v28, vcc
  v_lshrrev_b32 v30, 1, v28
  v_mov_b32 v29, 0x781b93b4
  v_mov_b32 v31, 0xd8e1e48d
  v_cmp_gt_u32 vcc, 16, v30
  s_nop 1
  v_cndmask_b32 v29, v31, v29, vcc
  v_and_b32 v31, 15, v30
  v_lshlrev_b32 v31, 1, v31
  v_lshrrev_b32 v29, v31, v29
  v_and_b32 v29, 3, v29
  v_and_b32 v30, 0xfc, v30
  v_or_b32 v30, v30, v29
  v_lshrrev_b32 v29, 3, v30
  v_and_b32 v30, 7, v30
  v_xor_b32 v30, v30, v22
  v_and_b32 v31, 1, v28
  v_lshl_add_u32 v30, v30, 4, v21
  v_lshl_add_u32 v30, v31, 3, v30
  v_lshl_add_u32 v13, v29, 12, v30
  v_add_u32 v27, 8, v23
  v_add_u32 v28, v26, v27
  v_add_u32 v29, 15, v28
  v_cmp_gt_u32 vcc, 5, v27
  s_nop 1
  v_cndmask_b32 v28, v29, v28, vcc
  s_lshl_b32 s45, s44, 3
  v_lshl_add_u32 v29, v24, 2, s45
  v_add_u32 v29, v29, v27
  v_add_u32 v29, 38, v29
  v_cmp_gt_u32 vcc, 10, v27
  s_nop 1
  v_cndmask_b32 v28, v29, v28, vcc
  v_cmp_gt_u32 vcc, 14, v27
  v_add_u32 v29, 42, v24
  s_nop 0
  v_cndmask_b32 v28, v29, v28, vcc
  v_lshrrev_b32 v30, 1, v28
  v_mov_b32 v29, 0x781b93b4
  v_mov_b32 v31, 0xd8e1e48d
  v_cmp_gt_u32 vcc, 16, v30
  s_nop 1
  v_cndmask_b32 v29, v31, v29, vcc
  v_and_b32 v31, 15, v30
  v_lshlrev_b32 v31, 1, v31
  v_lshrrev_b32 v29, v31, v29
  v_and_b32 v29, 3, v29
  v_and_b32 v30, 0xfc, v30
  v_or_b32 v30, v30, v29
  v_lshrrev_b32 v29, 3, v30
  v_and_b32 v30, 7, v30
  v_xor_b32 v30, v30, v22
  v_and_b32 v31, 1, v28
  v_lshl_add_u32 v30, v30, 4, v21
  v_lshl_add_u32 v30, v31, 3, v30
  v_lshl_add_u32 v14, v29, 12, v30
  v_add_u32 v27, 12, v23
  v_add_u32 v28, v26, v27
  v_add_u32 v29, 15, v28
  v_cmp_gt_u32 vcc, 5, v27
  s_nop 1
  v_cndmask_b32 v28, v29, v28, vcc
  s_lshl_b32 s45, s44, 3
  v_lshl_add_u32 v29, v24, 2, s45
  v_add_u32 v29, v29, v27
  v_add_u32 v29, 38, v29
  v_cmp_gt_u32 vcc, 10, v27
  s_nop 1
  v_cndmask_b32 v28, v29, v28, vcc
  v_cmp_gt_u32 vcc, 14, v27
  v_add_u32 v29, 42, v24
  s_nop 0
  v_cndmask_b32 v28, v29, v28, vcc
  v_lshrrev_b32 v30, 1, v28
  v_mov_b32 v29, 0x781b93b4
  v_mov_b32 v31, 0xd8e1e48d
  v_cmp_gt_u32 vcc, 16, v30
  s_nop 1
  v_cndmask_b32 v29, v31, v29, vcc
  v_and_b32 v31, 15, v30
  v_lshlrev_b32 v31, 1, v31
  v_lshrrev_b32 v29, v31, v29
  v_and_b32 v29, 3, v29
  v_and_b32 v30, 0xfc, v30
  v_or_b32 v30, v30, v29
  v_lshrrev_b32 v29, 3, v30
  v_and_b32 v30, 7, v30
  v_xor_b32 v30, v30, v22
  v_and_b32 v31, 1, v28
  v_lshl_add_u32 v30, v30, 4, v21
  v_lshl_add_u32 v30, v31, 3, v30
  v_lshl_add_u32 v15, v29, 12, v30
L_parallel_sum__linear_kernel_hedgehog__mixer_channel_mlp__prompt_kernel_c_go:
  s_lshl_b32 s45, s43, 10
  s_add_u32 s45, s45, 151552
  v_lshl_add_u32 v32, v16, 4, s45
  s_lshl_b32 s45, s44, 11
  s_add_u32 s45, s45, 147456
  v_lshl_add_u32 v33, v16, 4, s45
  v_mov_b32 v34, 157696
  v_cmp_eq_u32 vcc, 0, v17
  s_nop 1
  v_cndmask_b32 v33, v34, v33, vcc
  v_lshrrev_b32 v25, 1, v18
  s_lshl_b32 s45, s44, 1
  v_add_u32 v26, s45, v24
  v_lshlrev_b32 v26, 10, v26
  v_add_u32 v26, 153600, v26
  v_mul_u32_u24 v27, 40, v19
  v_add_u32 v27, v27, v26
  v_lshl_add_u32 v27, v23, 3, v27
  v_mov_b32 v28, 157696
  v_cmp_eq_u32 vcc, v24, v25
  s_nop 1
  v_cndmask_b32 v35, v28, v27, vcc
  v_add_u32 v30, 32, v27
  v_cmp_eq_u32 s[58:59], 0, v23
  s_nop 0
  s_and_b64 vcc, vcc, s[58:59]
  v_cndmask_b32 v31, v28, v30, vcc
  s_cmp_eq_u32 s37, 0
  s_cbranch_scc1 L_parallel_sum__linear_kernel_hedgehog__mixer_channel_mlp__prompt_kernel_jobs_kv
  s_waitcnt vmcnt(8)
  v_lshlrev_b32 v52, 16, v40
  v_lshrrev_b32 v176, 4, v1
  v_and_b32 v53, 0xffff0000, v40
  v_lshlrev_b32 v54, 16, v41
  v_lshrrev_b32 v177, 2, v1
  v_and_b32 v55, 0xffff0000, v41
  v_lshlrev_b32 v56, 16, v42
  v_and_b32 v177, 3, v177
  v_and_b32 v57, 0xffff0000, v42
  v_lshlrev_b32 v58, 16, v43
  v_and_b32 v178, 3, v1
  v_and_b32 v59, 0xffff0000, v43
  v_lshlrev_b32 v60, 16, v44
  v_lshrrev_b32 v180, 1, v176
  v_and_b32 v61, 0xffff0000, v44
  v_lshlrev_b32 v62, 16, v45
  v_lshl_add_u32 v180, v180, 3, v177
  v_and_b32 v63, 0xffff0000, v45
  v_lshlrev_b32 v64, 16, v46
  v_lshlrev_b32 v180, 7, v180
  v_and_b32 v65, 0xffff0000, v46
  v_lshlrev_b32 v66, 16, v47
  v_and_b32 v181, 1, v176
  v_and_b32 v67, 0xffff0000, v47
  v_lshlrev_b32 v68, 16, v48
  v_lshlrev_b32 v181, 1, v181
  v_and_b32 v69, 0xffff0000, v48
  v_lshlrev_b32 v70, 16, v49
  v_lshrrev_b32 v182, 1, v178
  v_and_b32 v71, 0xffff0000, v49
  v_add_f32 v72, v52, v53
  v_add_u32 v181, v181, v182
  v_add_f32 v73, v54, v55
  v_add_f32 v72, v72, v56
  v_lshrrev_b32 v182, 1, v177
  v_add_f32 v73, v73, v57
  v_add_f32 v72, v72, v58
  v_lshlrev_b32 v182, 2, v182
  v_add_f32 v73, v73, v59
  v_add_f32 v72, v72, v60
  v_and_b32 v183, 1, v178
  v_add_f32 v73, v73, v61
  v_add_f32 v72, v72, v62
  v_lshl_add_u32 v180, v183, 3, v180
  v_add_f32 v73, v73, v63
  v_add_f32 v72, v72, v64
  v_add_u32 v180, s52, v180
  v_add_f32 v73, v73, v65
  v_add_f32 v72, v72, v66
  v_xor_b32 v183, v181, v182
  v_add_f32 v73, v73, v67
  v_add_f32 v72, v72, v68
  v_lshl_add_u32 v184, v183, 4, v180
  v_add_f32 v73, v73, v69
  v_add_f32 v72, v72, v70
  v_xor_b32 v183, 4, v183
  v_add_f32 v73, v73, v71
  v_add_f32 v72, v72, v73
  v_lshl_add_u32 v185, v183, 4, v180
  s_nop 0
  v_add_f32_dpp v72, v72, v72 row_ror:8 row_mask:0xf bank_mask:0xf
  s_nop 1
  v_add_f32_dpp v72, v72, v72 row_ror:4 row_mask:0xf bank_mask:0xf
  v_mov_b32 v188, 0x3f803f80
  s_nop 0
  v_add_f32_dpp v72, v72, v72 row_ror:2 row_mask:0xf bank_mask:0xf
  s_nop 1
  v_add_f32_dpp v72, v72, v72 row_ror:1 row_mask:0xf bank_mask:0xf
  v_mov_b32 v189, 0x3f803f80
  ds_swizzle_b32 v73, v72 offset:0x401F
  s_waitcnt lgkmcnt(0)
  v_mov_b32 v190, 0x3f803f80
  v_add_f32 v72, v72, v73
  v_mul_f32 v74, 0.0015625, v72
  v_mov_b32 v191, 0x3f803f80
  v_sub_f32 v52, v52, v74
  v_sub_f32 v53, v53, v74
  v_sub_f32 v54, v54, v74
  v_sub_f32 v55, v55, v74
  ds_read_b64_tr_b16 v[192:193], v184 offset:0
  v_sub_f32 v56, v56, v74
  v_sub_f32 v57, v57, v74
  ds_read_b64_tr_b16 v[194:195], v184 offset:512
  v_sub_f32 v58, v58, v74
  v_sub_f32 v59, v59, v74
  ds_read_b64_tr_b16 v[196:197], v185 offset:0
  v_sub_f32 v60, v60, v74
  v_sub_f32 v61, v61, v74
  ds_read_b64_tr_b16 v[198:199], v185 offset:512
  v_sub_f32 v62, v62, v74
  v_sub_f32 v63, v63, v74
  ds_read_b64_tr_b16 v[200:201], v184 offset:2048
  v_sub_f32 v64, v64, v74
  v_sub_f32 v65, v65, v74
  ds_read_b64_tr_b16 v[202:203], v184 offset:2560
  v_sub_f32 v66, v66, v74
  v_sub_f32 v67, v67, v74
  ds_read_b64_tr_b16 v[204:205], v185 offset:2048
  v_sub_f32 v68, v68, v74
  v_sub_f32 v69, v69, v74
  ds_read_b64_tr_b16 v[206:207], v185 offset:2560
  v_sub_f32 v70, v70, v74
  v_sub_f32 v71, v71, v74
  ds_read_b64_tr_b16 v[208:209], v184 offset:4096
  v_mul_f32 v72, v52, v52
  v_mul_f32 v73, v53, v53
  ds_read_b64_tr_b16 v[210:211], v184 offset:4608
  v_fmac_f32 v72, v54, v54
  v_fmac_f32 v73, v55, v55
  ds_read_b64_tr_b16 v[212:213], v185 offset:4096
  v_fmac_f32 v72, v56, v56
  v_fmac_f32 v73, v57, v57
  ds_read_b64_tr_b16 v[214:215], v185 offset:4608
  v_fmac_f32 v72, v58, v58
  v_fmac_f32 v73, v59, v59
  s_waitcnt lgkmcnt(4)
  v_fmac_f32 v72, v60, v60
  v_fmac_f32 v73, v61, v61
  ds_read_b64_tr_b16 v[216:217], v184 offset:6144
  v_fmac_f32 v72, v62, v62
  v_fmac_f32 v73, v63, v63
  ds_read_b64_tr_b16 v[218:219], v184 offset:6656
  v_fmac_f32 v72, v64, v64
  v_fmac_f32 v73, v65, v65
  ds_read_b64_tr_b16 v[220:221], v185 offset:6144
  v_fmac_f32 v72, v66, v66
  v_fmac_f32 v73, v67, v67
  ds_read_b64_tr_b16 v[222:223], v185 offset:6656
  v_fmac_f32 v72, v68, v68
  v_fmac_f32 v73, v69, v69
  s_waitcnt lgkmcnt(0)
  v_fmac_f32 v72, v70, v70
  v_fmac_f32 v73, v71, v71
  v_mfma_f32_32x32x16_bf16 v[224:239], v[188:191], v[192:195], 0
  v_add_f32 v72, v72, v73
  s_nop 1
  v_add_f32_dpp v72, v72, v72 row_ror:8 row_mask:0xf bank_mask:0xf
  v_mfma_f32_32x32x16_bf16 v[240:255], v[188:191], v[196:199], 0
  s_nop 0
  v_add_f32_dpp v72, v72, v72 row_ror:4 row_mask:0xf bank_mask:0xf
  s_nop 1
  v_add_f32_dpp v72, v72, v72 row_ror:2 row_mask:0xf bank_mask:0xf
  v_mfma_f32_32x32x16_bf16 v[224:239], v[188:191], v[200:203], v[224:239]
  s_nop 0
  v_add_f32_dpp v72, v72, v72 row_ror:1 row_mask:0xf bank_mask:0xf
  ds_swizzle_b32 v73, v72 offset:0x401F
  v_mfma_f32_32x32x16_bf16 v[240:255], v[188:191], v[204:207], v[240:255]
  s_waitcnt lgkmcnt(0)
  v_add_f32 v72, v72, v73
  v_mfma_f32_32x32x16_bf16 v[224:239], v[188:191], v[208:211], v[224:239]
  v_mul_f32 v72, 0.0015625, v72
  v_add_f32 v73, 0x3727c5ac, v72
  v_rsq_f32 v77, v73
  v_mov_b32 v76, v74
  v_mul_f32 v73, v77, v77
  v_mul_f32 v73, v73, v72
  v_add_f32 v73, 0x3727c5ac, v73
  v_rsq_f32 v73, v73
  v_mov_b32 v79, 0
  v_mul_f32 v78, v77, v73
  v_lshlrev_b32 v39, 4, v38
  v_add_u32 v39, 0, v39
  v_cmp_eq_u32 vcc, 0, v37
  v_mov_b32 v73, 0x7fff0000
  s_nop 0
  v_cndmask_b32 v39, v73, v39, vcc
  buffer_store_dwordx4 v[76:79], v39, s[24:27], 0 offen sc1
  v_mfma_f32_32x32x16_bf16 v[240:255], v[188:191], v[212:215], v[240:255]
  v_mfma_f32_32x32x16_bf16 v[224:239], v[188:191], v[216:219], v[224:239]
  v_mfma_f32_32x32x16_bf16 v[240:255], v[188:191], v[220:223], v[240:255]
  s_mul_i32 s41, s55, 14592
  s_lshl_b32 s42, s54, 8
  s_add_u32 s41, s41, s42
  s_add_u32 s41, s41, 65536
  v_lshlrev_b32 v176, 2, v1
  v_cmp_gt_u32 vcc, 32, v1
  v_mov_b32 v177, 0x7fff0000
  s_nop 0
  v_cndmask_b32 v176, v177, v176, vcc
  s_cmp_eq_u32 s50, -1
  s_cselect_b32 s42, 0x7fff0000, 0
  v_add_u32 v176, s42, v176
  v_mov_b32 v177, 0x7fff0000
  v_min_u32 v176, v176, v177
  buffer_store_dword v224, v176, s[24:27], s41 offen offset:0 sc1
  buffer_store_dword v240, v176, s[24:27], s41 offen offset:128 sc1
  v_lshrrev_b32 v36, 4, v1
  v_lshrrev_b32 v37, 2, v1
  v_and_b32 v37, 3, v37
  v_lshl_add_u32 v36, v36, 3, v37
  v_lshlrev_b32 v36, 7, v36
  v_and_b32 v37, 3, v1
  v_lshl_add_u32 v36, v37, 3, v36
  v_add_u32 v36, s87, v36
  v_lshlrev_b32 v37, 4, v1
  s_cmp_eq_u32 s51, -1
  s_cselect_b32 s41, 0x7fff0000, 0
  v_add_u32 v37, s41, v37
  s_waitcnt vmcnt(7)
  ds_read_b64_tr_b16 v[52:53], v36 offset:0
  ds_read_b64_tr_b16 v[54:55], v36 offset:512
  ds_read_b64_tr_b16 v[56:57], v36 offset:32
  ds_read_b64_tr_b16 v[58:59], v36 offset:544
  ds_read_b64_tr_b16 v[60:61], v36 offset:64
  ds_read_b64_tr_b16 v[62:63], v36 offset:576
  ds_read_b64_tr_b16 v[64:65], v36 offset:96
  ds_read_b64_tr_b16 v[66:67], v36 offset:608
  s_waitcnt lgkmcnt(0)
  v_lshrrev_b32 v76, 4, v1
  v_lshrrev_b32 v77, 2, v1
  v_and_b32 v77, 3, v77
  v_lshl_add_u32 v76, v76, 3, v77
  v_lshlrev_b32 v76, 7, v76
  v_and_b32 v77, 3, v1
  v_lshl_add_u32 v76, v77, 3, v76
  v_add_u32 v76, s48, v76
  v_lshlrev_b32 v77, 4, v1
  s_cmp_eq_u32 s49, -1
  s_cselect_b32 s41, 0x7fff0000, 0
  v_add_u32 v77, s41, v77
  s_waitcnt vmcnt(3)
  ds_read_b64_tr_b16 v[92:93], v76 offset:0
  ds_read_b64_tr_b16 v[94:95], v76 offset:512
  ds_read_b64_tr_b16 v[96:97], v76 offset:32
  ds_read_b64_tr_b16 v[98:99], v76 offset:544
  ds_read_b64_tr_b16 v[100:101], v76 offset:64
  ds_read_b64_tr_b16 v[102:103], v76 offset:576
  ds_read_b64_tr_b16 v[104:105], v76 offset:96
  ds_read_b64_tr_b16 v[106:107], v76 offset:608
  s_waitcnt lgkmcnt(0)
  s_lshl_b32 s41, s57, 2
  s_add_u32 s41, s41, 0
  s_mul_i32 s42, s41, 13
  s_lshr_b32 s42, s42, 6
  s_mul_i32 s43, s42, 5
  s_sub_u32 s43, s41, s43
  s_mul_i32 s42, s42, 74
  s_add_u32 s42, s42, s56
  s_mul_i32 s42, s42, 5
  s_add_u32 s42, s42, s43
  s_lshl_b32 s42, s42, 10
  s_add_u32 s42, s42, 4194304
  buffer_store_dwordx4 v[52:55], v37, s[24:27], s42 offen sc1
  s_lshl_b32 s41, s57, 2
  s_add_u32 s41, s41, 1
  s_mul_i32 s42, s41, 13
  s_lshr_b32 s42, s42, 6
  s_mul_i32 s43, s42, 5
  s_sub_u32 s43, s41, s43
  s_mul_i32 s42, s42, 74
  s_add_u32 s42, s42, s56
  s_mul_i32 s42, s42, 5
  s_add_u32 s42, s42, s43
  s_lshl_b32 s42, s42, 10
  s_add_u32 s42, s42, 4194304
  buffer_store_dwordx4 v[56:59], v37, s[24:27], s42 offen sc1
  s_lshl_b32 s41, s57, 2
  s_add_u32 s41, s41, 2
  s_mul_i32 s42, s41, 13
  s_lshr_b32 s42, s42, 6
  s_mul_i32 s43, s42, 5
  s_sub_u32 s43, s41, s43
  s_mul_i32 s42, s42, 74
  s_add_u32 s42, s42, s56
  s_mul_i32 s42, s42, 5
  s_add_u32 s42, s42, s43
  s_lshl_b32 s42, s42, 10
  s_add_u32 s42, s42, 4194304
  buffer_store_dwordx4 v[60:63], v37, s[24:27], s42 offen sc1
  s_lshl_b32 s41, s57, 2
  s_add_u32 s41, s41, 3
  s_mul_i32 s42, s41, 13
  s_lshr_b32 s42, s42, 6
  s_mul_i32 s43, s42, 5
  s_sub_u32 s43, s41, s43
  s_mul_i32 s42, s42, 74
  s_add_u32 s42, s42, s56
  s_mul_i32 s42, s42, 5
  s_add_u32 s42, s42, s43
  s_lshl_b32 s42, s42, 10
  s_add_u32 s42, s42, 4194304
  buffer_store_dwordx4 v[64:67], v37, s[24:27], s42 offen sc1
  s_lshl_b32 s41, s101, 2
  s_add_u32 s41, s41, 0
  s_mul_i32 s42, s41, 13
  s_lshr_b32 s42, s42, 6
  s_mul_i32 s43, s42, 5
  s_sub_u32 s43, s41, s43
  s_mul_i32 s42, s42, 74
  s_add_u32 s42, s42, s100
  s_mul_i32 s42, s42, 5
  s_add_u32 s42, s42, s43
  s_lshl_b32 s42, s42, 10
  s_add_u32 s42, s42, 4194304
  buffer_store_dwordx4 v[92:95], v77, s[24:27], s42 offen sc1
  s_lshl_b32 s41, s101, 2
  s_add_u32 s41, s41, 1
  s_mul_i32 s42, s41, 13
  s_lshr_b32 s42, s42, 6
  s_mul_i32 s43, s42, 5
  s_sub_u32 s43, s41, s43
  s_mul_i32 s42, s42, 74
  s_add_u32 s42, s42, s100
  s_mul_i32 s42, s42, 5
  s_add_u32 s42, s42, s43
  s_lshl_b32 s42, s42, 10
  s_add_u32 s42, s42, 4194304
  buffer_store_dwordx4 v[96:99], v77, s[24:27], s42 offen sc1
  s_lshl_b32 s41, s101, 2
  s_add_u32 s41, s41, 2
  s_mul_i32 s42, s41, 13
  s_lshr_b32 s42, s42, 6
  s_mul_i32 s43, s42, 5
  s_sub_u32 s43, s41, s43
  s_mul_i32 s42, s42, 74
  s_add_u32 s42, s42, s100
  s_mul_i32 s42, s42, 5
  s_add_u32 s42, s42, s43
  s_lshl_b32 s42, s42, 10
  s_add_u32 s42, s42, 4194304
  buffer_store_dwordx4 v[100:103], v77, s[24:27], s42 offen sc1
  s_lshl_b32 s41, s101, 2
  s_add_u32 s41, s41, 3
  s_mul_i32 s42, s41, 13
  s_lshr_b32 s42, s42, 6
  s_mul_i32 s43, s42, 5
  s_sub_u32 s43, s41, s43
  s_mul_i32 s42, s42, 74
  s_add_u32 s42, s42, s100
  s_mul_i32 s42, s42, 5
  s_add_u32 s42, s42, s43
  s_lshl_b32 s42, s42, 10
  s_add_u32 s42, s42, 4194304
  buffer_store_dwordx4 v[104:107], v77, s[24:27], s42 offen sc1
  s_branch L_parallel_sum__linear_kernel_hedgehog__mixer_channel_mlp__prompt_kernel_jobs_done
L_parallel_sum__linear_kernel_hedgehog__mixer_channel_mlp__prompt_kernel_jobs_kv:
  s_waitcnt vmcnt(8)
  v_lshlrev_b32 v52, 16, v40
  v_and_b32 v53, 0xffff0000, v40
  v_lshlrev_b32 v54, 16, v41
  v_and_b32 v55, 0xffff0000, v41
  v_lshlrev_b32 v56, 16, v42
  v_and_b32 v57, 0xffff0000, v42
  v_lshlrev_b32 v58, 16, v43
  v_and_b32 v59, 0xffff0000, v43
  v_lshlrev_b32 v60, 16, v44
  v_and_b32 v61, 0xffff0000, v44
  v_lshlrev_b32 v62, 16, v45
  v_and_b32 v63, 0xffff0000, v45
  v_lshlrev_b32 v64, 16, v46
  v_and_b32 v65, 0xffff0000, v46
  v_lshlrev_b32 v66, 16, v47
  v_and_b32 v67, 0xffff0000, v47
  v_lshlrev_b32 v68, 16, v48
  v_and_b32 v69, 0xffff0000, v48
  v_lshlrev_b32 v70, 16, v49
  v_and_b32 v71, 0xffff0000, v49
  v_add_f32 v72, v52, v53
  v_add_f32 v73, v54, v55
  v_add_f32 v72, v72, v56
  v_add_f32 v73, v73, v57
  v_add_f32 v72, v72, v58
  v_add_f32 v73, v73, v59
  v_add_f32 v72, v72, v60
  v_add_f32 v73, v73, v61
  v_add_f32 v72, v72, v62
  v_add_f32 v73, v73, v63
  v_add_f32 v72, v72, v64
  v_add_f32 v73, v73, v65
  v_add_f32 v72, v72, v66
  v_add_f32 v73, v73, v67
  v_add_f32 v72, v72, v68
  v_add_f32 v73, v73, v69
  v_add_f32 v72, v72, v70
  v_add_f32 v73, v73, v71
  v_add_f32 v72, v72, v73
  s_nop 1
  v_add_f32_dpp v72, v72, v72 row_ror:8 row_mask:0xf bank_mask:0xf
  s_nop 1
  v_add_f32_dpp v72, v72, v72 row_ror:4 row_mask:0xf bank_mask:0xf
  s_nop 1
  v_add_f32_dpp v72, v72, v72 row_ror:2 row_mask:0xf bank_mask:0xf
  s_nop 1
  v_add_f32_dpp v72, v72, v72 row_ror:1 row_mask:0xf bank_mask:0xf
  ds_swizzle_b32 v73, v72 offset:0x401F
  s_waitcnt lgkmcnt(0)
  v_add_f32 v72, v72, v73
  v_mul_f32 v74, 0.0015625, v72
  v_sub_f32 v52, v52, v74
  v_sub_f32 v53, v53, v74
  v_sub_f32 v54, v54, v74
  v_sub_f32 v55, v55, v74
  v_sub_f32 v56, v56, v74
  v_sub_f32 v57, v57, v74
  v_sub_f32 v58, v58, v74
  v_sub_f32 v59, v59, v74
  v_sub_f32 v60, v60, v74
  v_sub_f32 v61, v61, v74
  v_sub_f32 v62, v62, v74
  v_sub_f32 v63, v63, v74
  v_sub_f32 v64, v64, v74
  v_sub_f32 v65, v65, v74
  v_sub_f32 v66, v66, v74
  v_sub_f32 v67, v67, v74
  v_sub_f32 v68, v68, v74
  v_sub_f32 v69, v69, v74
  v_sub_f32 v70, v70, v74
  v_sub_f32 v71, v71, v74
  v_mul_f32 v72, v52, v52
  v_mul_f32 v73, v53, v53
  v_fmac_f32 v72, v54, v54
  v_fmac_f32 v73, v55, v55
  v_fmac_f32 v72, v56, v56
  v_fmac_f32 v73, v57, v57
  v_fmac_f32 v72, v58, v58
  v_fmac_f32 v73, v59, v59
  v_fmac_f32 v72, v60, v60
  v_fmac_f32 v73, v61, v61
  v_fmac_f32 v72, v62, v62
  v_fmac_f32 v73, v63, v63
  v_fmac_f32 v72, v64, v64
  v_fmac_f32 v73, v65, v65
  v_fmac_f32 v72, v66, v66
  v_fmac_f32 v73, v67, v67
  v_fmac_f32 v72, v68, v68
  v_fmac_f32 v73, v69, v69
  v_fmac_f32 v72, v70, v70
  v_fmac_f32 v73, v71, v71
  v_add_f32 v72, v72, v73
  s_nop 1
  v_add_f32_dpp v72, v72, v72 row_ror:8 row_mask:0xf bank_mask:0xf
  s_nop 1
  v_add_f32_dpp v72, v72, v72 row_ror:4 row_mask:0xf bank_mask:0xf
  s_nop 1
  v_add_f32_dpp v72, v72, v72 row_ror:2 row_mask:0xf bank_mask:0xf
  s_nop 1
  v_add_f32_dpp v72, v72, v72 row_ror:1 row_mask:0xf bank_mask:0xf
  ds_swizzle_b32 v73, v72 offset:0x401F
  s_waitcnt lgkmcnt(0)
  v_add_f32 v72, v72, v73
  v_mul_f32 v72, 0.0015625, v72
  v_add_f32 v73, 0x3727c5ac, v72
  v_rsq_f32 v77, v73
  v_mov_b32 v76, v74
  v_mul_f32 v73, v77, v77
  v_mul_f32 v73, v73, v72
  v_add_f32 v73, 0x3727c5ac, v73
  v_rsq_f32 v73, v73
  v_mov_b32 v79, 0
  v_mul_f32 v78, v77, v73
  v_lshlrev_b32 v39, 4, v38
  v_add_u32 v39, 0, v39
  v_cmp_eq_u32 vcc, 0, v37
  v_mov_b32 v73, 0x7fff0000
  s_nop 0
  v_cndmask_b32 v39, v73, v39, vcc
  buffer_store_dwordx4 v[76:79], v39, s[24:27], 0 offen sc1
  s_cmp_eq_u32 s50, -1
  s_cbranch_scc1 L_parallel_sum__linear_kernel_hedgehog__mixer_channel_mlp__prompt_kernel_jk_nocs
  v_lshrrev_b32 v176, 4, v1
  v_lshrrev_b32 v177, 2, v1
  v_and_b32 v177, 3, v177
  v_and_b32 v178, 3, v1
  v_lshrrev_b32 v180, 1, v176
  v_lshl_add_u32 v180, v180, 3, v177
  v_lshlrev_b32 v180, 7, v180
  v_and_b32 v181, 1, v176
  v_lshlrev_b32 v181, 1, v181
  v_lshrrev_b32 v182, 1, v178
  v_add_u32 v181, v181, v182
  v_lshrrev_b32 v182, 1, v177
  v_lshlrev_b32 v182, 2, v182
  v_and_b32 v183, 1, v178
  v_lshl_add_u32 v180, v183, 3, v180
  v_add_u32 v180, s52, v180
  v_xor_b32 v183, v181, v182
  v_lshl_add_u32 v184, v183, 4, v180
  v_xor_b32 v183, 4, v183
  v_lshl_add_u32 v185, v183, 4, v180
  v_mov_b32 v188, 0x3f803f80
  v_mov_b32 v189, 0x3f803f80
  v_mov_b32 v190, 0x3f803f80
  v_mov_b32 v191, 0x3f803f80
  s_waitcnt vmcnt(1)
  ds_read_b64_tr_b16 v[192:193], v184 offset:0
  ds_read_b64_tr_b16 v[194:195], v184 offset:512
  ds_read_b64_tr_b16 v[196:197], v185 offset:0
  ds_read_b64_tr_b16 v[198:199], v185 offset:512
  ds_read_b64_tr_b16 v[200:201], v184 offset:2048
  ds_read_b64_tr_b16 v[202:203], v184 offset:2560
  ds_read_b64_tr_b16 v[204:205], v185 offset:2048
  ds_read_b64_tr_b16 v[206:207], v185 offset:2560
  ds_read_b64_tr_b16 v[208:209], v184 offset:4096
  ds_read_b64_tr_b16 v[210:211], v184 offset:4608
  ds_read_b64_tr_b16 v[212:213], v185 offset:4096
  ds_read_b64_tr_b16 v[214:215], v185 offset:4608
  s_waitcnt lgkmcnt(4)
  ds_read_b64_tr_b16 v[216:217], v184 offset:6144
  ds_read_b64_tr_b16 v[218:219], v184 offset:6656
  ds_read_b64_tr_b16 v[220:221], v185 offset:6144
  ds_read_b64_tr_b16 v[222:223], v185 offset:6656
  s_waitcnt lgkmcnt(0)
  v_mfma_f32_32x32x16_bf16 v[224:239], v[188:191], v[192:195], 0
  v_mfma_f32_32x32x16_bf16 v[240:255], v[188:191], v[196:199], 0
  v_mfma_f32_32x32x16_bf16 v[224:239], v[188:191], v[200:203], v[224:239]
  v_mfma_f32_32x32x16_bf16 v[240:255], v[188:191], v[204:207], v[240:255]
  v_mfma_f32_32x32x16_bf16 v[224:239], v[188:191], v[208:211], v[224:239]
  v_mfma_f32_32x32x16_bf16 v[240:255], v[188:191], v[212:215], v[240:255]
  v_mfma_f32_32x32x16_bf16 v[224:239], v[188:191], v[216:219], v[224:239]
  v_mfma_f32_32x32x16_bf16 v[240:255], v[188:191], v[220:223], v[240:255]
  s_mul_i32 s41, s55, 14592
  s_lshl_b32 s42, s54, 8
  s_add_u32 s41, s41, s42
  s_add_u32 s41, s41, 65536
  v_lshlrev_b32 v176, 2, v1
  v_cmp_gt_u32 vcc, 32, v1
  v_mov_b32 v177, 0x7fff0000
  s_nop 0
  v_cndmask_b32 v176, v177, v176, vcc
  s_cmp_eq_u32 s50, -1
  s_cselect_b32 s42, 0x7fff0000, 0
  v_add_u32 v176, s42, v176
  v_mov_b32 v177, 0x7fff0000
  v_min_u32 v176, v176, v177
  buffer_store_dword v224, v176, s[24:27], s41 offen offset:0 sc1
  buffer_store_dword v240, v176, s[24:27], s41 offen offset:128 sc1
L_parallel_sum__linear_kernel_hedgehog__mixer_channel_mlp__prompt_kernel_jk_nocs:
L_parallel_sum__linear_kernel_hedgehog__mixer_channel_mlp__prompt_kernel_jobs_done:
  s_mul_i32 s41, s2, 3
  s_add_u32 s41, s41, 16
  v_add_u32 v36, s41, v1
  v_cmp_gt_u32 vcc, 624, v36
  s_nop 0
  s_mov_b64 s[58:59], vcc
  v_cmp_gt_u32 vcc, 3, v1
  s_nop 0
  s_and_b64 vcc, vcc, s[58:59]
  s_cmp_eq_u32 s39, 1
  s_cselect_b64 s[58:59], -1, 0
  s_and_b64 vcc, vcc, s[58:59]
  v_lshlrev_b32 v36, 7, v36
  v_add_u32 v36, 20971520, v36
  v_mov_b32 v37, 0x7fff0000
  v_cndmask_b32 v36, v37, v36, vcc
  v_mov_b32 v38, 0
  buffer_store_dword v38, v36, s[24:27], 0 offen sc1
  v_mov_b32 v48, 0
  s_lshr_b32 s43, s39, 1
  s_and_b32 s44, s39, 1
  global_load_dword v49, v48, s[84:85] sc1
  s_barrier
  s_setprio 1
  ds_read_b128 v[80:83], v4 offset:0
  ds_read_b128 v[84:87], v4 offset:4096
  ds_read_b64_tr_b16 v[88:89], v12 offset:0
  ds_read_b64_tr_b16 v[90:91], v12 offset:512
  ds_read_b64_tr_b16 v[92:93], v13 offset:0
  ds_read_b64_tr_b16 v[94:95], v13 offset:512
  ds_read_b64_tr_b16 v[96:97], v14 offset:0
  ds_read_b64_tr_b16 v[98:99], v14 offset:512
  ds_read_b64_tr_b16 v[100:101], v15 offset:0
  ds_read_b64_tr_b16 v[102:103], v15 offset:512
  s_waitcnt lgkmcnt(0)
  v_mfma_f32_32x32x16_bf16 v[128:143], v[88:91], v[80:83], 0
  ds_read_b128 v[104:107], v5 offset:0
  ds_read_b128 v[108:111], v5 offset:4096
  v_mfma_f32_32x32x16_bf16 v[192:207], v[88:91], v[84:87], 0
  ds_read_b64_tr_b16 v[112:113], v12 offset:2048
  ds_read_b64_tr_b16 v[114:115], v12 offset:2560
  v_mfma_f32_32x32x16_bf16 v[144:159], v[92:95], v[80:83], 0
  ds_read_b64_tr_b16 v[116:117], v13 offset:2048
  ds_read_b64_tr_b16 v[118:119], v13 offset:2560
  v_mfma_f32_32x32x16_bf16 v[208:223], v[92:95], v[84:87], 0
  ds_read_b64_tr_b16 v[120:121], v14 offset:2048
  ds_read_b64_tr_b16 v[122:123], v14 offset:2560
  v_mfma_f32_32x32x16_bf16 v[160:175], v[96:99], v[80:83], 0
  ds_read_b64_tr_b16 v[124:125], v15 offset:2048
  v_mfma_f32_32x32x16_bf16 v[224:239], v[96:99], v[84:87], 0
  ds_read_b64_tr_b16 v[126:127], v15 offset:2560
  v_mfma_f32_32x32x16_bf16 v[176:191], v[100:103], v[80:83], 0
  v_mfma_f32_32x32x16_bf16 v[240:255], v[100:103], v[84:87], 0
  s_waitcnt lgkmcnt(0)
  v_mfma_f32_32x32x16_bf16 v[128:143], v[112:115], v[104:107], v[128:143]
  s_barrier
  ds_read_b128 v[80:83], v6 offset:0
  ds_read_b128 v[84:87], v6 offset:4096
  v_mfma_f32_32x32x16_bf16 v[192:207], v[112:115], v[108:111], v[192:207]
  ds_read_b64_tr_b16 v[88:89], v12 offset:16384
  ds_read_b64_tr_b16 v[90:91], v12 offset:16896
  v_mfma_f32_32x32x16_bf16 v[144:159], v[116:119], v[104:107], v[144:159]
  ds_read_b64_tr_b16 v[92:93], v13 offset:16384
  ds_read_b64_tr_b16 v[94:95], v13 offset:16896
  v_mfma_f32_32x32x16_bf16 v[208:223], v[116:119], v[108:111], v[208:223]
  ds_read_b64_tr_b16 v[96:97], v14 offset:16384
  ds_read_b64_tr_b16 v[98:99], v14 offset:16896
  v_mfma_f32_32x32x16_bf16 v[160:175], v[120:123], v[104:107], v[160:175]
  ds_read_b64_tr_b16 v[100:101], v15 offset:16384
  v_mfma_f32_32x32x16_bf16 v[224:239], v[120:123], v[108:111], v[224:239]
  ds_read_b64_tr_b16 v[102:103], v15 offset:16896
  v_mfma_f32_32x32x16_bf16 v[176:191], v[124:127], v[104:107], v[176:191]
  v_mfma_f32_32x32x16_bf16 v[240:255], v[124:127], v[108:111], v[240:255]
  s_waitcnt lgkmcnt(0)
  v_mfma_f32_32x32x16_bf16 v[128:143], v[88:91], v[80:83], v[128:143]
  ds_read_b128 v[104:107], v7 offset:0
  ds_read_b128 v[108:111], v7 offset:4096
  v_mfma_f32_32x32x16_bf16 v[192:207], v[88:91], v[84:87], v[192:207]
  ds_read_b64_tr_b16 v[112:113], v12 offset:18432
  ds_read_b64_tr_b16 v[114:115], v12 offset:18944
  v_mfma_f32_32x32x16_bf16 v[144:159], v[92:95], v[80:83], v[144:159]
  ds_read_b64_tr_b16 v[116:117], v13 offset:18432
  ds_read_b64_tr_b16 v[118:119], v13 offset:18944
  v_mfma_f32_32x32x16_bf16 v[208:223], v[92:95], v[84:87], v[208:223]
  ds_read_b64_tr_b16 v[120:121], v14 offset:18432
  ds_read_b64_tr_b16 v[122:123], v14 offset:18944
  v_mfma_f32_32x32x16_bf16 v[160:175], v[96:99], v[80:83], v[160:175]
  ds_read_b64_tr_b16 v[124:125], v15 offset:18432
  v_mfma_f32_32x32x16_bf16 v[224:239], v[96:99], v[84:87], v[224:239]
  ds_read_b64_tr_b16 v[126:127], v15 offset:18944
  v_add_u32 v4, s47, v8
  v_mfma_f32_32x32x16_bf16 v[176:191], v[100:103], v[80:83], v[176:191]
  v_add_u32 v5, s47, v9
  v_mfma_f32_32x32x16_bf16 v[240:255], v[100:103], v[84:87], v[240:255]
  v_add_u32 v6, s47, v10
  s_waitcnt lgkmcnt(0)
  v_mfma_f32_32x32x16_bf16 v[128:143], v[112:115], v[104:107], v[128:143]
  s_barrier
  ds_read_b128 v[80:83], v4 offset:0
  ds_read_b128 v[84:87], v4 offset:4096
  v_mfma_f32_32x32x16_bf16 v[192:207], v[112:115], v[108:111], v[192:207]
  ds_read_b64_tr_b16 v[88:89], v12 offset:32768
  ds_read_b64_tr_b16 v[90:91], v12 offset:33280
  v_mfma_f32_32x32x16_bf16 v[144:159], v[116:119], v[104:107], v[144:159]
  ds_read_b64_tr_b16 v[92:93], v13 offset:32768
  ds_read_b64_tr_b16 v[94:95], v13 offset:33280
  v_mfma_f32_32x32x16_bf16 v[208:223], v[116:119], v[108:111], v[208:223]
  ds_read_b64_tr_b16 v[96:97], v14 offset:32768
  ds_read_b64_tr_b16 v[98:99], v14 offset:33280
  v_mfma_f32_32x32x16_bf16 v[160:175], v[120:123], v[104:107], v[160:175]
  ds_read_b64_tr_b16 v[100:101], v15 offset:32768
  v_mfma_f32_32x32x16_bf16 v[224:239], v[120:123], v[108:111], v[224:239]
  ds_read_b64_tr_b16 v[102:103], v15 offset:33280
  v_mfma_f32_32x32x16_bf16 v[176:191], v[124:127], v[104:107], v[176:191]
  v_mfma_f32_32x32x16_bf16 v[240:255], v[124:127], v[108:111], v[240:255]
  v_add_u32 v7, s47, v11
  s_add_u32 s47, s47, 16384
  s_cmp_eq_u32 s47, 49152
  s_cselect_b32 s47, 0, s47
  s_waitcnt lgkmcnt(0)
  v_mfma_f32_32x32x16_bf16 v[128:143], v[88:91], v[80:83], v[128:143]
  ds_read_b128 v[104:107], v5 offset:0
  ds_read_b128 v[108:111], v5 offset:4096
  v_mfma_f32_32x32x16_bf16 v[192:207], v[88:91], v[84:87], v[192:207]
  ds_read_b64_tr_b16 v[112:113], v12 offset:34816
  ds_read_b64_tr_b16 v[114:115], v12 offset:35328
  v_mfma_f32_32x32x16_bf16 v[144:159], v[92:95], v[80:83], v[144:159]
  ds_read_b64_tr_b16 v[116:117], v13 offset:34816
  ds_read_b64_tr_b16 v[118:119], v13 offset:35328
  v_mfma_f32_32x32x16_bf16 v[208:223], v[92:95], v[84:87], v[208:223]
  ds_read_b64_tr_b16 v[120:121], v14 offset:34816
  ds_read_b64_tr_b16 v[122:123], v14 offset:35328
  v_mfma_f32_32x32x16_bf16 v[160:175], v[96:99], v[80:83], v[160:175]
  ds_read_b64_tr_b16 v[124:125], v15 offset:34816
  v_mfma_f32_32x32x16_bf16 v[224:239], v[96:99], v[84:87], v[224:239]
  ds_read_b64_tr_b16 v[126:127], v15 offset:35328
  v_mfma_f32_32x32x16_bf16 v[176:191], v[100:103], v[80:83], v[176:191]
  v_mfma_f32_32x32x16_bf16 v[240:255], v[100:103], v[84:87], v[240:255]
  s_waitcnt lgkmcnt(0)
  v_mfma_f32_32x32x16_bf16 v[128:143], v[112:115], v[104:107], v[128:143]
  s_barrier
  ds_read_b128 v[80:83], v6 offset:0
  ds_read_b128 v[84:87], v6 offset:4096
  v_mfma_f32_32x32x16_bf16 v[192:207], v[112:115], v[108:111], v[192:207]
  ds_read_b64_tr_b16 v[88:89], v12 offset:49152
  ds_read_b64_tr_b16 v[90:91], v12 offset:49664
  v_mfma_f32_32x32x16_bf16 v[144:159], v[116:119], v[104:107], v[144:159]
  ds_read_b64_tr_b16 v[92:93], v13 offset:49152
  ds_read_b64_tr_b16 v[94:95], v13 offset:49664
  v_mfma_f32_32x32x16_bf16 v[208:223], v[116:119], v[108:111], v[208:223]
  ds_read_b64_tr_b16 v[96:97], v14 offset:49152
  ds_read_b64_tr_b16 v[98:99], v14 offset:49664
  v_mfma_f32_32x32x16_bf16 v[160:175], v[120:123], v[104:107], v[160:175]
  ds_read_b64_tr_b16 v[100:101], v15 offset:49152
  v_mfma_f32_32x32x16_bf16 v[224:239], v[120:123], v[108:111], v[224:239]
  ds_read_b64_tr_b16 v[102:103], v15 offset:49664
  v_mfma_f32_32x32x16_bf16 v[176:191], v[124:127], v[104:107], v[176:191]
  v_mfma_f32_32x32x16_bf16 v[240:255], v[124:127], v[108:111], v[240:255]
  s_waitcnt lgkmcnt(0)
  v_mfma_f32_32x32x16_bf16 v[128:143], v[88:91], v[80:83], v[128:143]
  ds_read_b128 v[104:107], v7 offset:0
  ds_read_b128 v[108:111], v7 offset:4096
  v_mfma_f32_32x32x16_bf16 v[192:207], v[88:91], v[84:87], v[192:207]
  ds_read_b64_tr_b16 v[112:113], v12 offset:51200
  ds_read_b64_tr_b16 v[114:115], v12 offset:51712
  v_mfma_f32_32x32x16_bf16 v[144:159], v[92:95], v[80:83], v[144:159]
  ds_read_b64_tr_b16 v[116:117], v13 offset:51200
  ds_read_b64_tr_b16 v[118:119], v13 offset:51712
  v_mfma_f32_32x32x16_bf16 v[208:223], v[92:95], v[84:87], v[208:223]
  ds_read_b64_tr_b16 v[120:121], v14 offset:51200
  ds_read_b64_tr_b16 v[122:123], v14 offset:51712
  v_mfma_f32_32x32x16_bf16 v[160:175], v[96:99], v[80:83], v[160:175]
  ds_read_b64_tr_b16 v[124:125], v15 offset:51200
  v_mfma_f32_32x32x16_bf16 v[224:239], v[96:99], v[84:87], v[224:239]
  ds_read_b64_tr_b16 v[126:127], v15 offset:51712
  v_add_u32 v4, s47, v8
  v_mfma_f32_32x32x16_bf16 v[176:191], v[100:103], v[80:83], v[176:191]
  v_add_u32 v5, s47, v9
  v_mfma_f32_32x32x16_bf16 v[240:255], v[100:103], v[84:87], v[240:255]
  v_add_u32 v6, s47, v10
  s_waitcnt lgkmcnt(0)
  v_mfma_f32_32x32x16_bf16 v[128:143], v[112:115], v[104:107], v[128:143]
  s_barrier
  ds_read_b128 v[80:83], v4 offset:0
  ds_read_b128 v[84:87], v4 offset:4096
  v_mfma_f32_32x32x16_bf16 v[192:207], v[112:115], v[108:111], v[192:207]
  ds_read_b64_tr_b16 v[88:89], v12 offset:0
  ds_read_b64_tr_b16 v[90:91], v12 offset:512
  v_mfma_f32_32x32x16_bf16 v[144:159], v[116:119], v[104:107], v[144:159]
  ds_read_b64_tr_b16 v[92:93], v13 offset:0
  ds_read_b64_tr_b16 v[94:95], v13 offset:512
  v_mfma_f32_32x32x16_bf16 v[208:223], v[116:119], v[108:111], v[208:223]
  ds_read_b64_tr_b16 v[96:97], v14 offset:0
  ds_read_b64_tr_b16 v[98:99], v14 offset:512
  v_mfma_f32_32x32x16_bf16 v[160:175], v[120:123], v[104:107], v[160:175]
  ds_read_b64_tr_b16 v[100:101], v15 offset:0
  v_mfma_f32_32x32x16_bf16 v[224:239], v[120:123], v[108:111], v[224:239]
  ds_read_b64_tr_b16 v[102:103], v15 offset:512
  v_mfma_f32_32x32x16_bf16 v[176:191], v[124:127], v[104:107], v[176:191]
  v_mfma_f32_32x32x16_bf16 v[240:255], v[124:127], v[108:111], v[240:255]
  v_add_u32 v7, s47, v11
  s_add_u32 s47, s47, 16384
  s_cmp_eq_u32 s47, 49152
  s_cselect_b32 s47, 0, s47
  s_mov_b32 s46, 1
.p2align 3
L_parallel_sum__linear_kernel_hedgehog__mixer_channel_mlp__prompt_kernel_kloop:
  s_waitcnt lgkmcnt(0)
  v_mfma_f32_32x32x16_bf16 v[128:143], v[88:91], v[80:83], v[128:143]
  ds_read_b128 v[104:107], v5 offset:0
  ds_read_b128 v[108:111], v5 offset:4096
  v_mfma_f32_32x32x16_bf16 v[192:207], v[88:91], v[84:87], v[192:207]
  ds_read_b64_tr_b16 v[112:113], v12 offset:2048
  ds_read_b64_tr_b16 v[114:115], v12 offset:2560
  v_mfma_f32_32x32x16_bf16 v[144:159], v[92:95], v[80:83], v[144:159]
  ds_read_b64_tr_b16 v[116:117], v13 offset:2048
  ds_read_b64_tr_b16 v[118:119], v13 offset:2560
  v_mfma_f32_32x32x16_bf16 v[208:223], v[92:95], v[84:87], v[208:223]
  ds_read_b64_tr_b16 v[120:121], v14 offset:2048
  ds_read_b64_tr_b16 v[122:123], v14 offset:2560
  v_mfma_f32_32x32x16_bf16 v[160:175], v[96:99], v[80:83], v[160:175]
  ds_read_b64_tr_b16 v[124:125], v15 offset:2048
  v_mfma_f32_32x32x16_bf16 v[224:239], v[96:99], v[84:87], v[224:239]
  ds_read_b64_tr_b16 v[126:127], v15 offset:2560
  v_mfma_f32_32x32x16_bf16 v[176:191], v[100:103], v[80:83], v[176:191]
  v_mfma_f32_32x32x16_bf16 v[240:255], v[100:103], v[84:87], v[240:255]
  s_waitcnt lgkmcnt(0)
  v_mfma_f32_32x32x16_bf16 v[128:143], v[112:115], v[104:107], v[128:143]
  s_barrier
  ds_read_b128 v[80:83], v6 offset:0
  ds_read_b128 v[84:87], v6 offset:4096
  v_mfma_f32_32x32x16_bf16 v[192:207], v[112:115], v[108:111], v[192:207]
  ds_read_b64_tr_b16 v[88:89], v12 offset:16384
  ds_read_b64_tr_b16 v[90:91], v12 offset:16896
  v_mfma_f32_32x32x16_bf16 v[144:159], v[116:119], v[104:107], v[144:159]
  ds_read_b64_tr_b16 v[92:93], v13 offset:16384
  ds_read_b64_tr_b16 v[94:95], v13 offset:16896
  v_mfma_f32_32x32x16_bf16 v[208:223], v[116:119], v[108:111], v[208:223]
  ds_read_b64_tr_b16 v[96:97], v14 offset:16384
  ds_read_b64_tr_b16 v[98:99], v14 offset:16896
  v_mfma_f32_32x32x16_bf16 v[160:175], v[120:123], v[104:107], v[160:175]
  ds_read_b64_tr_b16 v[100:101], v15 offset:16384
  v_mfma_f32_32x32x16_bf16 v[224:239], v[120:123], v[108:111], v[224:239]
  ds_read_b64_tr_b16 v[102:103], v15 offset:16896
  v_mfma_f32_32x32x16_bf16 v[176:191], v[124:127], v[104:107], v[176:191]
  v_mfma_f32_32x32x16_bf16 v[240:255], v[124:127], v[108:111], v[240:255]
  s_waitcnt lgkmcnt(0)
  v_mfma_f32_32x32x16_bf16 v[128:143], v[88:91], v[80:83], v[128:143]
  ds_read_b128 v[104:107], v7 offset:0
  ds_read_b128 v[108:111], v7 offset:4096
  v_mfma_f32_32x32x16_bf16 v[192:207], v[88:91], v[84:87], v[192:207]
  ds_read_b64_tr_b16 v[112:113], v12 offset:18432
  ds_read_b64_tr_b16 v[114:115], v12 offset:18944
  v_mfma_f32_32x32x16_bf16 v[144:159], v[92:95], v[80:83], v[144:159]
  ds_read_b64_tr_b16 v[116:117], v13 offset:18432
  ds_read_b64_tr_b16 v[118:119], v13 offset:18944
  v_mfma_f32_32x32x16_bf16 v[208:223], v[92:95], v[84:87], v[208:223]
  ds_read_b64_tr_b16 v[120:121], v14 offset:18432
  ds_read_b64_tr_b16 v[122:123], v14 offset:18944
  v_mfma_f32_32x32x16_bf16 v[160:175], v[96:99], v[80:83], v[160:175]
  ds_read_b64_tr_b16 v[124:125], v15 offset:18432
  v_mfma_f32_32x32x16_bf16 v[224:239], v[96:99], v[84:87], v[224:239]
  ds_read_b64_tr_b16 v[126:127], v15 offset:18944
  v_add_u32 v4, s47, v8
  v_mfma_f32_32x32x16_bf16 v[176:191], v[100:103], v[80:83], v[176:191]
  v_add_u32 v5, s47, v9
  v_mfma_f32_32x32x16_bf16 v[240:255], v[100:103], v[84:87], v[240:255]
  v_add_u32 v6, s47, v10
  s_waitcnt lgkmcnt(0)
  v_mfma_f32_32x32x16_bf16 v[128:143], v[112:115], v[104:107], v[128:143]
  s_cmp_eq_u32 s46, 1
  s_cbranch_scc0 L_parallel_sum__linear_kernel_hedgehog__mixer_channel_mlp__prompt_kernel_f2n1
  s_waitcnt vmcnt(0)
L_parallel_sum__linear_kernel_hedgehog__mixer_channel_mlp__prompt_kernel_f2n1:
  s_barrier
  s_lshl_b32 s41, s46, 2
  s_or_b32 s41, s41, s39
  s_cmp_eq_u32 s41, 4
  s_cbranch_scc0 L_parallel_sum__linear_kernel_hedgehog__mixer_channel_mlp__prompt_kernel_f2n2
  v_readfirstlane_b32 s53, v49
  s_nop 0
  s_cmp_eq_u32 s53, 1
  s_cbranch_scc1 L_parallel_sum__linear_kernel_hedgehog__mixer_channel_mlp__prompt_kernel_f2go
L_parallel_sum__linear_kernel_hedgehog__mixer_channel_mlp__prompt_kernel_f2g0:
  s_sleep 4
  global_load_dword v49, v48, s[84:85] sc1
  s_waitcnt vmcnt(0)
  v_readfirstlane_b32 s53, v49
  s_nop 0
  s_cmp_eq_u32 s53, 1
  s_cbranch_scc0 L_parallel_sum__linear_kernel_hedgehog__mixer_channel_mlp__prompt_kernel_f2g0
L_parallel_sum__linear_kernel_hedgehog__mixer_channel_mlp__prompt_kernel_f2go:
  s_lshr_b32 s41, s2, 4
  s_lshl_b32 s41, s41, 7
  s_and_b32 s42, s2, 15
  s_add_u32 s41, s41, s42
  s_add_u32 s41, s41, 20971520
  v_mov_b32 v2, s41
  v_mov_b32 v0, 1
  s_mov_b64 exec, 1
  buffer_store_byte v0, v2, s[24:27], 0 offen sc1
  s_mov_b64 exec, -1
L_parallel_sum__linear_kernel_hedgehog__mixer_channel_mlp__prompt_kernel_f2n2:
  ds_read_b128 v[80:83], v4 offset:0
  ds_read_b128 v[84:87], v4 offset:4096
  v_mfma_f32_32x32x16_bf16 v[192:207], v[112:115], v[108:111], v[192:207]
  ds_read_b64_tr_b16 v[88:89], v12 offset:32768
  ds_read_b64_tr_b16 v[90:91], v12 offset:33280
  v_mfma_f32_32x32x16_bf16 v[144:159], v[116:119], v[104:107], v[144:159]
  ds_read_b64_tr_b16 v[92:93], v13 offset:32768
  ds_read_b64_tr_b16 v[94:95], v13 offset:33280
  v_mfma_f32_32x32x16_bf16 v[208:223], v[116:119], v[108:111], v[208:223]
  ds_read_b64_tr_b16 v[96:97], v14 offset:32768
  ds_read_b64_tr_b16 v[98:99], v14 offset:33280
  v_mfma_f32_32x32x16_bf16 v[160:175], v[120:123], v[104:107], v[160:175]
  ds_read_b64_tr_b16 v[100:101], v15 offset:32768
  v_mfma_f32_32x32x16_bf16 v[224:239], v[120:123], v[108:111], v[224:239]
  ds_read_b64_tr_b16 v[102:103], v15 offset:33280
  v_mfma_f32_32x32x16_bf16 v[176:191], v[124:127], v[104:107], v[176:191]
  v_mfma_f32_32x32x16_bf16 v[240:255], v[124:127], v[108:111], v[240:255]
  v_add_u32 v7, s47, v11
  s_add_u32 s47, s47, 16384
  s_cmp_eq_u32 s47, 49152
  s_cselect_b32 s47, 0, s47
  s_waitcnt lgkmcnt(0)
  v_mfma_f32_32x32x16_bf16 v[128:143], v[88:91], v[80:83], v[128:143]
  ds_read_b128 v[104:107], v5 offset:0
  ds_read_b128 v[108:111], v5 offset:4096
  v_mfma_f32_32x32x16_bf16 v[192:207], v[88:91], v[84:87], v[192:207]
  ds_read_b64_tr_b16 v[112:113], v12 offset:34816
  ds_read_b64_tr_b16 v[114:115], v12 offset:35328
  v_mfma_f32_32x32x16_bf16 v[144:159], v[92:95], v[80:83], v[144:159]
  ds_read_b64_tr_b16 v[116:117], v13 offset:34816
  ds_read_b64_tr_b16 v[118:119], v13 offset:35328
  v_mfma_f32_32x32x16_bf16 v[208:223], v[92:95], v[84:87], v[208:223]
  ds_read_b64_tr_b16 v[120:121], v14 offset:34816
  ds_read_b64_tr_b16 v[122:123], v14 offset:35328
  v_mfma_f32_32x32x16_bf16 v[160:175], v[96:99], v[80:83], v[160:175]
  ds_read_b64_tr_b16 v[124:125], v15 offset:34816
  v_mfma_f32_32x32x16_bf16 v[224:239], v[96:99], v[84:87], v[224:239]
  ds_read_b64_tr_b16 v[126:127], v15 offset:35328
  v_mfma_f32_32x32x16_bf16 v[176:191], v[100:103], v[80:83], v[176:191]
  v_mfma_f32_32x32x16_bf16 v[240:255], v[100:103], v[84:87], v[240:255]
  s_waitcnt lgkmcnt(0)
  v_mfma_f32_32x32x16_bf16 v[128:143], v[112:115], v[104:107], v[128:143]
  s_barrier
  ds_read_b128 v[80:83], v6 offset:0
  ds_read_b128 v[84:87], v6 offset:4096
  v_mfma_f32_32x32x16_bf16 v[192:207], v[112:115], v[108:111], v[192:207]
  ds_read_b64_tr_b16 v[88:89], v12 offset:49152
  ds_read_b64_tr_b16 v[90:91], v12 offset:49664
  v_mfma_f32_32x32x16_bf16 v[144:159], v[116:119], v[104:107], v[144:159]
  ds_read_b64_tr_b16 v[92:93], v13 offset:49152
  ds_read_b64_tr_b16 v[94:95], v13 offset:49664
  v_mfma_f32_32x32x16_bf16 v[208:223], v[116:119], v[108:111], v[208:223]
  ds_read_b64_tr_b16 v[96:97], v14 offset:49152
  ds_read_b64_tr_b16 v[98:99], v14 offset:49664
  v_mfma_f32_32x32x16_bf16 v[160:175], v[120:123], v[104:107], v[160:175]
  ds_read_b64_tr_b16 v[100:101], v15 offset:49152
  v_mfma_f32_32x32x16_bf16 v[224:239], v[120:123], v[108:111], v[224:239]
  ds_read_b64_tr_b16 v[102:103], v15 offset:49664
  v_mfma_f32_32x32x16_bf16 v[176:191], v[124:127], v[104:107], v[176:191]
  v_mfma_f32_32x32x16_bf16 v[240:255], v[124:127], v[108:111], v[240:255]
  s_waitcnt lgkmcnt(0)
  v_mfma_f32_32x32x16_bf16 v[128:143], v[88:91], v[80:83], v[128:143]
  ds_read_b128 v[104:107], v7 offset:0
  ds_read_b128 v[108:111], v7 offset:4096
  v_mfma_f32_32x32x16_bf16 v[192:207], v[88:91], v[84:87], v[192:207]
  ds_read_b64_tr_b16 v[112:113], v12 offset:51200
  ds_read_b64_tr_b16 v[114:115], v12 offset:51712
  v_mfma_f32_32x32x16_bf16 v[144:159], v[92:95], v[80:83], v[144:159]
  ds_read_b64_tr_b16 v[116:117], v13 offset:51200
  ds_read_b64_tr_b16 v[118:119], v13 offset:51712
  v_mfma_f32_32x32x16_bf16 v[208:223], v[92:95], v[84:87], v[208:223]
  ds_read_b64_tr_b16 v[120:121], v14 offset:51200
  ds_read_b64_tr_b16 v[122:123], v14 offset:51712
  v_mfma_f32_32x32x16_bf16 v[160:175], v[96:99], v[80:83], v[160:175]
  ds_read_b64_tr_b16 v[124:125], v15 offset:51200
  v_mfma_f32_32x32x16_bf16 v[224:239], v[96:99], v[84:87], v[224:239]
  ds_read_b64_tr_b16 v[126:127], v15 offset:51712
  v_add_u32 v4, s47, v8
  v_mfma_f32_32x32x16_bf16 v[176:191], v[100:103], v[80:83], v[176:191]
  v_add_u32 v5, s47, v9
  v_mfma_f32_32x32x16_bf16 v[240:255], v[100:103], v[84:87], v[240:255]
  v_add_u32 v6, s47, v10
  s_waitcnt lgkmcnt(0)
  v_mfma_f32_32x32x16_bf16 v[128:143], v[112:115], v[104:107], v[128:143]
  s_barrier
  ds_read_b128 v[80:83], v4 offset:0
  ds_read_b128 v[84:87], v4 offset:4096
  v_mfma_f32_32x32x16_bf16 v[192:207], v[112:115], v[108:111], v[192:207]
  ds_read_b64_tr_b16 v[88:89], v12 offset:0
  ds_read_b64_tr_b16 v[90:91], v12 offset:512
  v_mfma_f32_32x32x16_bf16 v[144:159], v[116:119], v[104:107], v[144:159]
  ds_read_b64_tr_b16 v[92:93], v13 offset:0
  ds_read_b64_tr_b16 v[94:95], v13 offset:512
  v_mfma_f32_32x32x16_bf16 v[208:223], v[116:119], v[108:111], v[208:223]
  ds_read_b64_tr_b16 v[96:97], v14 offset:0
  ds_read_b64_tr_b16 v[98:99], v14 offset:512
  v_mfma_f32_32x32x16_bf16 v[160:175], v[120:123], v[104:107], v[160:175]
  ds_read_b64_tr_b16 v[100:101], v15 offset:0
  v_mfma_f32_32x32x16_bf16 v[224:239], v[120:123], v[108:111], v[224:239]
  ds_read_b64_tr_b16 v[102:103], v15 offset:512
  v_mfma_f32_32x32x16_bf16 v[176:191], v[124:127], v[104:107], v[176:191]
  v_mfma_f32_32x32x16_bf16 v[240:255], v[124:127], v[108:111], v[240:255]
  v_add_u32 v7, s47, v11
  s_add_u32 s47, s47, 16384
  s_cmp_eq_u32 s47, 49152
  s_cselect_b32 s47, 0, s47
  s_add_u32 s46, s46, 1
  s_cmp_lt_u32 s46, 4
  s_cbranch_scc1 L_parallel_sum__linear_kernel_hedgehog__mixer_channel_mlp__prompt_kernel_kloop
  s_waitcnt lgkmcnt(0)
  v_mfma_f32_32x32x16_bf16 v[128:143], v[88:91], v[80:83], v[128:143]
  ds_read_b128 v[104:107], v5 offset:0
  ds_read_b128 v[108:111], v5 offset:4096
  v_mfma_f32_32x32x16_bf16 v[192:207], v[88:91], v[84:87], v[192:207]
  ds_read_b64_tr_b16 v[112:113], v12 offset:2048
  ds_read_b64_tr_b16 v[114:115], v12 offset:2560
  v_mfma_f32_32x32x16_bf16 v[144:159], v[92:95], v[80:83], v[144:159]
  ds_read_b64_tr_b16 v[116:117], v13 offset:2048
  ds_read_b64_tr_b16 v[118:119], v13 offset:2560
  v_mfma_f32_32x32x16_bf16 v[208:223], v[92:95], v[84:87], v[208:223]
  ds_read_b64_tr_b16 v[120:121], v14 offset:2048
  ds_read_b64_tr_b16 v[122:123], v14 offset:2560
  v_mfma_f32_32x32x16_bf16 v[160:175], v[96:99], v[80:83], v[160:175]
  ds_read_b64_tr_b16 v[124:125], v15 offset:2048
  v_mfma_f32_32x32x16_bf16 v[224:239], v[96:99], v[84:87], v[224:239]
  ds_read_b64_tr_b16 v[126:127], v15 offset:2560
  v_mfma_f32_32x32x16_bf16 v[176:191], v[100:103], v[80:83], v[176:191]
  v_mfma_f32_32x32x16_bf16 v[240:255], v[100:103], v[84:87], v[240:255]
  s_waitcnt lgkmcnt(0)
  v_mfma_f32_32x32x16_bf16 v[128:143], v[112:115], v[104:107], v[128:143]
  s_barrier
  ds_read_b128 v[80:83], v6 offset:0
  ds_read_b128 v[84:87], v6 offset:4096
  v_mfma_f32_32x32x16_bf16 v[192:207], v[112:115], v[108:111], v[192:207]
  ds_read_b64_tr_b16 v[88:89], v12 offset:16384
  ds_read_b64_tr_b16 v[90:91], v12 offset:16896
  v_mfma_f32_32x32x16_bf16 v[144:159], v[116:119], v[104:107], v[144:159]
  ds_read_b64_tr_b16 v[92:93], v13 offset:16384
  ds_read_b64_tr_b16 v[94:95], v13 offset:16896
  v_mfma_f32_32x32x16_bf16 v[208:223], v[116:119], v[108:111], v[208:223]
  ds_read_b64_tr_b16 v[96:97], v14 offset:16384
  ds_read_b64_tr_b16 v[98:99], v14 offset:16896
  v_mfma_f32_32x32x16_bf16 v[160:175], v[120:123], v[104:107], v[160:175]
  ds_read_b64_tr_b16 v[100:101], v15 offset:16384
  v_mfma_f32_32x32x16_bf16 v[224:239], v[120:123], v[108:111], v[224:239]
  ds_read_b64_tr_b16 v[102:103], v15 offset:16896
  v_mfma_f32_32x32x16_bf16 v[176:191], v[124:127], v[104:107], v[176:191]
  v_mfma_f32_32x32x16_bf16 v[240:255], v[124:127], v[108:111], v[240:255]
  s_waitcnt lgkmcnt(0)
  v_mfma_f32_32x32x16_bf16 v[128:143], v[88:91], v[80:83], v[128:143]
  ds_read_b128 v[104:107], v7 offset:0
  ds_read_b128 v[108:111], v7 offset:4096
  v_mfma_f32_32x32x16_bf16 v[192:207], v[88:91], v[84:87], v[192:207]
  ds_read_b64_tr_b16 v[112:113], v12 offset:18432
  ds_read_b64_tr_b16 v[114:115], v12 offset:18944
  v_mfma_f32_32x32x16_bf16 v[144:159], v[92:95], v[80:83], v[144:159]
  ds_read_b64_tr_b16 v[116:117], v13 offset:18432
  ds_read_b64_tr_b16 v[118:119], v13 offset:18944
  v_mfma_f32_32x32x16_bf16 v[208:223], v[92:95], v[84:87], v[208:223]
  ds_read_b64_tr_b16 v[120:121], v14 offset:18432
  ds_read_b64_tr_b16 v[122:123], v14 offset:18944
  v_mfma_f32_32x32x16_bf16 v[160:175], v[96:99], v[80:83], v[160:175]
  ds_read_b64_tr_b16 v[124:125], v15 offset:18432
  v_mfma_f32_32x32x16_bf16 v[224:239], v[96:99], v[84:87], v[224:239]
  ds_read_b64_tr_b16 v[126:127], v15 offset:18944
  v_add_u32 v4, s47, v8
  v_mfma_f32_32x32x16_bf16 v[176:191], v[100:103], v[80:83], v[176:191]
  v_add_u32 v5, s47, v9
  v_mfma_f32_32x32x16_bf16 v[240:255], v[100:103], v[84:87], v[240:255]
  v_add_u32 v6, s47, v10
  s_waitcnt lgkmcnt(0)
  v_mfma_f32_32x32x16_bf16 v[128:143], v[112:115], v[104:107], v[128:143]
  s_barrier
  ds_read_b128 v[80:83], v4 offset:0
  ds_read_b128 v[84:87], v4 offset:4096
  v_mfma_f32_32x32x16_bf16 v[192:207], v[112:115], v[108:111], v[192:207]
  ds_read_b64_tr_b16 v[88:89], v12 offset:32768
  ds_read_b64_tr_b16 v[90:91], v12 offset:33280
  v_mfma_f32_32x32x16_bf16 v[144:159], v[116:119], v[104:107], v[144:159]
  ds_read_b64_tr_b16 v[92:93], v13 offset:32768
  ds_read_b64_tr_b16 v[94:95], v13 offset:33280
  v_mfma_f32_32x32x16_bf16 v[208:223], v[116:119], v[108:111], v[208:223]
  ds_read_b64_tr_b16 v[96:97], v14 offset:32768
  ds_read_b64_tr_b16 v[98:99], v14 offset:33280
  v_mfma_f32_32x32x16_bf16 v[160:175], v[120:123], v[104:107], v[160:175]
  ds_read_b64_tr_b16 v[100:101], v15 offset:32768
  v_mfma_f32_32x32x16_bf16 v[224:239], v[120:123], v[108:111], v[224:239]
  ds_read_b64_tr_b16 v[102:103], v15 offset:33280
  v_mfma_f32_32x32x16_bf16 v[176:191], v[124:127], v[104:107], v[176:191]
  v_mfma_f32_32x32x16_bf16 v[240:255], v[124:127], v[108:111], v[240:255]
  v_add_u32 v7, s47, v11
  s_add_u32 s47, s47, 16384
  s_cmp_eq_u32 s47, 49152
  s_cselect_b32 s47, 0, s47
  s_waitcnt lgkmcnt(0)
  v_mfma_f32_32x32x16_bf16 v[128:143], v[88:91], v[80:83], v[128:143]
  ds_read_b128 v[104:107], v5 offset:0
  ds_read_b128 v[108:111], v5 offset:4096
  v_mfma_f32_32x32x16_bf16 v[192:207], v[88:91], v[84:87], v[192:207]
  ds_read_b64_tr_b16 v[112:113], v12 offset:34816
  ds_read_b64_tr_b16 v[114:115], v12 offset:35328
  v_mfma_f32_32x32x16_bf16 v[144:159], v[92:95], v[80:83], v[144:159]
  ds_read_b64_tr_b16 v[116:117], v13 offset:34816
  ds_read_b64_tr_b16 v[118:119], v13 offset:35328
  v_mfma_f32_32x32x16_bf16 v[208:223], v[92:95], v[84:87], v[208:223]
  ds_read_b64_tr_b16 v[120:121], v14 offset:34816
  ds_read_b64_tr_b16 v[122:123], v14 offset:35328
  v_mfma_f32_32x32x16_bf16 v[160:175], v[96:99], v[80:83], v[160:175]
  ds_read_b64_tr_b16 v[124:125], v15 offset:34816
  v_mfma_f32_32x32x16_bf16 v[224:239], v[96:99], v[84:87], v[224:239]
  ds_read_b64_tr_b16 v[126:127], v15 offset:35328
  v_mfma_f32_32x32x16_bf16 v[176:191], v[100:103], v[80:83], v[176:191]
  v_mfma_f32_32x32x16_bf16 v[240:255], v[100:103], v[84:87], v[240:255]
  s_waitcnt lgkmcnt(0)
  v_mfma_f32_32x32x16_bf16 v[128:143], v[112:115], v[104:107], v[128:143]
  s_barrier
  ds_read_b128 v[80:83], v6 offset:0
  ds_read_b128 v[84:87], v6 offset:4096
  v_mfma_f32_32x32x16_bf16 v[192:207], v[112:115], v[108:111], v[192:207]
  ds_read_b64_tr_b16 v[88:89], v12 offset:49152
  ds_read_b64_tr_b16 v[90:91], v12 offset:49664
  v_mfma_f32_32x32x16_bf16 v[144:159], v[116:119], v[104:107], v[144:159]
  ds_read_b64_tr_b16 v[92:93], v13 offset:49152
  ds_read_b64_tr_b16 v[94:95], v13 offset:49664
  v_mfma_f32_32x32x16_bf16 v[208:223], v[116:119], v[108:111], v[208:223]
  ds_read_b64_tr_b16 v[96:97], v14 offset:49152
  ds_read_b64_tr_b16 v[98:99], v14 offset:49664
  v_mfma_f32_32x32x16_bf16 v[160:175], v[120:123], v[104:107], v[160:175]
  ds_read_b64_tr_b16 v[100:101], v15 offset:49152
  v_mfma_f32_32x32x16_bf16 v[224:239], v[120:123], v[108:111], v[224:239]
  ds_read_b64_tr_b16 v[102:103], v15 offset:49664
  v_mfma_f32_32x32x16_bf16 v[176:191], v[124:127], v[104:107], v[176:191]
  v_mfma_f32_32x32x16_bf16 v[240:255], v[124:127], v[108:111], v[240:255]
  s_waitcnt lgkmcnt(0)
  v_mfma_f32_32x32x16_bf16 v[128:143], v[88:91], v[80:83], v[128:143]
  ds_read_b128 v[104:107], v7 offset:0
  ds_read_b128 v[108:111], v7 offset:4096
  v_mfma_f32_32x32x16_bf16 v[192:207], v[88:91], v[84:87], v[192:207]
  ds_read_b64_tr_b16 v[112:113], v12 offset:51200
  ds_read_b64_tr_b16 v[114:115], v12 offset:51712
  v_mfma_f32_32x32x16_bf16 v[144:159], v[92:95], v[80:83], v[144:159]
  ds_read_b64_tr_b16 v[116:117], v13 offset:51200
  ds_read_b64_tr_b16 v[118:119], v13 offset:51712
  v_mfma_f32_32x32x16_bf16 v[208:223], v[92:95], v[84:87], v[208:223]
  ds_read_b64_tr_b16 v[120:121], v14 offset:51200
  ds_read_b64_tr_b16 v[122:123], v14 offset:51712
  v_mfma_f32_32x32x16_bf16 v[160:175], v[96:99], v[80:83], v[160:175]
  ds_read_b64_tr_b16 v[124:125], v15 offset:51200
  v_mfma_f32_32x32x16_bf16 v[224:239], v[96:99], v[84:87], v[224:239]
  ds_read_b64_tr_b16 v[126:127], v15 offset:51712
  v_add_u32 v4, s47, v8
  v_mfma_f32_32x32x16_bf16 v[176:191], v[100:103], v[80:83], v[176:191]
  v_add_u32 v5, s47, v9
  v_mfma_f32_32x32x16_bf16 v[240:255], v[100:103], v[84:87], v[240:255]
  v_add_u32 v6, s47, v10
  s_waitcnt lgkmcnt(0)
  v_mfma_f32_32x32x16_bf16 v[128:143], v[112:115], v[104:107], v[128:143]
  s_barrier
  ds_read_b128 v[36:39], v32 offset:0
  ds_read_b128 v[40:43], v32 offset:512
  v_mfma_f32_32x32x16_bf16 v[192:207], v[112:115], v[108:111], v[192:207]
  ds_read_b128 v[88:91], v33 offset:0
  ds_read_b128 v[92:95], v33 offset:512
  v_mfma_f32_32x32x16_bf16 v[144:159], v[116:119], v[104:107], v[144:159]
  ds_read_b128 v[96:99], v33 offset:1024
  ds_read_b128 v[100:103], v33 offset:1536
  v_mfma_f32_32x32x16_bf16 v[208:223], v[116:119], v[108:111], v[208:223]
  v_mfma_f32_32x32x16_bf16 v[160:175], v[120:123], v[104:107], v[160:175]
  v_mfma_f32_32x32x16_bf16 v[224:239], v[120:123], v[108:111], v[224:239]
  v_mfma_f32_32x32x16_bf16 v[176:191], v[124:127], v[104:107], v[176:191]
  v_mfma_f32_32x32x16_bf16 v[240:255], v[124:127], v[108:111], v[240:255]
  v_add_u32 v7, s47, v11
  s_add_u32 s47, s47, 16384
  s_cmp_eq_u32 s47, 49152
  s_cselect_b32 s47, 0, s47
  ds_read_b64_tr_b16 v[56:57], v35 offset:0
  ds_read_b64_tr_b16 v[58:59], v35 offset:160
  ds_read_b64_tr_b16 v[60:61], v35 offset:320
  ds_read_b64_tr_b16 v[62:63], v35 offset:480
  ds_read_b64_tr_b16 v[64:65], v35 offset:640
  v_mov_b32 v66, 0
  v_mov_b32 v67, 0
  ds_read_b64_tr_b16 v[68:69], v31 offset:0
  ds_read_b64_tr_b16 v[70:71], v31 offset:160
  ds_read_b64_tr_b16 v[72:73], v31 offset:320
  ds_read_b64_tr_b16 v[74:75], v31 offset:480
  ds_read_b64_tr_b16 v[76:77], v31 offset:640
  v_mov_b32 v78, 0
  v_mov_b32 v79, 0
  s_waitcnt lgkmcnt(10)
  v_rcp_f32 v44, v38
  v_sub_f32 v45, 0, v36
  v_cvt_pk_bf16_f32 v80, v45, v45
  v_and_b32 v46, 0xffff0000, v80
  v_sub_f32 v46, v45, v46
  v_cvt_pk_bf16_f32 v47, v44, v44
  v_and_b32 v48, 0xffff0000, v47
  v_sub_f32 v48, v44, v48
  v_cvt_pk_bf16_f32 v81, v46, v44
  v_cvt_pk_bf16_f32 v82, v48, 0
  v_mov_b32 v83, 0
  v_mov_b32 v39, v44
  v_cmp_eq_u32 vcc, 0, v17
  s_nop 1
  v_cndmask_b32 v80, 0, v80, vcc
  v_cndmask_b32 v81, 0, v81, vcc
  v_cndmask_b32 v82, 0, v82, vcc
  v_rcp_f32 v44, v42
  v_sub_f32 v45, 0, v40
  v_cvt_pk_bf16_f32 v84, v45, v45
  v_and_b32 v46, 0xffff0000, v84
  v_sub_f32 v46, v45, v46
  v_cvt_pk_bf16_f32 v47, v44, v44
  v_and_b32 v48, 0xffff0000, v47
  v_sub_f32 v48, v44, v48
  v_cvt_pk_bf16_f32 v85, v46, v44
  v_cvt_pk_bf16_f32 v86, v48, 0
  v_mov_b32 v87, 0
  v_mov_b32 v43, v44
  v_cmp_eq_u32 vcc, 0, v17
  s_nop 1
  v_cndmask_b32 v84, 0, v84, vcc
  v_cndmask_b32 v85, 0, v85, vcc
  v_cndmask_b32 v86, 0, v86, vcc
  v_mfma_f32_32x32x16_bf16 v[128:143], v[88:91], v[80:83], v[128:143]
  s_nop 0
  v_mfma_f32_32x32x16_bf16 v[192:207], v[88:91], v[84:87], v[192:207]
  v_mfma_f32_32x32x16_bf16 v[144:159], v[92:95], v[80:83], v[144:159]
  v_mfma_f32_32x32x16_bf16 v[208:223], v[92:95], v[84:87], v[208:223]
  v_mfma_f32_32x32x16_bf16 v[160:175], v[96:99], v[80:83], v[160:175]
  v_mfma_f32_32x32x16_bf16 v[224:239], v[96:99], v[84:87], v[224:239]
  v_mfma_f32_32x32x16_bf16 v[176:191], v[100:103], v[80:83], v[176:191]
  v_mfma_f32_32x32x16_bf16 v[240:255], v[100:103], v[84:87], v[240:255]
  s_cmp_eq_u32 s37, 0
  s_cbranch_scc1 L_parallel_sum__linear_kernel_hedgehog__mixer_channel_mlp__prompt_kernel_epi_kv
  s_waitcnt lgkmcnt(0)
  v_lshrrev_b32 v56, 4, v16
  v_and_b32 v57, 15, v16
  v_mul_u32_u24 v58, 75776, v56
  v_lshl_add_u32 v58, v17, 9, v58
  v_lshl_add_u32 v58, v57, 4, v58
  v_mul_u32_u24 v59, 20480, v56
  v_lshl_add_u32 v59, v17, 7, v59
  v_lshl_add_u32 v59, v57, 3, v59
  s_lshl_b32 s48, s36, 3
  s_lshl_b32 s49, s43, 2
  s_add_u32 s48, s48, s49
  s_lshr_b32 s40, s2, 3
  s_and_b32 s68, s2, 3
  s_lshl_b32 s68, s68, 3
  s_lshr_b32 s41, s40, 2
  s_add_u32 s68, s68, s41
  s_lshr_b32 s69, s2, 2
  s_and_b32 s69, s69, 1
  s_lshl_b32 s69, s69, 2
  s_and_b32 s41, s40, 3
  s_add_u32 s69, s69, s41
  s_lshl_b32 s86, s68, 2
  s_add_u32 s86, s86, s39
  s_lshl_b32 s50, s44, 1
  s_add_u32 s50, s50, 0
  s_lshl_b32 s51, s38, 2
  s_add_u32 s51, s51, s50
  s_cmp_lt_u32 s51, 27
  s_cbranch_scc1 L_parallel_sum__linear_kernel_hedgehog__mixer_channel_mlp__prompt_kernel_g_w1_00
  s_bitcmp1_b32 s51, 0
  s_cbranch_scc1 L_parallel_sum__linear_kernel_hedgehog__mixer_channel_mlp__prompt_kernel_g_none_00
  s_cmp_lt_u32 s51, 28
  s_cbranch_scc1 L_parallel_sum__linear_kernel_hedgehog__mixer_channel_mlp__prompt_kernel_g_none_00
  s_lshr_b32 s51, s51, 1
  s_sub_u32 s51, s51, 6
  s_add_u32 s52, s48, 0
  s_mul_i32 s52, s52, 160
  s_lshl_b32 s53, s51, 4
  s_add_u32 s52, s52, s53
  s_lshl_b32 s52, s52, 7
  s_add_u32 s52, s52, 524288
  v_cvt_pk_bf16_f32 v60, v128, v129
  v_cvt_pk_bf16_f32 v61, v130, v131
  buffer_store_dwordx2 v[60:61], v59, s[24:27], s52 offen offset:0 sc1
  v_cvt_pk_bf16_f32 v62, v132, v133
  v_cvt_pk_bf16_f32 v63, v134, v135
  buffer_store_dwordx2 v[62:63], v59, s[24:27], s52 offen offset:256 sc1
  v_cvt_pk_bf16_f32 v64, v136, v137
  v_cvt_pk_bf16_f32 v65, v138, v139
  buffer_store_dwordx2 v[64:65], v59, s[24:27], s52 offen offset:512 sc1
  v_cvt_pk_bf16_f32 v66, v140, v141
  v_cvt_pk_bf16_f32 v67, v142, v143
  buffer_store_dwordx2 v[66:67], v59, s[24:27], s52 offen offset:768 sc1
  v_cvt_pk_bf16_f32 v60, v144, v145
  v_cvt_pk_bf16_f32 v61, v146, v147
  buffer_store_dwordx2 v[60:61], v59, s[24:27], s52 offen offset:1024 sc1
  v_cvt_pk_bf16_f32 v62, v148, v149
  v_cvt_pk_bf16_f32 v63, v150, v151
  buffer_store_dwordx2 v[62:63], v59, s[24:27], s52 offen offset:1280 sc1
  v_cvt_pk_bf16_f32 v64, v152, v153
  v_cvt_pk_bf16_f32 v65, v154, v155
  buffer_store_dwordx2 v[64:65], v59, s[24:27], s52 offen offset:1536 sc1
  v_cvt_pk_bf16_f32 v66, v156, v157
  v_cvt_pk_bf16_f32 v67, v158, v159
  buffer_store_dwordx2 v[66:67], v59, s[24:27], s52 offen offset:1792 sc1
  s_branch L_parallel_sum__linear_kernel_hedgehog__mixer_channel_mlp__prompt_kernel_g_done_00
L_parallel_sum__linear_kernel_hedgehog__mixer_channel_mlp__prompt_kernel_g_none_00:
  s_branch L_parallel_sum__linear_kernel_hedgehog__mixer_channel_mlp__prompt_kernel_g_done_00
L_parallel_sum__linear_kernel_hedgehog__mixer_channel_mlp__prompt_kernel_g_w1_00:
  s_and_b32 s53, s51, 1
  s_mul_i32 s53, s53, 27
  s_add_u32 s51, s51, s53
  v_mul_f32 v50, 0xc0135761, v38
  v_mul_f32 v52, v38, v38
  v_mul_f32 v52, v52, v38
  v_mov_b32 v51, v50
  v_mul_f32 v52, 0xbdd2d3e8, v52
  v_mov_b32 v54, v39
  v_mov_b32 v55, v39
  v_mov_b32 v53, v52
  s_add_u32 s52, s48, 0
  s_mul_i32 s52, s52, 74
  s_add_u32 s52, s52, s51
  s_lshl_b32 s52, s52, 10
  s_add_u32 s52, s52, 8388608
  v_pk_mul_f32 v[60:61], v[128:129], v[128:129]
  v_pk_mul_f32 v[62:63], v[130:131], v[130:131]
  v_pk_mul_f32 v[64:65], v[132:133], v[132:133]
  v_pk_mul_f32 v[66:67], v[134:135], v[134:135]
  v_pk_fma_f32 v[60:61], v[60:61], v[52:53], v[50:51]
  v_pk_fma_f32 v[62:63], v[62:63], v[52:53], v[50:51]
  v_pk_fma_f32 v[64:65], v[64:65], v[52:53], v[50:51]
  v_pk_fma_f32 v[66:67], v[66:67], v[52:53], v[50:51]
  v_pk_mul_f32 v[60:61], v[60:61], v[128:129]
  v_pk_mul_f32 v[62:63], v[62:63], v[130:131]
  v_pk_mul_f32 v[64:65], v[64:65], v[132:133]
  v_pk_mul_f32 v[66:67], v[66:67], v[134:135]
  v_exp_f32 v60, v60
  v_exp_f32 v61, v61
  v_exp_f32 v62, v62
  v_exp_f32 v63, v63
  v_exp_f32 v64, v64
  v_exp_f32 v65, v65
  v_exp_f32 v66, v66
  v_exp_f32 v67, v67
  v_pk_fma_f32 v[60:61], v[60:61], v[54:55], v[54:55]
  v_pk_fma_f32 v[62:63], v[62:63], v[54:55], v[54:55]
  v_pk_fma_f32 v[64:65], v[64:65], v[54:55], v[54:55]
  v_pk_fma_f32 v[66:67], v[66:67], v[54:55], v[54:55]
  v_rcp_f32 v60, v60
  v_rcp_f32 v61, v61
  v_rcp_f32 v62, v62
  v_rcp_f32 v63, v63
  v_rcp_f32 v64, v64
  v_rcp_f32 v65, v65
  v_rcp_f32 v66, v66
  v_rcp_f32 v67, v67
  v_pk_mul_f32 v[60:61], v[60:61], v[128:129]
  v_pk_mul_f32 v[62:63], v[62:63], v[130:131]
  v_pk_mul_f32 v[64:65], v[64:65], v[132:133]
  v_pk_mul_f32 v[66:67], v[66:67], v[134:135]
  v_cvt_pk_bf16_f32 v68, v60, v61
  v_cvt_pk_bf16_f32 v69, v62, v63
  v_cvt_pk_bf16_f32 v70, v64, v65
  v_cvt_pk_bf16_f32 v71, v66, v67
  v_pk_mul_f32 v[60:61], v[136:137], v[136:137]
  v_pk_mul_f32 v[62:63], v[138:139], v[138:139]
  v_pk_mul_f32 v[64:65], v[140:141], v[140:141]
  v_pk_mul_f32 v[66:67], v[142:143], v[142:143]
  v_pk_fma_f32 v[60:61], v[60:61], v[52:53], v[50:51]
  v_pk_fma_f32 v[62:63], v[62:63], v[52:53], v[50:51]
  v_pk_fma_f32 v[64:65], v[64:65], v[52:53], v[50:51]
  v_pk_fma_f32 v[66:67], v[66:67], v[52:53], v[50:51]
  v_pk_mul_f32 v[60:61], v[60:61], v[136:137]
  v_pk_mul_f32 v[62:63], v[62:63], v[138:139]
  v_pk_mul_f32 v[64:65], v[64:65], v[140:141]
  v_pk_mul_f32 v[66:67], v[66:67], v[142:143]
  v_exp_f32 v60, v60
  v_exp_f32 v61, v61
  v_exp_f32 v62, v62
  v_exp_f32 v63, v63
  v_exp_f32 v64, v64
  v_exp_f32 v65, v65
  v_exp_f32 v66, v66
  v_exp_f32 v67, v67
  v_pk_fma_f32 v[60:61], v[60:61], v[54:55], v[54:55]
  v_pk_fma_f32 v[62:63], v[62:63], v[54:55], v[54:55]
  v_pk_fma_f32 v[64:65], v[64:65], v[54:55], v[54:55]
  v_pk_fma_f32 v[66:67], v[66:67], v[54:55], v[54:55]
  v_rcp_f32 v60, v60
  v_rcp_f32 v61, v61
  v_rcp_f32 v62, v62
  v_rcp_f32 v63, v63
  v_rcp_f32 v64, v64
  v_rcp_f32 v65, v65
  v_rcp_f32 v66, v66
  v_rcp_f32 v67, v67
  v_pk_mul_f32 v[60:61], v[60:61], v[136:137]
  v_pk_mul_f32 v[62:63], v[62:63], v[138:139]
  v_pk_mul_f32 v[64:65], v[64:65], v[140:141]
  v_pk_mul_f32 v[66:67], v[66:67], v[142:143]
  v_cvt_pk_bf16_f32 v72, v60, v61
  v_cvt_pk_bf16_f32 v73, v62, v63
  v_cvt_pk_bf16_f32 v74, v64, v65
  v_cvt_pk_bf16_f32 v75, v66, v67
  buffer_store_dwordx4 v[68:71], v58, s[24:27], s52 offen offset:0 sc1
  buffer_store_dwordx4 v[72:75], v58, s[24:27], s52 offen offset:256 sc1
  v_pk_mul_f32 v[60:61], v[144:145], v[144:145]
  v_pk_mul_f32 v[62:63], v[146:147], v[146:147]
  v_pk_mul_f32 v[64:65], v[148:149], v[148:149]
  v_pk_mul_f32 v[66:67], v[150:151], v[150:151]
  v_pk_fma_f32 v[60:61], v[60:61], v[52:53], v[50:51]
  v_pk_fma_f32 v[62:63], v[62:63], v[52:53], v[50:51]
  v_pk_fma_f32 v[64:65], v[64:65], v[52:53], v[50:51]
  v_pk_fma_f32 v[66:67], v[66:67], v[52:53], v[50:51]
  v_pk_mul_f32 v[60:61], v[60:61], v[144:145]
  v_pk_mul_f32 v[62:63], v[62:63], v[146:147]
  v_pk_mul_f32 v[64:65], v[64:65], v[148:149]
  v_pk_mul_f32 v[66:67], v[66:67], v[150:151]
  v_exp_f32 v60, v60
  v_exp_f32 v61, v61
  v_exp_f32 v62, v62
  v_exp_f32 v63, v63
  v_exp_f32 v64, v64
  v_exp_f32 v65, v65
  v_exp_f32 v66, v66
  v_exp_f32 v67, v67
  v_pk_fma_f32 v[60:61], v[60:61], v[54:55], v[54:55]
  v_pk_fma_f32 v[62:63], v[62:63], v[54:55], v[54:55]
  v_pk_fma_f32 v[64:65], v[64:65], v[54:55], v[54:55]
  v_pk_fma_f32 v[66:67], v[66:67], v[54:55], v[54:55]
  v_rcp_f32 v60, v60
  v_rcp_f32 v61, v61
  v_rcp_f32 v62, v62
  v_rcp_f32 v63, v63
  v_rcp_f32 v64, v64
  v_rcp_f32 v65, v65
  v_rcp_f32 v66, v66
  v_rcp_f32 v67, v67
  v_pk_mul_f32 v[60:61], v[60:61], v[144:145]
  v_pk_mul_f32 v[62:63], v[62:63], v[146:147]
  v_pk_mul_f32 v[64:65], v[64:65], v[148:149]
  v_pk_mul_f32 v[66:67], v[66:67], v[150:151]
  v_cvt_pk_bf16_f32 v20, v60, v61
  v_cvt_pk_bf16_f32 v21, v62, v63
  v_cvt_pk_bf16_f32 v22, v64, v65
  v_cvt_pk_bf16_f32 v23, v66, v67
  v_pk_mul_f32 v[60:61], v[152:153], v[152:153]
  v_pk_mul_f32 v[62:63], v[154:155], v[154:155]
  v_pk_mul_f32 v[64:65], v[156:157], v[156:157]
  v_pk_mul_f32 v[66:67], v[158:159], v[158:159]
  v_pk_fma_f32 v[60:61], v[60:61], v[52:53], v[50:51]
  v_pk_fma_f32 v[62:63], v[62:63], v[52:53], v[50:51]
  v_pk_fma_f32 v[64:65], v[64:65], v[52:53], v[50:51]
  v_pk_fma_f32 v[66:67], v[66:67], v[52:53], v[50:51]
  v_pk_mul_f32 v[60:61], v[60:61], v[152:153]
  v_pk_mul_f32 v[62:63], v[62:63], v[154:155]
  v_pk_mul_f32 v[64:65], v[64:65], v[156:157]
  v_pk_mul_f32 v[66:67], v[66:67], v[158:159]
  v_exp_f32 v60, v60
  v_exp_f32 v61, v61
  v_exp_f32 v62, v62
  v_exp_f32 v63, v63
  v_exp_f32 v64, v64
  v_exp_f32 v65, v65
  v_exp_f32 v66, v66
  v_exp_f32 v67, v67
  v_pk_fma_f32 v[60:61], v[60:61], v[54:55], v[54:55]
  v_pk_fma_f32 v[62:63], v[62:63], v[54:55], v[54:55]
  v_pk_fma_f32 v[64:65], v[64:65], v[54:55], v[54:55]
  v_pk_fma_f32 v[66:67], v[66:67], v[54:55], v[54:55]
  v_rcp_f32 v60, v60
  v_rcp_f32 v61, v61
  v_rcp_f32 v62, v62
  v_rcp_f32 v63, v63
  v_rcp_f32 v64, v64
  v_rcp_f32 v65, v65
  v_rcp_f32 v66, v66
  v_rcp_f32 v67, v67
  v_pk_mul_f32 v[60:61], v[60:61], v[152:153]
  v_pk_mul_f32 v[62:63], v[62:63], v[154:155]
  v_pk_mul_f32 v[64:65], v[64:65], v[156:157]
  v_pk_mul_f32 v[66:67], v[66:67], v[158:159]
  v_cvt_pk_bf16_f32 v24, v60, v61
  v_cvt_pk_bf16_f32 v25, v62, v63
  v_cvt_pk_bf16_f32 v26, v64, v65
  v_cvt_pk_bf16_f32 v27, v66, v67
  buffer_store_dwordx4 v[20:23], v58, s[24:27], s52 offen offset:1024 sc1
  buffer_store_dwordx4 v[24:27], v58, s[24:27], s52 offen offset:1280 sc1
L_parallel_sum__linear_kernel_hedgehog__mixer_channel_mlp__prompt_kernel_g_done_00:
  s_lshl_b32 s50, s44, 1
  s_add_u32 s50, s50, 0
  s_lshl_b32 s51, s38, 2
  s_add_u32 s51, s51, s50
  s_cmp_lt_u32 s51, 27
  s_cbranch_scc1 L_parallel_sum__linear_kernel_hedgehog__mixer_channel_mlp__prompt_kernel_g_w1_01
  s_bitcmp1_b32 s51, 0
  s_cbranch_scc1 L_parallel_sum__linear_kernel_hedgehog__mixer_channel_mlp__prompt_kernel_g_none_01
  s_cmp_lt_u32 s51, 28
  s_cbranch_scc1 L_parallel_sum__linear_kernel_hedgehog__mixer_channel_mlp__prompt_kernel_g_none_01
  s_lshr_b32 s51, s51, 1
  s_sub_u32 s51, s51, 6
  s_add_u32 s52, s48, 2
  s_mul_i32 s52, s52, 160
  s_lshl_b32 s53, s51, 4
  s_add_u32 s52, s52, s53
  s_lshl_b32 s52, s52, 7
  s_add_u32 s52, s52, 524288
  v_cvt_pk_bf16_f32 v60, v192, v193
  v_cvt_pk_bf16_f32 v61, v194, v195
  buffer_store_dwordx2 v[60:61], v59, s[24:27], s52 offen offset:0 sc1
  v_cvt_pk_bf16_f32 v62, v196, v197
  v_cvt_pk_bf16_f32 v63, v198, v199
  buffer_store_dwordx2 v[62:63], v59, s[24:27], s52 offen offset:256 sc1
  v_cvt_pk_bf16_f32 v64, v200, v201
  v_cvt_pk_bf16_f32 v65, v202, v203
  buffer_store_dwordx2 v[64:65], v59, s[24:27], s52 offen offset:512 sc1
  v_cvt_pk_bf16_f32 v66, v204, v205
  v_cvt_pk_bf16_f32 v67, v206, v207
  buffer_store_dwordx2 v[66:67], v59, s[24:27], s52 offen offset:768 sc1
  v_cvt_pk_bf16_f32 v60, v208, v209
  v_cvt_pk_bf16_f32 v61, v210, v211
  buffer_store_dwordx2 v[60:61], v59, s[24:27], s52 offen offset:1024 sc1
  v_cvt_pk_bf16_f32 v62, v212, v213
  v_cvt_pk_bf16_f32 v63, v214, v215
  buffer_store_dwordx2 v[62:63], v59, s[24:27], s52 offen offset:1280 sc1
  v_cvt_pk_bf16_f32 v64, v216, v217
  v_cvt_pk_bf16_f32 v65, v218, v219
  buffer_store_dwordx2 v[64:65], v59, s[24:27], s52 offen offset:1536 sc1
  v_cvt_pk_bf16_f32 v66, v220, v221
  v_cvt_pk_bf16_f32 v67, v222, v223
  buffer_store_dwordx2 v[66:67], v59, s[24:27], s52 offen offset:1792 sc1
  s_branch L_parallel_sum__linear_kernel_hedgehog__mixer_channel_mlp__prompt_kernel_g_done_01
L_parallel_sum__linear_kernel_hedgehog__mixer_channel_mlp__prompt_kernel_g_none_01:
  s_branch L_parallel_sum__linear_kernel_hedgehog__mixer_channel_mlp__prompt_kernel_g_done_01
L_parallel_sum__linear_kernel_hedgehog__mixer_channel_mlp__prompt_kernel_g_w1_01:
  s_and_b32 s53, s51, 1
  s_mul_i32 s53, s53, 27
  s_add_u32 s51, s51, s53
  v_mul_f32 v50, 0xc0135761, v42
  v_mul_f32 v52, v42, v42
  v_mul_f32 v52, v52, v42
  v_mov_b32 v51, v50
  v_mul_f32 v52, 0xbdd2d3e8, v52
  v_mov_b32 v54, v43
  v_mov_b32 v55, v43
  v_mov_b32 v53, v52
  s_add_u32 s52, s48, 2
  s_mul_i32 s52, s52, 74
  s_add_u32 s52, s52, s51
  s_lshl_b32 s52, s52, 10
  s_add_u32 s52, s52, 8388608
  v_pk_mul_f32 v[60:61], v[192:193], v[192:193]
  v_pk_mul_f32 v[62:63], v[194:195], v[194:195]
  v_pk_mul_f32 v[64:65], v[196:197], v[196:197]
  v_pk_mul_f32 v[66:67], v[198:199], v[198:199]
  v_pk_fma_f32 v[60:61], v[60:61], v[52:53], v[50:51]
  v_pk_fma_f32 v[62:63], v[62:63], v[52:53], v[50:51]
  v_pk_fma_f32 v[64:65], v[64:65], v[52:53], v[50:51]
  v_pk_fma_f32 v[66:67], v[66:67], v[52:53], v[50:51]
  v_pk_mul_f32 v[60:61], v[60:61], v[192:193]
  v_pk_mul_f32 v[62:63], v[62:63], v[194:195]
  v_pk_mul_f32 v[64:65], v[64:65], v[196:197]
  v_pk_mul_f32 v[66:67], v[66:67], v[198:199]
  v_exp_f32 v60, v60
  v_exp_f32 v61, v61
  v_exp_f32 v62, v62
  v_exp_f32 v63, v63
  v_exp_f32 v64, v64
  v_exp_f32 v65, v65
  v_exp_f32 v66, v66
  v_exp_f32 v67, v67
  v_pk_fma_f32 v[60:61], v[60:61], v[54:55], v[54:55]
  v_pk_fma_f32 v[62:63], v[62:63], v[54:55], v[54:55]
  v_pk_fma_f32 v[64:65], v[64:65], v[54:55], v[54:55]
  v_pk_fma_f32 v[66:67], v[66:67], v[54:55], v[54:55]
  v_rcp_f32 v60, v60
  v_rcp_f32 v61, v61
  v_rcp_f32 v62, v62
  v_rcp_f32 v63, v63
  v_rcp_f32 v64, v64
  v_rcp_f32 v65, v65
  v_rcp_f32 v66, v66
  v_rcp_f32 v67, v67
  v_pk_mul_f32 v[60:61], v[60:61], v[192:193]
  v_pk_mul_f32 v[62:63], v[62:63], v[194:195]
  v_pk_mul_f32 v[64:65], v[64:65], v[196:197]
  v_pk_mul_f32 v[66:67], v[66:67], v[198:199]
  v_cvt_pk_bf16_f32 v68, v60, v61
  v_cvt_pk_bf16_f32 v69, v62, v63
  v_cvt_pk_bf16_f32 v70, v64, v65
  v_cvt_pk_bf16_f32 v71, v66, v67
  v_pk_mul_f32 v[60:61], v[200:201], v[200:201]
  v_pk_mul_f32 v[62:63], v[202:203], v[202:203]
  v_pk_mul_f32 v[64:65], v[204:205], v[204:205]
  v_pk_mul_f32 v[66:67], v[206:207], v[206:207]
  v_pk_fma_f32 v[60:61], v[60:61], v[52:53], v[50:51]
  v_pk_fma_f32 v[62:63], v[62:63], v[52:53], v[50:51]
  v_pk_fma_f32 v[64:65], v[64:65], v[52:53], v[50:51]
  v_pk_fma_f32 v[66:67], v[66:67], v[52:53], v[50:51]
  v_pk_mul_f32 v[60:61], v[60:61], v[200:201]
  v_pk_mul_f32 v[62:63], v[62:63], v[202:203]
  v_pk_mul_f32 v[64:65], v[64:65], v[204:205]
  v_pk_mul_f32 v[66:67], v[66:67], v[206:207]
  v_exp_f32 v60, v60
  v_exp_f32 v61, v61
  v_exp_f32 v62, v62
  v_exp_f32 v63, v63
  v_exp_f32 v64, v64
  v_exp_f32 v65, v65
  v_exp_f32 v66, v66
  v_exp_f32 v67, v67
  v_pk_fma_f32 v[60:61], v[60:61], v[54:55], v[54:55]
  v_pk_fma_f32 v[62:63], v[62:63], v[54:55], v[54:55]
  v_pk_fma_f32 v[64:65], v[64:65], v[54:55], v[54:55]
  v_pk_fma_f32 v[66:67], v[66:67], v[54:55], v[54:55]
  v_rcp_f32 v60, v60
  v_rcp_f32 v61, v61
  v_rcp_f32 v62, v62
  v_rcp_f32 v63, v63
  v_rcp_f32 v64, v64
  v_rcp_f32 v65, v65
  v_rcp_f32 v66, v66
  v_rcp_f32 v67, v67
  v_pk_mul_f32 v[60:61], v[60:61], v[200:201]
  v_pk_mul_f32 v[62:63], v[62:63], v[202:203]
  v_pk_mul_f32 v[64:65], v[64:65], v[204:205]
  v_pk_mul_f32 v[66:67], v[66:67], v[206:207]
  v_cvt_pk_bf16_f32 v72, v60, v61
  v_cvt_pk_bf16_f32 v73, v62, v63
  v_cvt_pk_bf16_f32 v74, v64, v65
  v_cvt_pk_bf16_f32 v75, v66, v67
  buffer_store_dwordx4 v[68:71], v58, s[24:27], s52 offen offset:0 sc1
  buffer_store_dwordx4 v[72:75], v58, s[24:27], s52 offen offset:256 sc1
  v_pk_mul_f32 v[60:61], v[208:209], v[208:209]
  v_pk_mul_f32 v[62:63], v[210:211], v[210:211]
  v_pk_mul_f32 v[64:65], v[212:213], v[212:213]
  v_pk_mul_f32 v[66:67], v[214:215], v[214:215]
  v_pk_fma_f32 v[60:61], v[60:61], v[52:53], v[50:51]
  v_pk_fma_f32 v[62:63], v[62:63], v[52:53], v[50:51]
  v_pk_fma_f32 v[64:65], v[64:65], v[52:53], v[50:51]
  v_pk_fma_f32 v[66:67], v[66:67], v[52:53], v[50:51]
  v_pk_mul_f32 v[60:61], v[60:61], v[208:209]
  v_pk_mul_f32 v[62:63], v[62:63], v[210:211]
  v_pk_mul_f32 v[64:65], v[64:65], v[212:213]
  v_pk_mul_f32 v[66:67], v[66:67], v[214:215]
  v_exp_f32 v60, v60
  v_exp_f32 v61, v61
  v_exp_f32 v62, v62
  v_exp_f32 v63, v63
  v_exp_f32 v64, v64
  v_exp_f32 v65, v65
  v_exp_f32 v66, v66
  v_exp_f32 v67, v67
  v_pk_fma_f32 v[60:61], v[60:61], v[54:55], v[54:55]
  v_pk_fma_f32 v[62:63], v[62:63], v[54:55], v[54:55]
  v_pk_fma_f32 v[64:65], v[64:65], v[54:55], v[54:55]
  v_pk_fma_f32 v[66:67], v[66:67], v[54:55], v[54:55]
  v_rcp_f32 v60, v60
  v_rcp_f32 v61, v61
  v_rcp_f32 v62, v62
  v_rcp_f32 v63, v63
  v_rcp_f32 v64, v64
  v_rcp_f32 v65, v65
  v_rcp_f32 v66, v66
  v_rcp_f32 v67, v67
  v_pk_mul_f32 v[60:61], v[60:61], v[208:209]
  v_pk_mul_f32 v[62:63], v[62:63], v[210:211]
  v_pk_mul_f32 v[64:65], v[64:65], v[212:213]
  v_pk_mul_f32 v[66:67], v[66:67], v[214:215]
  v_cvt_pk_bf16_f32 v20, v60, v61
  v_cvt_pk_bf16_f32 v21, v62, v63
  v_cvt_pk_bf16_f32 v22, v64, v65
  v_cvt_pk_bf16_f32 v23, v66, v67
  v_pk_mul_f32 v[60:61], v[216:217], v[216:217]
  v_pk_mul_f32 v[62:63], v[218:219], v[218:219]
  v_pk_mul_f32 v[64:65], v[220:221], v[220:221]
  v_pk_mul_f32 v[66:67], v[222:223], v[222:223]
  v_pk_fma_f32 v[60:61], v[60:61], v[52:53], v[50:51]
  v_pk_fma_f32 v[62:63], v[62:63], v[52:53], v[50:51]
  v_pk_fma_f32 v[64:65], v[64:65], v[52:53], v[50:51]
  v_pk_fma_f32 v[66:67], v[66:67], v[52:53], v[50:51]
  v_pk_mul_f32 v[60:61], v[60:61], v[216:217]
  v_pk_mul_f32 v[62:63], v[62:63], v[218:219]
  v_pk_mul_f32 v[64:65], v[64:65], v[220:221]
  v_pk_mul_f32 v[66:67], v[66:67], v[222:223]
  v_exp_f32 v60, v60
  v_exp_f32 v61, v61
  v_exp_f32 v62, v62
  v_exp_f32 v63, v63
  v_exp_f32 v64, v64
  v_exp_f32 v65, v65
  v_exp_f32 v66, v66
  v_exp_f32 v67, v67
  v_pk_fma_f32 v[60:61], v[60:61], v[54:55], v[54:55]
  v_pk_fma_f32 v[62:63], v[62:63], v[54:55], v[54:55]
  v_pk_fma_f32 v[64:65], v[64:65], v[54:55], v[54:55]
  v_pk_fma_f32 v[66:67], v[66:67], v[54:55], v[54:55]
  v_rcp_f32 v60, v60
  v_rcp_f32 v61, v61
  v_rcp_f32 v62, v62
  v_rcp_f32 v63, v63
  v_rcp_f32 v64, v64
  v_rcp_f32 v65, v65
  v_rcp_f32 v66, v66
  v_rcp_f32 v67, v67
  v_pk_mul_f32 v[60:61], v[60:61], v[216:217]
  v_pk_mul_f32 v[62:63], v[62:63], v[218:219]
  v_pk_mul_f32 v[64:65], v[64:65], v[220:221]
  v_pk_mul_f32 v[66:67], v[66:67], v[222:223]
  v_cvt_pk_bf16_f32 v24, v60, v61
  v_cvt_pk_bf16_f32 v25, v62, v63
  v_cvt_pk_bf16_f32 v26, v64, v65
  v_cvt_pk_bf16_f32 v27, v66, v67
  buffer_store_dwordx4 v[20:23], v58, s[24:27], s52 offen offset:1024 sc1
  buffer_store_dwordx4 v[24:27], v58, s[24:27], s52 offen offset:1280 sc1
L_parallel_sum__linear_kernel_hedgehog__mixer_channel_mlp__prompt_kernel_g_done_01:
  s_lshl_b32 s50, s44, 1
  s_add_u32 s50, s50, 1
  s_lshl_b32 s51, s38, 2
  s_add_u32 s51, s51, s50
  s_cmp_lt_u32 s51, 27
  s_cbranch_scc1 L_parallel_sum__linear_kernel_hedgehog__mixer_channel_mlp__prompt_kernel_g_w1_10
  s_bitcmp1_b32 s51, 0
  s_cbranch_scc1 L_parallel_sum__linear_kernel_hedgehog__mixer_channel_mlp__prompt_kernel_g_none_10
  s_cmp_lt_u32 s51, 28
  s_cbranch_scc1 L_parallel_sum__linear_kernel_hedgehog__mixer_channel_mlp__prompt_kernel_g_none_10
  s_lshr_b32 s51, s51, 1
  s_sub_u32 s51, s51, 6
  s_add_u32 s52, s48, 0
  s_mul_i32 s52, s52, 160
  s_lshl_b32 s53, s51, 4
  s_add_u32 s52, s52, s53
  s_lshl_b32 s52, s52, 7
  s_add_u32 s52, s52, 524288
  v_cvt_pk_bf16_f32 v60, v160, v161
  v_cvt_pk_bf16_f32 v61, v162, v163
  buffer_store_dwordx2 v[60:61], v59, s[24:27], s52 offen offset:0 sc1
  v_cvt_pk_bf16_f32 v62, v164, v165
  v_cvt_pk_bf16_f32 v63, v166, v167
  buffer_store_dwordx2 v[62:63], v59, s[24:27], s52 offen offset:256 sc1
  v_cvt_pk_bf16_f32 v64, v168, v169
  v_cvt_pk_bf16_f32 v65, v170, v171
  buffer_store_dwordx2 v[64:65], v59, s[24:27], s52 offen offset:512 sc1
  v_cvt_pk_bf16_f32 v66, v172, v173
  v_cvt_pk_bf16_f32 v67, v174, v175
  buffer_store_dwordx2 v[66:67], v59, s[24:27], s52 offen offset:768 sc1
  v_cvt_pk_bf16_f32 v60, v176, v177
  v_cvt_pk_bf16_f32 v61, v178, v179
  buffer_store_dwordx2 v[60:61], v59, s[24:27], s52 offen offset:1024 sc1
  v_cvt_pk_bf16_f32 v62, v180, v181
  v_cvt_pk_bf16_f32 v63, v182, v183
  buffer_store_dwordx2 v[62:63], v59, s[24:27], s52 offen offset:1280 sc1
  v_cvt_pk_bf16_f32 v64, v184, v185
  v_cvt_pk_bf16_f32 v65, v186, v187
  buffer_store_dwordx2 v[64:65], v59, s[24:27], s52 offen offset:1536 sc1
  v_cvt_pk_bf16_f32 v66, v188, v189
  v_cvt_pk_bf16_f32 v67, v190, v191
  buffer_store_dwordx2 v[66:67], v59, s[24:27], s52 offen offset:1792 sc1
  s_waitcnt vmcnt(8)
  s_branch L_parallel_sum__linear_kernel_hedgehog__mixer_channel_mlp__prompt_kernel_g_done_10
L_parallel_sum__linear_kernel_hedgehog__mixer_channel_mlp__prompt_kernel_g_none_10:
  s_waitcnt vmcnt(0)
  s_branch L_parallel_sum__linear_kernel_hedgehog__mixer_channel_mlp__prompt_kernel_g_done_10
L_parallel_sum__linear_kernel_hedgehog__mixer_channel_mlp__prompt_kernel_g_w1_10:
  s_and_b32 s53, s51, 1
  s_mul_i32 s53, s53, 27
  s_add_u32 s51, s51, s53
  v_mul_f32 v50, 0xc0135761, v38
  v_mul_f32 v52, v38, v38
  v_mul_f32 v52, v52, v38
  v_mov_b32 v51, v50
  v_mul_f32 v52, 0xbdd2d3e8, v52
  v_mov_b32 v54, v39
  v_mov_b32 v55, v39
  v_mov_b32 v53, v52
  s_add_u32 s52, s48, 0
  s_mul_i32 s52, s52, 74
  s_add_u32 s52, s52, s51
  s_lshl_b32 s52, s52, 10
  s_add_u32 s52, s52, 8388608
  v_pk_mul_f32 v[60:61], v[160:161], v[160:161]
  v_pk_mul_f32 v[62:63], v[162:163], v[162:163]
  v_pk_mul_f32 v[64:65], v[164:165], v[164:165]
  v_pk_mul_f32 v[66:67], v[166:167], v[166:167]
  v_pk_fma_f32 v[60:61], v[60:61], v[52:53], v[50:51]
  v_pk_fma_f32 v[62:63], v[62:63], v[52:53], v[50:51]
  v_pk_fma_f32 v[64:65], v[64:65], v[52:53], v[50:51]
  v_pk_fma_f32 v[66:67], v[66:67], v[52:53], v[50:51]
  v_pk_mul_f32 v[60:61], v[60:61], v[160:161]
  v_pk_mul_f32 v[62:63], v[62:63], v[162:163]
  v_pk_mul_f32 v[64:65], v[64:65], v[164:165]
  v_pk_mul_f32 v[66:67], v[66:67], v[166:167]
  v_exp_f32 v60, v60
  v_exp_f32 v61, v61
  v_exp_f32 v62, v62
  v_exp_f32 v63, v63
  v_exp_f32 v64, v64
  v_exp_f32 v65, v65
  v_exp_f32 v66, v66
  v_exp_f32 v67, v67
  v_pk_fma_f32 v[60:61], v[60:61], v[54:55], v[54:55]
  v_pk_fma_f32 v[62:63], v[62:63], v[54:55], v[54:55]
  v_pk_fma_f32 v[64:65], v[64:65], v[54:55], v[54:55]
  v_pk_fma_f32 v[66:67], v[66:67], v[54:55], v[54:55]
  v_rcp_f32 v60, v60
  v_rcp_f32 v61, v61
  v_rcp_f32 v62, v62
  v_rcp_f32 v63, v63
  v_rcp_f32 v64, v64
  v_rcp_f32 v65, v65
  v_rcp_f32 v66, v66
  v_rcp_f32 v67, v67
  v_pk_mul_f32 v[60:61], v[60:61], v[160:161]
  v_pk_mul_f32 v[62:63], v[62:63], v[162:163]
  v_pk_mul_f32 v[64:65], v[64:65], v[164:165]
  v_pk_mul_f32 v[66:67], v[66:67], v[166:167]
  v_cvt_pk_bf16_f32 v68, v60, v61
  v_cvt_pk_bf16_f32 v69, v62, v63
  v_cvt_pk_bf16_f32 v70, v64, v65
  v_cvt_pk_bf16_f32 v71, v66, v67
  v_pk_mul_f32 v[60:61], v[168:169], v[168:169]
  v_pk_mul_f32 v[62:63], v[170:171], v[170:171]
  v_pk_mul_f32 v[64:65], v[172:173], v[172:173]
  v_pk_mul_f32 v[66:67], v[174:175], v[174:175]
  v_pk_fma_f32 v[60:61], v[60:61], v[52:53], v[50:51]
  v_pk_fma_f32 v[62:63], v[62:63], v[52:53], v[50:51]
  v_pk_fma_f32 v[64:65], v[64:65], v[52:53], v[50:51]
  v_pk_fma_f32 v[66:67], v[66:67], v[52:53], v[50:51]
  v_pk_mul_f32 v[60:61], v[60:61], v[168:169]
  v_pk_mul_f32 v[62:63], v[62:63], v[170:171]
  v_pk_mul_f32 v[64:65], v[64:65], v[172:173]
  v_pk_mul_f32 v[66:67], v[66:67], v[174:175]
  v_exp_f32 v60, v60
  v_exp_f32 v61, v61
  v_exp_f32 v62, v62
  v_exp_f32 v63, v63
  v_exp_f32 v64, v64
  v_exp_f32 v65, v65
  v_exp_f32 v66, v66
  v_exp_f32 v67, v67
  v_pk_fma_f32 v[60:61], v[60:61], v[54:55], v[54:55]
  v_pk_fma_f32 v[62:63], v[62:63], v[54:55], v[54:55]
  v_pk_fma_f32 v[64:65], v[64:65], v[54:55], v[54:55]
  v_pk_fma_f32 v[66:67], v[66:67], v[54:55], v[54:55]
  v_rcp_f32 v60, v60
  v_rcp_f32 v61, v61
  v_rcp_f32 v62, v62
  v_rcp_f32 v63, v63
  v_rcp_f32 v64, v64
  v_rcp_f32 v65, v65
  v_rcp_f32 v66, v66
  v_rcp_f32 v67, v67
  v_pk_mul_f32 v[60:61], v[60:61], v[168:169]
  v_pk_mul_f32 v[62:63], v[62:63], v[170:171]
  v_pk_mul_f32 v[64:65], v[64:65], v[172:173]
  v_pk_mul_f32 v[66:67], v[66:67], v[174:175]
  v_cvt_pk_bf16_f32 v72, v60, v61
  v_cvt_pk_bf16_f32 v73, v62, v63
  v_cvt_pk_bf16_f32 v74, v64, v65
  v_cvt_pk_bf16_f32 v75, v66, v67
  buffer_store_dwordx4 v[68:71], v58, s[24:27], s52 offen offset:0 sc1
  buffer_store_dwordx4 v[72:75], v58, s[24:27], s52 offen offset:256 sc1
  v_pk_mul_f32 v[60:61], v[176:177], v[176:177]
  v_pk_mul_f32 v[62:63], v[178:179], v[178:179]
  v_pk_mul_f32 v[64:65], v[180:181], v[180:181]
  v_pk_mul_f32 v[66:67], v[182:183], v[182:183]
  v_pk_fma_f32 v[60:61], v[60:61], v[52:53], v[50:51]
  v_pk_fma_f32 v[62:63], v[62:63], v[52:53], v[50:51]
  v_pk_fma_f32 v[64:65], v[64:65], v[52:53], v[50:51]
  v_pk_fma_f32 v[66:67], v[66:67], v[52:53], v[50:51]
  v_pk_mul_f32 v[60:61], v[60:61], v[176:177]
  v_pk_mul_f32 v[62:63], v[62:63], v[178:179]
  v_pk_mul_f32 v[64:65], v[64:65], v[180:181]
  v_pk_mul_f32 v[66:67], v[66:67], v[182:183]
  v_exp_f32 v60, v60
  v_exp_f32 v61, v61
  v_exp_f32 v62, v62
  v_exp_f32 v63, v63
  v_exp_f32 v64, v64
  v_exp_f32 v65, v65
  v_exp_f32 v66, v66
  v_exp_f32 v67, v67
  v_pk_fma_f32 v[60:61], v[60:61], v[54:55], v[54:55]
  v_pk_fma_f32 v[62:63], v[62:63], v[54:55], v[54:55]
  v_pk_fma_f32 v[64:65], v[64:65], v[54:55], v[54:55]
  v_pk_fma_f32 v[66:67], v[66:67], v[54:55], v[54:55]
  v_rcp_f32 v60, v60
  v_rcp_f32 v61, v61
  v_rcp_f32 v62, v62
  v_rcp_f32 v63, v63
  v_rcp_f32 v64, v64
  v_rcp_f32 v65, v65
  v_rcp_f32 v66, v66
  v_rcp_f32 v67, v67
  v_pk_mul_f32 v[60:61], v[60:61], v[176:177]
  v_pk_mul_f32 v[62:63], v[62:63], v[178:179]
  v_pk_mul_f32 v[64:65], v[64:65], v[180:181]
  v_pk_mul_f32 v[66:67], v[66:67], v[182:183]
  v_cvt_pk_bf16_f32 v20, v60, v61
  v_cvt_pk_bf16_f32 v21, v62, v63
  v_cvt_pk_bf16_f32 v22, v64, v65
  v_cvt_pk_bf16_f32 v23, v66, v67
  v_pk_mul_f32 v[60:61], v[184:185], v[184:185]
  v_pk_mul_f32 v[62:63], v[186:187], v[186:187]
  v_pk_mul_f32 v[64:65], v[188:189], v[188:189]
  v_pk_mul_f32 v[66:67], v[190:191], v[190:191]
  v_pk_fma_f32 v[60:61], v[60:61], v[52:53], v[50:51]
  v_pk_fma_f32 v[62:63], v[62:63], v[52:53], v[50:51]
  v_pk_fma_f32 v[64:65], v[64:65], v[52:53], v[50:51]
  v_pk_fma_f32 v[66:67], v[66:67], v[52:53], v[50:51]
  v_pk_mul_f32 v[60:61], v[60:61], v[184:185]
  v_pk_mul_f32 v[62:63], v[62:63], v[186:187]
  v_pk_mul_f32 v[64:65], v[64:65], v[188:189]
  v_pk_mul_f32 v[66:67], v[66:67], v[190:191]
  v_exp_f32 v60, v60
  v_exp_f32 v61, v61
  v_exp_f32 v62, v62
  v_exp_f32 v63, v63
  v_exp_f32 v64, v64
  v_exp_f32 v65, v65
  v_exp_f32 v66, v66
  v_exp_f32 v67, v67
  v_pk_fma_f32 v[60:61], v[60:61], v[54:55], v[54:55]
  v_pk_fma_f32 v[62:63], v[62:63], v[54:55], v[54:55]
  v_pk_fma_f32 v[64:65], v[64:65], v[54:55], v[54:55]
  v_pk_fma_f32 v[66:67], v[66:67], v[54:55], v[54:55]
  v_rcp_f32 v60, v60
  v_rcp_f32 v61, v61
  v_rcp_f32 v62, v62
  v_rcp_f32 v63, v63
  v_rcp_f32 v64, v64
  v_rcp_f32 v65, v65
  v_rcp_f32 v66, v66
  v_rcp_f32 v67, v67
  v_pk_mul_f32 v[60:61], v[60:61], v[184:185]
  v_pk_mul_f32 v[62:63], v[62:63], v[186:187]
  v_pk_mul_f32 v[64:65], v[64:65], v[188:189]
  v_pk_mul_f32 v[66:67], v[66:67], v[190:191]
  v_cvt_pk_bf16_f32 v24, v60, v61
  v_cvt_pk_bf16_f32 v25, v62, v63
  v_cvt_pk_bf16_f32 v26, v64, v65
  v_cvt_pk_bf16_f32 v27, v66, v67
  buffer_store_dwordx4 v[20:23], v58, s[24:27], s52 offen offset:1024 sc1
  buffer_store_dwordx4 v[24:27], v58, s[24:27], s52 offen offset:1280 sc1
  s_waitcnt vmcnt(4)
L_parallel_sum__linear_kernel_hedgehog__mixer_channel_mlp__prompt_kernel_g_done_10:
  s_barrier
  s_cmp_eq_u32 s39, 0
  s_cbranch_scc0 L_parallel_sum__linear_kernel_hedgehog__mixer_channel_mlp__prompt_kernel_fh1
  s_lshl_b32 s41, s36, 1
  s_lshr_b32 s42, s38, 2
  s_add_u32 s41, s41, s42
  s_lshl_b32 s41, s41, 7
  s_and_b32 s42, s38, 3
  s_add_u32 s41, s41, s42
  s_add_u32 s41, s41, 20973568
  v_mov_b32 v2, s41
  v_mov_b32 v0, 1
  s_mov_b64 exec, 1
  buffer_store_byte v0, v2, s[24:27], 0 offen sc1
  s_mov_b64 exec, -1
L_parallel_sum__linear_kernel_hedgehog__mixer_channel_mlp__prompt_kernel_fh1:
  s_lshl_b32 s50, s44, 1
  s_add_u32 s50, s50, 1
  s_lshl_b32 s51, s38, 2
  s_add_u32 s51, s51, s50
  s_cmp_lt_u32 s51, 27
  s_cbranch_scc1 L_parallel_sum__linear_kernel_hedgehog__mixer_channel_mlp__prompt_kernel_g_w1_11
  s_bitcmp1_b32 s51, 0
  s_cbranch_scc1 L_parallel_sum__linear_kernel_hedgehog__mixer_channel_mlp__prompt_kernel_g_none_11
  s_cmp_lt_u32 s51, 28
  s_cbranch_scc1 L_parallel_sum__linear_kernel_hedgehog__mixer_channel_mlp__prompt_kernel_g_none_11
  s_lshr_b32 s51, s51, 1
  s_sub_u32 s51, s51, 6
  s_add_u32 s52, s48, 2
  s_mul_i32 s52, s52, 160
  s_lshl_b32 s53, s51, 4
  s_add_u32 s52, s52, s53
  s_lshl_b32 s52, s52, 7
  s_add_u32 s52, s52, 524288
  v_cvt_pk_bf16_f32 v60, v224, v225
  v_cvt_pk_bf16_f32 v61, v226, v227
  buffer_store_dwordx2 v[60:61], v59, s[24:27], s52 offen offset:0 sc1
  v_cvt_pk_bf16_f32 v62, v228, v229
  v_cvt_pk_bf16_f32 v63, v230, v231
  buffer_store_dwordx2 v[62:63], v59, s[24:27], s52 offen offset:256 sc1
  v_cvt_pk_bf16_f32 v64, v232, v233
  v_cvt_pk_bf16_f32 v65, v234, v235
  buffer_store_dwordx2 v[64:65], v59, s[24:27], s52 offen offset:512 sc1
  v_cvt_pk_bf16_f32 v66, v236, v237
  v_cvt_pk_bf16_f32 v67, v238, v239
  buffer_store_dwordx2 v[66:67], v59, s[24:27], s52 offen offset:768 sc1
  v_cvt_pk_bf16_f32 v60, v240, v241
  v_cvt_pk_bf16_f32 v61, v242, v243
  buffer_store_dwordx2 v[60:61], v59, s[24:27], s52 offen offset:1024 sc1
  v_cvt_pk_bf16_f32 v62, v244, v245
  v_cvt_pk_bf16_f32 v63, v246, v247
  buffer_store_dwordx2 v[62:63], v59, s[24:27], s52 offen offset:1280 sc1
  v_cvt_pk_bf16_f32 v64, v248, v249
  v_cvt_pk_bf16_f32 v65, v250, v251
  buffer_store_dwordx2 v[64:65], v59, s[24:27], s52 offen offset:1536 sc1
  v_cvt_pk_bf16_f32 v66, v252, v253
  v_cvt_pk_bf16_f32 v67, v254, v255
  buffer_store_dwordx2 v[66:67], v59, s[24:27], s52 offen offset:1792 sc1
  s_branch L_parallel_sum__linear_kernel_hedgehog__mixer_channel_mlp__prompt_kernel_g_done_11
L_parallel_sum__linear_kernel_hedgehog__mixer_channel_mlp__prompt_kernel_g_none_11:
  s_branch L_parallel_sum__linear_kernel_hedgehog__mixer_channel_mlp__prompt_kernel_g_done_11
L_parallel_sum__linear_kernel_hedgehog__mixer_channel_mlp__prompt_kernel_g_w1_11:
  s_and_b32 s53, s51, 1
  s_mul_i32 s53, s53, 27
  s_add_u32 s51, s51, s53
  v_mul_f32 v50, 0xc0135761, v42
  v_mul_f32 v52, v42, v42
  v_mul_f32 v52, v52, v42
  v_mov_b32 v51, v50
  v_mul_f32 v52, 0xbdd2d3e8, v52
  v_mov_b32 v54, v43
  v_mov_b32 v55, v43
  v_mov_b32 v53, v52
  s_add_u32 s52, s48, 2
  s_mul_i32 s52, s52, 74
  s_add_u32 s52, s52, s51
  s_lshl_b32 s52, s52, 10
  s_add_u32 s52, s52, 8388608
  v_pk_mul_f32 v[60:61], v[224:225], v[224:225]
  v_pk_mul_f32 v[62:63], v[226:227], v[226:227]
  v_pk_mul_f32 v[64:65], v[228:229], v[228:229]
  v_pk_mul_f32 v[66:67], v[230:231], v[230:231]
  v_pk_fma_f32 v[60:61], v[60:61], v[52:53], v[50:51]
  v_pk_fma_f32 v[62:63], v[62:63], v[52:53], v[50:51]
  v_pk_fma_f32 v[64:65], v[64:65], v[52:53], v[50:51]
  v_pk_fma_f32 v[66:67], v[66:67], v[52:53], v[50:51]
  v_pk_mul_f32 v[60:61], v[60:61], v[224:225]
  v_pk_mul_f32 v[62:63], v[62:63], v[226:227]
  v_pk_mul_f32 v[64:65], v[64:65], v[228:229]
  v_pk_mul_f32 v[66:67], v[66:67], v[230:231]
  v_exp_f32 v60, v60
  v_exp_f32 v61, v61
  v_exp_f32 v62, v62
  v_exp_f32 v63, v63
  v_exp_f32 v64, v64
  v_exp_f32 v65, v65
  v_exp_f32 v66, v66
  v_exp_f32 v67, v67
  v_pk_fma_f32 v[60:61], v[60:61], v[54:55], v[54:55]
  v_pk_fma_f32 v[62:63], v[62:63], v[54:55], v[54:55]
  v_pk_fma_f32 v[64:65], v[64:65], v[54:55], v[54:55]
  v_pk_fma_f32 v[66:67], v[66:67], v[54:55], v[54:55]
  v_rcp_f32 v60, v60
  v_rcp_f32 v61, v61
  v_rcp_f32 v62, v62
  v_rcp_f32 v63, v63
  v_rcp_f32 v64, v64
  v_rcp_f32 v65, v65
  v_rcp_f32 v66, v66
  v_rcp_f32 v67, v67
  v_pk_mul_f32 v[60:61], v[60:61], v[224:225]
  v_pk_mul_f32 v[62:63], v[62:63], v[226:227]
  v_pk_mul_f32 v[64:65], v[64:65], v[228:229]
  v_pk_mul_f32 v[66:67], v[66:67], v[230:231]
  v_cvt_pk_bf16_f32 v68, v60, v61
  v_cvt_pk_bf16_f32 v69, v62, v63
  v_cvt_pk_bf16_f32 v70, v64, v65
  v_cvt_pk_bf16_f32 v71, v66, v67
  v_pk_mul_f32 v[60:61], v[232:233], v[232:233]
  v_pk_mul_f32 v[62:63], v[234:235], v[234:235]
  v_pk_mul_f32 v[64:65], v[236:237], v[236:237]
  v_pk_mul_f32 v[66:67], v[238:239], v[238:239]
  v_pk_fma_f32 v[60:61], v[60:61], v[52:53], v[50:51]
  v_pk_fma_f32 v[62:63], v[62:63], v[52:53], v[50:51]
  v_pk_fma_f32 v[64:65], v[64:65], v[52:53], v[50:51]
  v_pk_fma_f32 v[66:67], v[66:67], v[52:53], v[50:51]
  v_pk_mul_f32 v[60:61], v[60:61], v[232:233]
  v_pk_mul_f32 v[62:63], v[62:63], v[234:235]
  v_pk_mul_f32 v[64:65], v[64:65], v[236:237]
  v_pk_mul_f32 v[66:67], v[66:67], v[238:239]
  v_exp_f32 v60, v60
  v_exp_f32 v61, v61
  v_exp_f32 v62, v62
  v_exp_f32 v63, v63
  v_exp_f32 v64, v64
  v_exp_f32 v65, v65
  v_exp_f32 v66, v66
  v_exp_f32 v67, v67
  v_pk_fma_f32 v[60:61], v[60:61], v[54:55], v[54:55]
  v_pk_fma_f32 v[62:63], v[62:63], v[54:55], v[54:55]
  v_pk_fma_f32 v[64:65], v[64:65], v[54:55], v[54:55]
  v_pk_fma_f32 v[66:67], v[66:67], v[54:55], v[54:55]
  v_rcp_f32 v60, v60
  v_rcp_f32 v61, v61
  v_rcp_f32 v62, v62
  v_rcp_f32 v63, v63
  v_rcp_f32 v64, v64
  v_rcp_f32 v65, v65
  v_rcp_f32 v66, v66
  v_rcp_f32 v67, v67
  v_pk_mul_f32 v[60:61], v[60:61], v[232:233]
  v_pk_mul_f32 v[62:63], v[62:63], v[234:235]
  v_pk_mul_f32 v[64:65], v[64:65], v[236:237]
  v_pk_mul_f32 v[66:67], v[66:67], v[238:239]
  v_cvt_pk_bf16_f32 v72, v60, v61
  v_cvt_pk_bf16_f32 v73, v62, v63
  v_cvt_pk_bf16_f32 v74, v64, v65
  v_cvt_pk_bf16_f32 v75, v66, v67
  buffer_store_dwordx4 v[68:71], v58, s[24:27], s52 offen offset:0 sc1
  buffer_store_dwordx4 v[72:75], v58, s[24:27], s52 offen offset:256 sc1
  v_pk_mul_f32 v[60:61], v[240:241], v[240:241]
  v_pk_mul_f32 v[62:63], v[242:243], v[242:243]
  v_pk_mul_f32 v[64:65], v[244:245], v[244:245]
  v_pk_mul_f32 v[66:67], v[246:247], v[246:247]
  v_pk_fma_f32 v[60:61], v[60:61], v[52:53], v[50:51]
  v_pk_fma_f32 v[62:63], v[62:63], v[52:53], v[50:51]
  v_pk_fma_f32 v[64:65], v[64:65], v[52:53], v[50:51]
  v_pk_fma_f32 v[66:67], v[66:67], v[52:53], v[50:51]
  v_pk_mul_f32 v[60:61], v[60:61], v[240:241]
  v_pk_mul_f32 v[62:63], v[62:63], v[242:243]
  v_pk_mul_f32 v[64:65], v[64:65], v[244:245]
  v_pk_mul_f32 v[66:67], v[66:67], v[246:247]
  v_exp_f32 v60, v60
  v_exp_f32 v61, v61
  v_exp_f32 v62, v62
  v_exp_f32 v63, v63
  v_exp_f32 v64, v64
  v_exp_f32 v65, v65
  v_exp_f32 v66, v66
  v_exp_f32 v67, v67
  v_pk_fma_f32 v[60:61], v[60:61], v[54:55], v[54:55]
  v_pk_fma_f32 v[62:63], v[62:63], v[54:55], v[54:55]
  v_pk_fma_f32 v[64:65], v[64:65], v[54:55], v[54:55]
  v_pk_fma_f32 v[66:67], v[66:67], v[54:55], v[54:55]
  v_rcp_f32 v60, v60
  v_rcp_f32 v61, v61
  v_rcp_f32 v62, v62
  v_rcp_f32 v63, v63
  v_rcp_f32 v64, v64
  v_rcp_f32 v65, v65
  v_rcp_f32 v66, v66
  v_rcp_f32 v67, v67
  v_pk_mul_f32 v[60:61], v[60:61], v[240:241]
  v_pk_mul_f32 v[62:63], v[62:63], v[242:243]
  v_pk_mul_f32 v[64:65], v[64:65], v[244:245]
  v_pk_mul_f32 v[66:67], v[66:67], v[246:247]
  v_cvt_pk_bf16_f32 v20, v60, v61
  v_cvt_pk_bf16_f32 v21, v62, v63
  v_cvt_pk_bf16_f32 v22, v64, v65
  v_cvt_pk_bf16_f32 v23, v66, v67
  v_pk_mul_f32 v[60:61], v[248:249], v[248:249]
  v_pk_mul_f32 v[62:63], v[250:251], v[250:251]
  v_pk_mul_f32 v[64:65], v[252:253], v[252:253]
  v_pk_mul_f32 v[66:67], v[254:255], v[254:255]
  v_pk_fma_f32 v[60:61], v[60:61], v[52:53], v[50:51]
  v_pk_fma_f32 v[62:63], v[62:63], v[52:53], v[50:51]
  v_pk_fma_f32 v[64:65], v[64:65], v[52:53], v[50:51]
  v_pk_fma_f32 v[66:67], v[66:67], v[52:53], v[50:51]
  v_pk_mul_f32 v[60:61], v[60:61], v[248:249]
  v_pk_mul_f32 v[62:63], v[62:63], v[250:251]
  v_pk_mul_f32 v[64:65], v[64:65], v[252:253]
  v_pk_mul_f32 v[66:67], v[66:67], v[254:255]
  v_exp_f32 v60, v60
  v_exp_f32 v61, v61
  v_exp_f32 v62, v62
  v_exp_f32 v63, v63
  v_exp_f32 v64, v64
  v_exp_f32 v65, v65
  v_exp_f32 v66, v66
  v_exp_f32 v67, v67
  v_pk_fma_f32 v[60:61], v[60:61], v[54:55], v[54:55]
  v_pk_fma_f32 v[62:63], v[62:63], v[54:55], v[54:55]
  v_pk_fma_f32 v[64:65], v[64:65], v[54:55], v[54:55]
  v_pk_fma_f32 v[66:67], v[66:67], v[54:55], v[54:55]
  v_rcp_f32 v60, v60
  v_rcp_f32 v61, v61
  v_rcp_f32 v62, v62
  v_rcp_f32 v63, v63
  v_rcp_f32 v64, v64
  v_rcp_f32 v65, v65
  v_rcp_f32 v66, v66
  v_rcp_f32 v67, v67
  v_pk_mul_f32 v[60:61], v[60:61], v[248:249]
  v_pk_mul_f32 v[62:63], v[62:63], v[250:251]
  v_pk_mul_f32 v[64:65], v[64:65], v[252:253]
  v_pk_mul_f32 v[66:67], v[66:67], v[254:255]
  v_cvt_pk_bf16_f32 v24, v60, v61
  v_cvt_pk_bf16_f32 v25, v62, v63
  v_cvt_pk_bf16_f32 v26, v64, v65
  v_cvt_pk_bf16_f32 v27, v66, v67
  buffer_store_dwordx4 v[20:23], v58, s[24:27], s52 offen offset:1024 sc1
  buffer_store_dwordx4 v[24:27], v58, s[24:27], s52 offen offset:1280 sc1
L_parallel_sum__linear_kernel_hedgehog__mixer_channel_mlp__prompt_kernel_g_done_11:
  s_barrier
  s_branch L_parallel_sum__linear_kernel_hedgehog__mixer_channel_mlp__prompt_kernel_phase_b
L_parallel_sum__linear_kernel_hedgehog__mixer_channel_mlp__prompt_kernel_epi_kv:
  s_lshr_b32 s40, s2, 3
  s_and_b32 s68, s2, 3
  s_lshl_b32 s68, s68, 3
  s_lshr_b32 s41, s40, 2
  s_add_u32 s68, s68, s41
  s_lshr_b32 s69, s2, 2
  s_and_b32 s69, s69, 1
  s_lshl_b32 s69, s69, 2
  s_and_b32 s41, s40, 3
  s_add_u32 s69, s69, s41
  s_lshl_b32 s86, s68, 2
  s_add_u32 s86, s86, s39
  s_lshl_b32 s45, s43, 6
  v_add_u32 v32, s45, v16
  s_lshl_b32 s45, s44, 1
  v_add_u32 v33, s45, v17
  v_mul_u32_u24 v34, 336, v32
  v_mul_u32_u24 v35, 80, v33
  v_add_u32 v34, v34, v35
  v_add_u32 v34, 73728, v34
  v_mul_u32_u24 v35, 208, v32
  v_mul_u32_u24 v33, 48, v33
  v_add_u32 v35, v35, v33
  v_add_u32 v35, 116736, v35
  v_cvt_pk_bf16_f32 v80, v128, v129
  v_cvt_pk_bf16_f32 v81, v130, v131
  v_cvt_pk_bf16_f32 v82, v132, v133
  v_cvt_pk_bf16_f32 v83, v134, v135
  v_cvt_pk_bf16_f32 v84, v136, v137
  v_cvt_pk_bf16_f32 v85, v138, v139
  v_cvt_pk_bf16_f32 v86, v140, v141
  v_cvt_pk_bf16_f32 v87, v142, v143
  v_cvt_pk_bf16_f32 v88, v144, v145
  v_cvt_pk_bf16_f32 v89, v146, v147
  v_mov_b32 v90, 0
  v_mov_b32 v91, 0
  v_cvt_pk_bf16_f32 v92, v192, v193
  v_cvt_pk_bf16_f32 v93, v194, v195
  v_cvt_pk_bf16_f32 v94, v196, v197
  v_cvt_pk_bf16_f32 v95, v198, v199
  v_cvt_pk_bf16_f32 v96, v200, v201
  v_cvt_pk_bf16_f32 v97, v202, v203
  v_cvt_pk_bf16_f32 v98, v204, v205
  v_cvt_pk_bf16_f32 v99, v206, v207
  v_cvt_pk_bf16_f32 v100, v208, v209
  v_cvt_pk_bf16_f32 v101, v210, v211
  v_mov_b32 v102, 0
  v_mov_b32 v103, 0
  v_lshrrev_b32 v2, 4, v16
  v_and_b32 v0, 15, v16
  v_mul_u32_u24 v18, 20480, v2
  v_lshl_add_u32 v18, v17, 9, v18
  v_lshl_add_u32 v18, v0, 3, v18
  s_lshl_b32 s48, s36, 3
  s_lshl_b32 s49, s43, 2
  s_add_u32 s48, s48, s49
  s_add_u32 s52, s48, 0
  s_mul_i32 s52, s52, 160
  s_lshl_b32 s53, s38, 4
  s_add_u32 s52, s52, s53
  s_lshl_b32 s53, s44, 3
  s_add_u32 s52, s52, s53
  s_lshl_b32 s52, s52, 7
  s_add_u32 s52, s52, 524288
  v_cvt_pk_bf16_f32 v104, v168, v169
  v_cvt_pk_bf16_f32 v105, v170, v171
  buffer_store_dwordx2 v[104:105], v18, s[24:27], s52 offen offset:0 sc1
  v_cvt_pk_bf16_f32 v106, v172, v173
  v_cvt_pk_bf16_f32 v107, v174, v175
  buffer_store_dwordx2 v[106:107], v18, s[24:27], s52 offen offset:128 sc1
  v_cvt_pk_bf16_f32 v108, v176, v177
  v_cvt_pk_bf16_f32 v109, v178, v179
  buffer_store_dwordx2 v[108:109], v18, s[24:27], s52 offen offset:256 sc1
  v_cvt_pk_bf16_f32 v110, v180, v181
  v_cvt_pk_bf16_f32 v111, v182, v183
  buffer_store_dwordx2 v[110:111], v18, s[24:27], s52 offen offset:384 sc1
  s_add_u32 s52, s48, 2
  s_mul_i32 s52, s52, 160
  s_lshl_b32 s53, s38, 4
  s_add_u32 s52, s52, s53
  s_lshl_b32 s53, s44, 3
  s_add_u32 s52, s52, s53
  s_lshl_b32 s52, s52, 7
  s_add_u32 s52, s52, 524288
  v_cvt_pk_bf16_f32 v112, v232, v233
  v_cvt_pk_bf16_f32 v113, v234, v235
  buffer_store_dwordx2 v[112:113], v18, s[24:27], s52 offen offset:0 sc1
  v_cvt_pk_bf16_f32 v114, v236, v237
  v_cvt_pk_bf16_f32 v115, v238, v239
  buffer_store_dwordx2 v[114:115], v18, s[24:27], s52 offen offset:128 sc1
  v_cvt_pk_bf16_f32 v116, v240, v241
  v_cvt_pk_bf16_f32 v117, v242, v243
  buffer_store_dwordx2 v[116:117], v18, s[24:27], s52 offen offset:256 sc1
  v_cvt_pk_bf16_f32 v118, v244, v245
  v_cvt_pk_bf16_f32 v119, v246, v247
  buffer_store_dwordx2 v[118:119], v18, s[24:27], s52 offen offset:384 sc1
  s_waitcnt lgkmcnt(0)
  v_mfma_f32_32x32x16_bf16 v[168:183], v[56:59], v[80:83], 0
  v_mfma_f32_32x32x16_bf16 v[112:127], v[68:71], v[80:83], 0
  v_mfma_f32_32x32x16_bf16 v[232:247], v[56:59], v[92:95], 0
  v_mfma_f32_32x32x16_bf16 v[18:33], v[68:71], v[92:95], 0
  v_mfma_f32_32x32x16_bf16 v[168:183], v[60:63], v[84:87], v[168:183]
  v_mfma_f32_32x32x16_bf16 v[112:127], v[72:75], v[84:87], v[112:127]
  v_mfma_f32_32x32x16_bf16 v[232:247], v[60:63], v[96:99], v[232:247]
  v_mfma_f32_32x32x16_bf16 v[18:33], v[72:75], v[96:99], v[18:33]
  v_mfma_f32_32x32x16_bf16 v[168:183], v[64:67], v[88:91], v[168:183]
  v_mfma_f32_32x32x16_bf16 v[112:127], v[76:79], v[88:91], v[112:127]
  v_mfma_f32_32x32x16_bf16 v[232:247], v[64:67], v[100:103], v[232:247]
  v_mfma_f32_32x32x16_bf16 v[18:33], v[76:79], v[100:103], v[18:33]
  v_mov_b32 v4, v37
  v_mov_b32 v5, v37
  v_pk_mul_f32 v[148:149], v[148:149], v[4:5]
  v_pk_mul_f32 v[150:151], v[150:151], v[4:5]
  v_pk_mul_f32 v[152:153], v[152:153], v[4:5]
  v_pk_mul_f32 v[154:155], v[154:155], v[4:5]
  v_pk_mul_f32 v[156:157], v[156:157], v[4:5]
  v_pk_mul_f32 v[158:159], v[158:159], v[4:5]
  v_pk_mul_f32 v[160:161], v[160:161], v[4:5]
  v_pk_mul_f32 v[162:163], v[162:163], v[4:5]
  v_pk_mul_f32 v[164:165], v[164:165], v[4:5]
  v_pk_mul_f32 v[166:167], v[166:167], v[4:5]
  v_cvt_pk_bf16_f32 v44, v148, v149
  v_cvt_pk_bf16_f32 v45, v150, v151
  v_cvt_pk_bf16_f32 v46, v152, v153
  v_cvt_pk_bf16_f32 v47, v154, v155
  v_cvt_pk_bf16_f32 v48, v156, v157
  v_cvt_pk_bf16_f32 v49, v158, v159
  v_cvt_pk_bf16_f32 v50, v160, v161
  v_cvt_pk_bf16_f32 v51, v162, v163
  v_cvt_pk_bf16_f32 v52, v164, v165
  v_cvt_pk_bf16_f32 v53, v166, v167
  v_mov_b32 v54, 0x3f80
  v_mov_b32 v55, 0
  ds_write_b128 v35, v[44:47] offset:0
  ds_write_b128 v35, v[48:51] offset:16
  ds_write_b128 v35, v[52:55] offset:32
  v_mov_b32 v4, v41
  v_mov_b32 v5, v41
  v_pk_mul_f32 v[212:213], v[212:213], v[4:5]
  v_pk_mul_f32 v[214:215], v[214:215], v[4:5]
  v_pk_mul_f32 v[216:217], v[216:217], v[4:5]
  v_pk_mul_f32 v[218:219], v[218:219], v[4:5]
  v_pk_mul_f32 v[220:221], v[220:221], v[4:5]
  v_pk_mul_f32 v[222:223], v[222:223], v[4:5]
  v_pk_mul_f32 v[224:225], v[224:225], v[4:5]
  v_pk_mul_f32 v[226:227], v[226:227], v[4:5]
  v_pk_mul_f32 v[228:229], v[228:229], v[4:5]
  v_pk_mul_f32 v[230:231], v[230:231], v[4:5]
  v_cvt_pk_bf16_f32 v44, v212, v213
  v_cvt_pk_bf16_f32 v45, v214, v215
  v_cvt_pk_bf16_f32 v46, v216, v217
  v_cvt_pk_bf16_f32 v47, v218, v219
  v_cvt_pk_bf16_f32 v48, v220, v221
  v_cvt_pk_bf16_f32 v49, v222, v223
  v_cvt_pk_bf16_f32 v50, v224, v225
  v_cvt_pk_bf16_f32 v51, v226, v227
  v_cvt_pk_bf16_f32 v52, v228, v229
  v_cvt_pk_bf16_f32 v53, v230, v231
  v_mov_b32 v54, 0x3f80
  v_mov_b32 v55, 0
  ds_write_b128 v35, v[44:47] offset:6656
  ds_write_b128 v35, v[48:51] offset:6672
  ds_write_b128 v35, v[52:55] offset:6688
  v_mov_b32 v184, v112
  v_mov_b32 v185, v113
  v_mov_b32 v186, v114
  v_mov_b32 v187, v115
  v_max3_f32 v44, v168, v169, v170
  v_min3_f32 v45, v168, v169, v170
  v_max3_f32 v46, v171, v172, v173
  v_min3_f32 v47, v171, v172, v173
  v_max3_f32 v44, v44, v174, v175
  v_min3_f32 v45, v45, v174, v175
  v_max3_f32 v46, v46, v176, v177
  v_min3_f32 v47, v47, v176, v177
  v_max3_f32 v44, v44, v178, v179
  v_min3_f32 v45, v45, v178, v179
  v_max3_f32 v46, v46, v180, v181
  v_min3_f32 v47, v47, v180, v181
  v_max3_f32 v44, v44, v182, v183
  v_min3_f32 v45, v45, v182, v183
  v_max3_f32 v46, v46, v184, v185
  v_min3_f32 v47, v47, v184, v185
  v_max3_f32 v44, v44, v186, v187
  v_min3_f32 v45, v45, v186, v187
  v_max_f32 v44, v44, v46
  v_min_f32 v45, v45, v47
  v_mul_f32 v46, 0x3fb8aa3b, v37
  v_mov_b32 v47, v46
  v_mul_f32 v2, v44, v46
  v_mul_f32 v0, v45, v46
  v_sub_f32 v44, 0, v2
  v_sub_f32 v45, 0, v2
  v_pk_fma_f32 v[128:129], v[168:169], v[46:47], v[44:45]
  v_pk_fma_f32 v[130:131], v[170:171], v[46:47], v[44:45]
  v_pk_fma_f32 v[132:133], v[172:173], v[46:47], v[44:45]
  v_pk_fma_f32 v[134:135], v[174:175], v[46:47], v[44:45]
  v_pk_fma_f32 v[136:137], v[176:177], v[46:47], v[44:45]
  v_pk_fma_f32 v[138:139], v[178:179], v[46:47], v[44:45]
  v_pk_fma_f32 v[140:141], v[180:181], v[46:47], v[44:45]
  v_pk_fma_f32 v[142:143], v[182:183], v[46:47], v[44:45]
  v_pk_fma_f32 v[144:145], v[184:185], v[46:47], v[44:45]
  v_pk_fma_f32 v[146:147], v[186:187], v[46:47], v[44:45]
  v_mov_b32 v44, v0
  v_mov_b32 v45, v0
  v_pk_fma_f32 v[148:149], v[168:169], v[46:47], v[44:45] neg_lo:[1,0,0] neg_hi:[1,0,0]
  v_pk_fma_f32 v[150:151], v[170:171], v[46:47], v[44:45] neg_lo:[1,0,0] neg_hi:[1,0,0]
  v_pk_fma_f32 v[152:153], v[172:173], v[46:47], v[44:45] neg_lo:[1,0,0] neg_hi:[1,0,0]
  v_pk_fma_f32 v[154:155], v[174:175], v[46:47], v[44:45] neg_lo:[1,0,0] neg_hi:[1,0,0]
  v_pk_fma_f32 v[156:157], v[176:177], v[46:47], v[44:45] neg_lo:[1,0,0] neg_hi:[1,0,0]
  v_pk_fma_f32 v[158:159], v[178:179], v[46:47], v[44:45] neg_lo:[1,0,0] neg_hi:[1,0,0]
  v_pk_fma_f32 v[160:161], v[180:181], v[46:47], v[44:45] neg_lo:[1,0,0] neg_hi:[1,0,0]
  v_pk_fma_f32 v[162:163], v[182:183], v[46:47], v[44:45] neg_lo:[1,0,0] neg_hi:[1,0,0]
  v_pk_fma_f32 v[164:165], v[184:185], v[46:47], v[44:45] neg_lo:[1,0,0] neg_hi:[1,0,0]
  v_pk_fma_f32 v[166:167], v[186:187], v[46:47], v[44:45] neg_lo:[1,0,0] neg_hi:[1,0,0]
  v_exp_f32 v128, v128
  v_exp_f32 v129, v129
  v_exp_f32 v130, v130
  v_exp_f32 v131, v131
  v_exp_f32 v132, v132
  v_exp_f32 v133, v133
  v_exp_f32 v134, v134
  v_exp_f32 v135, v135
  v_exp_f32 v136, v136
  v_exp_f32 v137, v137
  v_exp_f32 v138, v138
  v_exp_f32 v139, v139
  v_exp_f32 v140, v140
  v_exp_f32 v141, v141
  v_exp_f32 v142, v142
  v_exp_f32 v143, v143
  v_exp_f32 v144, v144
  v_exp_f32 v145, v145
  v_exp_f32 v146, v146
  v_exp_f32 v147, v147
  v_exp_f32 v148, v148
  v_exp_f32 v149, v149
  v_exp_f32 v150, v150
  v_exp_f32 v151, v151
  v_exp_f32 v152, v152
  v_exp_f32 v153, v153
  v_exp_f32 v154, v154
  v_exp_f32 v155, v155
  v_exp_f32 v156, v156
  v_exp_f32 v157, v157
  v_exp_f32 v158, v158
  v_exp_f32 v159, v159
  v_exp_f32 v160, v160
  v_exp_f32 v161, v161
  v_exp_f32 v162, v162
  v_exp_f32 v163, v163
  v_exp_f32 v164, v164
  v_exp_f32 v165, v165
  v_exp_f32 v166, v166
  v_exp_f32 v167, v167
  v_pk_add_f32 v[44:45], v[128:129], v[130:131]
  v_pk_add_f32 v[46:47], v[148:149], v[150:151]
  v_pk_add_f32 v[44:45], v[44:45], v[132:133]
  v_pk_add_f32 v[46:47], v[46:47], v[152:153]
  v_pk_add_f32 v[44:45], v[44:45], v[134:135]
  v_pk_add_f32 v[46:47], v[46:47], v[154:155]
  v_pk_add_f32 v[44:45], v[44:45], v[136:137]
  v_pk_add_f32 v[46:47], v[46:47], v[156:157]
  v_pk_add_f32 v[44:45], v[44:45], v[138:139]
  v_pk_add_f32 v[46:47], v[46:47], v[158:159]
  v_pk_add_f32 v[44:45], v[44:45], v[140:141]
  v_pk_add_f32 v[46:47], v[46:47], v[160:161]
  v_pk_add_f32 v[44:45], v[44:45], v[142:143]
  v_pk_add_f32 v[46:47], v[46:47], v[162:163]
  v_pk_add_f32 v[44:45], v[44:45], v[144:145]
  v_pk_add_f32 v[46:47], v[46:47], v[164:165]
  v_pk_add_f32 v[44:45], v[44:45], v[146:147]
  v_pk_add_f32 v[46:47], v[46:47], v[166:167]
  v_add_f32 v44, v44, v45
  v_add_f32 v46, v46, v47
  v_rcp_f32 v44, v44
  v_rcp_f32 v46, v46
  v_mov_b32 v45, v44
  v_mov_b32 v47, v46
  v_pk_mul_f32 v[128:129], v[128:129], v[44:45]
  v_pk_mul_f32 v[148:149], v[148:149], v[46:47]
  v_pk_mul_f32 v[130:131], v[130:131], v[44:45]
  v_pk_mul_f32 v[150:151], v[150:151], v[46:47]
  v_pk_mul_f32 v[132:133], v[132:133], v[44:45]
  v_pk_mul_f32 v[152:153], v[152:153], v[46:47]
  v_pk_mul_f32 v[134:135], v[134:135], v[44:45]
  v_pk_mul_f32 v[154:155], v[154:155], v[46:47]
  v_pk_mul_f32 v[136:137], v[136:137], v[44:45]
  v_pk_mul_f32 v[156:157], v[156:157], v[46:47]
  v_pk_mul_f32 v[138:139], v[138:139], v[44:45]
  v_pk_mul_f32 v[158:159], v[158:159], v[46:47]
  v_pk_mul_f32 v[140:141], v[140:141], v[44:45]
  v_pk_mul_f32 v[160:161], v[160:161], v[46:47]
  v_pk_mul_f32 v[142:143], v[142:143], v[44:45]
  v_pk_mul_f32 v[162:163], v[162:163], v[46:47]
  v_pk_mul_f32 v[144:145], v[144:145], v[44:45]
  v_pk_mul_f32 v[164:165], v[164:165], v[46:47]
  v_pk_mul_f32 v[146:147], v[146:147], v[44:45]
  v_pk_mul_f32 v[166:167], v[166:167], v[46:47]
  v_cvt_pk_bf16_f32 v80, v128, v129
  v_cvt_pk_bf16_f32 v81, v130, v131
  v_cvt_pk_bf16_f32 v82, v132, v133
  v_cvt_pk_bf16_f32 v83, v134, v135
  v_cvt_pk_bf16_f32 v84, v136, v137
  v_cvt_pk_bf16_f32 v85, v138, v139
  v_cvt_pk_bf16_f32 v86, v140, v141
  v_cvt_pk_bf16_f32 v87, v142, v143
  v_cvt_pk_bf16_f32 v88, v144, v145
  v_cvt_pk_bf16_f32 v89, v146, v147
  v_cvt_pk_bf16_f32 v90, v148, v149
  v_cvt_pk_bf16_f32 v91, v150, v151
  v_cvt_pk_bf16_f32 v92, v152, v153
  v_cvt_pk_bf16_f32 v93, v154, v155
  v_cvt_pk_bf16_f32 v94, v156, v157
  v_cvt_pk_bf16_f32 v95, v158, v159
  v_cvt_pk_bf16_f32 v96, v160, v161
  v_cvt_pk_bf16_f32 v97, v162, v163
  v_cvt_pk_bf16_f32 v98, v164, v165
  v_cvt_pk_bf16_f32 v99, v166, v167
  ds_write_b128 v34, v[80:83] offset:0
  ds_write_b128 v34, v[84:87] offset:16
  ds_write_b128 v34, v[88:91] offset:32
  ds_write_b128 v34, v[92:95] offset:48
  ds_write_b128 v34, v[96:99] offset:64
  s_waitcnt vmcnt(0)
  s_lshl_b32 s41, s36, 1
  s_lshr_b32 s42, s39, 1
  s_add_u32 s41, s41, s42
  s_lshl_b32 s41, s41, 2
  s_lshr_b32 s42, s38, 1
  s_add_u32 s41, s41, s42
  s_lshl_b32 s41, s41, 7
  s_and_b32 s42, s38, 1
  s_lshl_b32 s42, s42, 1
  s_add_u32 s41, s41, s42
  s_and_b32 s42, s39, 1
  s_add_u32 s41, s41, s42
  s_add_u32 s41, s41, 20981760
  v_mov_b32 v2, s41
  v_mov_b32 v0, 1
  s_mov_b64 exec, 1
  buffer_store_byte v0, v2, s[24:27], 0 offen sc1
  s_mov_b64 exec, -1
  v_mov_b32 v248, v18
  v_mov_b32 v249, v19
  v_mov_b32 v250, v20
  v_mov_b32 v251, v21
  v_max3_f32 v44, v232, v233, v234
  v_min3_f32 v45, v232, v233, v234
  v_max3_f32 v46, v235, v236, v237
  v_min3_f32 v47, v235, v236, v237
  v_max3_f32 v44, v44, v238, v239
  v_min3_f32 v45, v45, v238, v239
  v_max3_f32 v46, v46, v240, v241
  v_min3_f32 v47, v47, v240, v241
  v_max3_f32 v44, v44, v242, v243
  v_min3_f32 v45, v45, v242, v243
  v_max3_f32 v46, v46, v244, v245
  v_min3_f32 v47, v47, v244, v245
  v_max3_f32 v44, v44, v246, v247
  v_min3_f32 v45, v45, v246, v247
  v_max3_f32 v46, v46, v248, v249
  v_min3_f32 v47, v47, v248, v249
  v_max3_f32 v44, v44, v250, v251
  v_min3_f32 v45, v45, v250, v251
  v_max_f32 v44, v44, v46
  v_min_f32 v45, v45, v47
  v_mul_f32 v46, 0x3fb8aa3b, v41
  v_mov_b32 v47, v46
  v_mul_f32 v2, v44, v46
  v_mul_f32 v0, v45, v46
  v_sub_f32 v44, 0, v2
  v_sub_f32 v45, 0, v2
  v_pk_fma_f32 v[192:193], v[232:233], v[46:47], v[44:45]
  v_pk_fma_f32 v[194:195], v[234:235], v[46:47], v[44:45]
  v_pk_fma_f32 v[196:197], v[236:237], v[46:47], v[44:45]
  v_pk_fma_f32 v[198:199], v[238:239], v[46:47], v[44:45]
  v_pk_fma_f32 v[200:201], v[240:241], v[46:47], v[44:45]
  v_pk_fma_f32 v[202:203], v[242:243], v[46:47], v[44:45]
  v_pk_fma_f32 v[204:205], v[244:245], v[46:47], v[44:45]
  v_pk_fma_f32 v[206:207], v[246:247], v[46:47], v[44:45]
  v_pk_fma_f32 v[208:209], v[248:249], v[46:47], v[44:45]
  v_pk_fma_f32 v[210:211], v[250:251], v[46:47], v[44:45]
  v_mov_b32 v44, v0
  v_mov_b32 v45, v0
  v_pk_fma_f32 v[212:213], v[232:233], v[46:47], v[44:45] neg_lo:[1,0,0] neg_hi:[1,0,0]
  v_pk_fma_f32 v[214:215], v[234:235], v[46:47], v[44:45] neg_lo:[1,0,0] neg_hi:[1,0,0]
  v_pk_fma_f32 v[216:217], v[236:237], v[46:47], v[44:45] neg_lo:[1,0,0] neg_hi:[1,0,0]
  v_pk_fma_f32 v[218:219], v[238:239], v[46:47], v[44:45] neg_lo:[1,0,0] neg_hi:[1,0,0]
  v_pk_fma_f32 v[220:221], v[240:241], v[46:47], v[44:45] neg_lo:[1,0,0] neg_hi:[1,0,0]
  v_pk_fma_f32 v[222:223], v[242:243], v[46:47], v[44:45] neg_lo:[1,0,0] neg_hi:[1,0,0]
  v_pk_fma_f32 v[224:225], v[244:245], v[46:47], v[44:45] neg_lo:[1,0,0] neg_hi:[1,0,0]
  v_pk_fma_f32 v[226:227], v[246:247], v[46:47], v[44:45] neg_lo:[1,0,0] neg_hi:[1,0,0]
  v_pk_fma_f32 v[228:229], v[248:249], v[46:47], v[44:45] neg_lo:[1,0,0] neg_hi:[1,0,0]
  v_pk_fma_f32 v[230:231], v[250:251], v[46:47], v[44:45] neg_lo:[1,0,0] neg_hi:[1,0,0]
  v_exp_f32 v192, v192
  v_exp_f32 v193, v193
  v_exp_f32 v194, v194
  v_exp_f32 v195, v195
  v_exp_f32 v196, v196
  v_exp_f32 v197, v197
  v_exp_f32 v198, v198
  v_exp_f32 v199, v199
  v_exp_f32 v200, v200
  v_exp_f32 v201, v201
  v_exp_f32 v202, v202
  v_exp_f32 v203, v203
  v_exp_f32 v204, v204
  v_exp_f32 v205, v205
  v_exp_f32 v206, v206
  v_exp_f32 v207, v207
  v_exp_f32 v208, v208
  v_exp_f32 v209, v209
  v_exp_f32 v210, v210
  v_exp_f32 v211, v211
  v_exp_f32 v212, v212
  v_exp_f32 v213, v213
  v_exp_f32 v214, v214
  v_exp_f32 v215, v215
  v_exp_f32 v216, v216
  v_exp_f32 v217, v217
  v_exp_f32 v218, v218
  v_exp_f32 v219, v219
  v_exp_f32 v220, v220
  v_exp_f32 v221, v221
  v_exp_f32 v222, v222
  v_exp_f32 v223, v223
  v_exp_f32 v224, v224
  v_exp_f32 v225, v225
  v_exp_f32 v226, v226
  v_exp_f32 v227, v227
  v_exp_f32 v228, v228
  v_exp_f32 v229, v229
  v_exp_f32 v230, v230
  v_exp_f32 v231, v231
  v_pk_add_f32 v[44:45], v[192:193], v[194:195]
  v_pk_add_f32 v[46:47], v[212:213], v[214:215]
  v_pk_add_f32 v[44:45], v[44:45], v[196:197]
  v_pk_add_f32 v[46:47], v[46:47], v[216:217]
  v_pk_add_f32 v[44:45], v[44:45], v[198:199]
  v_pk_add_f32 v[46:47], v[46:47], v[218:219]
  v_pk_add_f32 v[44:45], v[44:45], v[200:201]
  v_pk_add_f32 v[46:47], v[46:47], v[220:221]
  v_pk_add_f32 v[44:45], v[44:45], v[202:203]
  v_pk_add_f32 v[46:47], v[46:47], v[222:223]
  v_pk_add_f32 v[44:45], v[44:45], v[204:205]
  v_pk_add_f32 v[46:47], v[46:47], v[224:225]
  v_pk_add_f32 v[44:45], v[44:45], v[206:207]
  v_pk_add_f32 v[46:47], v[46:47], v[226:227]
  v_pk_add_f32 v[44:45], v[44:45], v[208:209]
  v_pk_add_f32 v[46:47], v[46:47], v[228:229]
  v_pk_add_f32 v[44:45], v[44:45], v[210:211]
  v_pk_add_f32 v[46:47], v[46:47], v[230:231]
  v_add_f32 v44, v44, v45
  v_add_f32 v46, v46, v47
  v_rcp_f32 v44, v44
  v_rcp_f32 v46, v46
  v_mov_b32 v45, v44
  v_mov_b32 v47, v46
  v_pk_mul_f32 v[192:193], v[192:193], v[44:45]
  v_pk_mul_f32 v[212:213], v[212:213], v[46:47]
  v_pk_mul_f32 v[194:195], v[194:195], v[44:45]
  v_pk_mul_f32 v[214:215], v[214:215], v[46:47]
  v_pk_mul_f32 v[196:197], v[196:197], v[44:45]
  v_pk_mul_f32 v[216:217], v[216:217], v[46:47]
  v_pk_mul_f32 v[198:199], v[198:199], v[44:45]
  v_pk_mul_f32 v[218:219], v[218:219], v[46:47]
  v_pk_mul_f32 v[200:201], v[200:201], v[44:45]
  v_pk_mul_f32 v[220:221], v[220:221], v[46:47]
  v_pk_mul_f32 v[202:203], v[202:203], v[44:45]
  v_pk_mul_f32 v[222:223], v[222:223], v[46:47]
  v_pk_mul_f32 v[204:205], v[204:205], v[44:45]
  v_pk_mul_f32 v[224:225], v[224:225], v[46:47]
  v_pk_mul_f32 v[206:207], v[206:207], v[44:45]
  v_pk_mul_f32 v[226:227], v[226:227], v[46:47]
  v_pk_mul_f32 v[208:209], v[208:209], v[44:45]
  v_pk_mul_f32 v[228:229], v[228:229], v[46:47]
  v_pk_mul_f32 v[210:211], v[210:211], v[44:45]
  v_pk_mul_f32 v[230:231], v[230:231], v[46:47]
  v_cvt_pk_bf16_f32 v80, v192, v193
  v_cvt_pk_bf16_f32 v81, v194, v195
  v_cvt_pk_bf16_f32 v82, v196, v197
  v_cvt_pk_bf16_f32 v83, v198, v199
  v_cvt_pk_bf16_f32 v84, v200, v201
  v_cvt_pk_bf16_f32 v85, v202, v203
  v_cvt_pk_bf16_f32 v86, v204, v205
  v_cvt_pk_bf16_f32 v87, v206, v207
  v_cvt_pk_bf16_f32 v88, v208, v209
  v_cvt_pk_bf16_f32 v89, v210, v211
  v_cvt_pk_bf16_f32 v90, v212, v213
  v_cvt_pk_bf16_f32 v91, v214, v215
  v_cvt_pk_bf16_f32 v92, v216, v217
  v_cvt_pk_bf16_f32 v93, v218, v219
  v_cvt_pk_bf16_f32 v94, v220, v221
  v_cvt_pk_bf16_f32 v95, v222, v223
  v_cvt_pk_bf16_f32 v96, v224, v225
  v_cvt_pk_bf16_f32 v97, v226, v227
  v_cvt_pk_bf16_f32 v98, v228, v229
  v_cvt_pk_bf16_f32 v99, v230, v231
  ds_write_b128 v34, v[80:83] offset:10752
  ds_write_b128 v34, v[84:87] offset:10768
  ds_write_b128 v34, v[88:91] offset:10784
  ds_write_b128 v34, v[92:95] offset:10800
  ds_write_b128 v34, v[96:99] offset:10816
  s_waitcnt lgkmcnt(0)
  s_barrier
  v_lshrrev_b32 v18, 4, v1
  v_lshrrev_b32 v19, 2, v1
  v_and_b32 v19, 3, v19
  v_and_b32 v20, 3, v1
  v_lshrrev_b32 v21, 1, v18
  v_lshl_add_u32 v21, v21, 3, v19
  v_and_b32 v22, 1, v18
  v_lshlrev_b32 v22, 2, v22
  v_add_u32 v22, v22, v20
  v_mul_u32_u24 v23, 336, v21
  s_mul_i32 s45, s39, 80
  s_add_u32 s45, s45, 73728
  v_add_u32 v23, s45, v23
  v_lshl_add_u32 v24, v22, 3, v23
  v_and_b32 v25, 1, v22
  v_lshl_add_u32 v25, v25, 3, v23
  v_add_u32 v25, 64, v25
  v_mul_u32_u24 v26, 208, v21
  s_mul_i32 s45, s39, 48
  s_add_u32 s45, s45, 116736
  v_add_u32 v26, s45, v26
  v_min_u32 v27, 5, v22
  v_lshl_add_u32 v26, v27, 3, v26
  ds_read_b64_tr_b16 v[128:129], v24 offset:0
  ds_read_b64_tr_b16 v[132:133], v25 offset:0
  ds_read_b64_tr_b16 v[136:137], v26 offset:0
  ds_read_b64_tr_b16 v[130:131], v24 offset:1344
  ds_read_b64_tr_b16 v[134:135], v25 offset:1344
  ds_read_b64_tr_b16 v[138:139], v26 offset:832
  ds_read_b64_tr_b16 v[140:141], v24 offset:5376
  ds_read_b64_tr_b16 v[144:145], v25 offset:5376
  ds_read_b64_tr_b16 v[148:149], v26 offset:3328
  ds_read_b64_tr_b16 v[142:143], v24 offset:6720
  ds_read_b64_tr_b16 v[146:147], v25 offset:6720
  ds_read_b64_tr_b16 v[150:151], v26 offset:4160
  v_lshlrev_b32 v28, 2, v16
  v_mul_u32_u24 v29, 384, v17
  v_add_u32 v28, v28, v29
  s_mul_i32 s46, s39, 3840
  s_add_u32 s46, s46, 20480
  v_add_u32 v28, s46, v28
  v_lshlrev_b32 v30, 4, v1
  v_add_u32 v31, s46, v30
  s_lshl_b32 s45, s38, 4
  s_add_u32 s45, s45, s36
  s_mul_i32 s45, s45, 160
  s_mul_i32 s46, s39, 40
  s_add_u32 s45, s45, s46
  s_mul_i32 s45, s45, 96
  s_add_u32 s45, s45, 18874368
  s_waitcnt lgkmcnt(6)
  v_mfma_f32_32x32x16_bf16 v[48:63], v[128:131], v[136:139], 0
  v_mfma_f32_32x32x16_bf16 v[64:79], v[132:135], v[136:139], 0
  ds_read_b64_tr_b16 v[152:153], v24 offset:10752
  ds_read_b64_tr_b16 v[156:157], v25 offset:10752
  ds_read_b64_tr_b16 v[160:161], v26 offset:6656
  ds_read_b64_tr_b16 v[154:155], v24 offset:12096
  ds_read_b64_tr_b16 v[158:159], v25 offset:12096
  ds_read_b64_tr_b16 v[162:163], v26 offset:7488
  s_waitcnt lgkmcnt(6)
  v_mfma_f32_32x32x16_bf16 v[48:63], v[140:143], v[148:151], v[48:63]
  v_mfma_f32_32x32x16_bf16 v[64:79], v[144:147], v[148:151], v[64:79]
  ds_read_b64_tr_b16 v[164:165], v24 offset:16128
  ds_read_b64_tr_b16 v[168:169], v25 offset:16128
  ds_read_b64_tr_b16 v[172:173], v26 offset:9984
  ds_read_b64_tr_b16 v[166:167], v24 offset:17472
  ds_read_b64_tr_b16 v[170:171], v25 offset:17472
  ds_read_b64_tr_b16 v[174:175], v26 offset:10816
  s_waitcnt lgkmcnt(6)
  v_mfma_f32_32x32x16_bf16 v[48:63], v[152:155], v[160:163], v[48:63]
  v_mfma_f32_32x32x16_bf16 v[64:79], v[156:159], v[160:163], v[64:79]
  ds_read_b64_tr_b16 v[176:177], v24 offset:21504
  ds_read_b64_tr_b16 v[180:181], v25 offset:21504
  ds_read_b64_tr_b16 v[184:185], v26 offset:13312
  ds_read_b64_tr_b16 v[178:179], v24 offset:22848
  ds_read_b64_tr_b16 v[182:183], v25 offset:22848
  ds_read_b64_tr_b16 v[186:187], v26 offset:14144
  s_waitcnt lgkmcnt(6)
  v_mfma_f32_32x32x16_bf16 v[48:63], v[164:167], v[172:175], v[48:63]
  v_mfma_f32_32x32x16_bf16 v[64:79], v[168:171], v[172:175], v[64:79]
  ds_read_b64_tr_b16 v[188:189], v24 offset:26880
  ds_read_b64_tr_b16 v[192:193], v25 offset:26880
  ds_read_b64_tr_b16 v[196:197], v26 offset:16640
  ds_read_b64_tr_b16 v[190:191], v24 offset:28224
  ds_read_b64_tr_b16 v[194:195], v25 offset:28224
  ds_read_b64_tr_b16 v[198:199], v26 offset:17472
  s_waitcnt lgkmcnt(6)
  v_mfma_f32_32x32x16_bf16 v[48:63], v[176:179], v[184:187], v[48:63]
  v_mfma_f32_32x32x16_bf16 v[64:79], v[180:183], v[184:187], v[64:79]
  ds_read_b64_tr_b16 v[200:201], v24 offset:32256
  ds_read_b64_tr_b16 v[204:205], v25 offset:32256
  ds_read_b64_tr_b16 v[208:209], v26 offset:19968
  ds_read_b64_tr_b16 v[202:203], v24 offset:33600
  ds_read_b64_tr_b16 v[206:207], v25 offset:33600
  ds_read_b64_tr_b16 v[210:211], v26 offset:20800
  s_waitcnt lgkmcnt(6)
  v_mfma_f32_32x32x16_bf16 v[48:63], v[188:191], v[196:199], v[48:63]
  v_mfma_f32_32x32x16_bf16 v[64:79], v[192:195], v[196:199], v[64:79]
  ds_read_b64_tr_b16 v[212:213], v24 offset:37632
  ds_read_b64_tr_b16 v[216:217], v25 offset:37632
  ds_read_b64_tr_b16 v[220:221], v26 offset:23296
  ds_read_b64_tr_b16 v[214:215], v24 offset:38976
  ds_read_b64_tr_b16 v[218:219], v25 offset:38976
  ds_read_b64_tr_b16 v[222:223], v26 offset:24128
  s_waitcnt lgkmcnt(6)
  v_mfma_f32_32x32x16_bf16 v[48:63], v[200:203], v[208:211], v[48:63]
  v_mfma_f32_32x32x16_bf16 v[64:79], v[204:207], v[208:211], v[64:79]
  s_waitcnt lgkmcnt(0)
  v_mfma_f32_32x32x16_bf16 v[48:63], v[212:215], v[220:223], v[48:63]
  v_mfma_f32_32x32x16_bf16 v[64:79], v[216:219], v[220:223], v[64:79]
  v_cmp_gt_u32 vcc, 24, v16
  s_nop 0
  s_and_saveexec_b64 s[50:51], vcc
  s_nop 7
  ds_write_b32 v28, v48 offset:0
  ds_write_b32 v28, v49 offset:96
  ds_write_b32 v28, v50 offset:192
  ds_write_b32 v28, v51 offset:288
  ds_write_b32 v28, v52 offset:768
  ds_write_b32 v28, v53 offset:864
  ds_write_b32 v28, v54 offset:960
  ds_write_b32 v28, v55 offset:1056
  ds_write_b32 v28, v56 offset:1536
  ds_write_b32 v28, v57 offset:1632
  ds_write_b32 v28, v58 offset:1728
  ds_write_b32 v28, v59 offset:1824
  ds_write_b32 v28, v60 offset:2304
  ds_write_b32 v28, v61 offset:2400
  ds_write_b32 v28, v62 offset:2496
  ds_write_b32 v28, v63 offset:2592
  ds_write_b32 v28, v64 offset:3072
  ds_write_b32 v28, v65 offset:3168
  ds_write_b32 v28, v66 offset:3264
  ds_write_b32 v28, v67 offset:3360
  s_mov_b64 exec, s[50:51]
  s_waitcnt lgkmcnt(0)
  ds_read_b128 v[80:83], v31 offset:0
  ds_read_b128 v[84:87], v31 offset:1024
  ds_read_b128 v[88:91], v31 offset:2048
  ds_read_b128 v[92:95], v31 offset:3072
  v_mov_b32 v29, 0x7fff0000
  v_cmp_gt_u32 vcc, 48, v1
  s_nop 1
  v_cndmask_b32 v29, v29, v30, vcc
  s_waitcnt lgkmcnt(3)
  buffer_store_dwordx4 v[80:83], v30, s[24:27], s45 offen offset:0 sc1
  s_waitcnt lgkmcnt(2)
  buffer_store_dwordx4 v[84:87], v30, s[24:27], s45 offen offset:1024 sc1
  s_waitcnt lgkmcnt(1)
  buffer_store_dwordx4 v[88:91], v30, s[24:27], s45 offen offset:2048 sc1
  s_waitcnt lgkmcnt(0)
  buffer_store_dwordx4 v[92:95], v29, s[24:27], s45 offen offset:3072 sc1
  s_barrier
L_parallel_sum__linear_kernel_hedgehog__mixer_channel_mlp__prompt_kernel_phase_b:
  s_cmp_eq_u32 s37, 0
  s_cbranch_scc1 L_parallel_sum__linear_kernel_hedgehog__mixer_channel_mlp__prompt_kernel_cb_kv
  v_and_b32 v16, 15, v1
  v_lshrrev_b32 v17, 4, v1
  s_lshl_b32 s45, s86, 4
  v_add_u32 v19, s45, v16
  v_mul_u32_u24 v24, 1280, v19
  s_mul_i32 s45, s69, 160
  v_lshl_add_u32 v25, v17, 3, s45
  v_add_u32 v24, v24, v25
  v_lshlrev_b32 v22, 4, v1
  s_lshl_b32 s44, s39, 12
  s_add_u32 s44, s44, 20480
  v_add_u32 v4, 0, v22
  v_add_u32 v8, s44, v4
  v_add_u32 v5, 36864, v22
  v_add_u32 v9, s44, v5
  v_add_u32 v6, 73728, v22
  v_add_u32 v10, s44, v6
  v_add_u32 v7, 110592, v22
  v_add_u32 v11, s44, v7
  v_mov_b32 v32, 0
  v_mov_b32 v33, 0
  v_mov_b32 v34, 0
  v_mov_b32 v35, 0
  v_mov_b32 v36, 0
  v_mov_b32 v37, 0
  v_mov_b32 v38, 0
  v_mov_b32 v39, 0
  v_mov_b32 v40, 0
  v_mov_b32 v41, 0
  v_mov_b32 v42, 0
  v_mov_b32 v43, 0
  v_mov_b32 v44, 0
  v_mov_b32 v45, 0
  v_mov_b32 v46, 0
  v_mov_b32 v47, 0
  v_mov_b32 v48, 0
  v_mov_b32 v49, 0
  v_mov_b32 v50, 0
  v_mov_b32 v51, 0
  v_lshrrev_b32 v26, 2, v1
  v_and_b32 v26, 3, v26
  v_and_b32 v27, 3, v1
  v_lshlrev_b32 v28, 10, v17
  v_mul_u32_u24 v29, 40, v26
  v_add_u32 v28, v28, v29
  v_add_u32 v28, 147456, v28
  v_mov_b32 v29, 159232
  v_cmp_eq_u32 vcc, v27, v17
  s_nop 1
  v_cndmask_b32 v28, v29, v28, vcc
  v_mul_u32_u24 v30, 1920, v17
  v_mul_u32_u24 v31, 48, v26
  v_add_u32 v30, v30, v31
  v_add_u32 v30, 151552, v30
  v_cndmask_b32 v30, v29, v30, vcc
  s_barrier
  ds_read_b128 v[64:67], v8 offset:0
  ds_read_b128 v[68:71], v4 offset:0
  ds_read_b128 v[72:75], v4 offset:1024
  ds_read_b128 v[76:79], v4 offset:2048
  ds_read_b128 v[80:83], v4 offset:3072
  ds_read_b128 v[84:87], v4 offset:4096
  ds_read_b128 v[88:91], v8 offset:1024
  ds_read_b128 v[92:95], v4 offset:5120
  ds_read_b128 v[96:99], v4 offset:6144
  ds_read_b128 v[100:103], v4 offset:7168
  ds_read_b128 v[104:107], v4 offset:8192
  ds_read_b128 v[108:111], v4 offset:9216
  s_waitcnt lgkmcnt(6)
  v_mfma_f32_16x16x32_bf16 v[32:35], v[68:71], v[64:67], v[32:35]
  ds_read_b128 v[112:115], v8 offset:2048
  v_mfma_f32_16x16x32_bf16 v[36:39], v[72:75], v[64:67], v[36:39]
  ds_read_b128 v[116:119], v4 offset:10240
  v_mfma_f32_16x16x32_bf16 v[40:43], v[76:79], v[64:67], v[40:43]
  ds_read_b128 v[120:123], v4 offset:11264
  v_mfma_f32_16x16x32_bf16 v[44:47], v[80:83], v[64:67], v[44:47]
  ds_read_b128 v[124:127], v4 offset:12288
  v_mfma_f32_16x16x32_bf16 v[48:51], v[84:87], v[64:67], v[48:51]
  ds_read_b128 v[128:131], v4 offset:13312
  ds_read_b128 v[132:135], v4 offset:14336
  s_waitcnt lgkmcnt(6)
  v_mfma_f32_16x16x32_bf16 v[32:35], v[92:95], v[88:91], v[32:35]
  ds_read_b128 v[136:139], v8 offset:3072
  v_mfma_f32_16x16x32_bf16 v[36:39], v[96:99], v[88:91], v[36:39]
  ds_read_b128 v[140:143], v4 offset:15360
  v_mfma_f32_16x16x32_bf16 v[40:43], v[100:103], v[88:91], v[40:43]
  ds_read_b128 v[144:147], v4 offset:16384
  v_mfma_f32_16x16x32_bf16 v[44:47], v[104:107], v[88:91], v[44:47]
  ds_read_b128 v[148:151], v4 offset:17408
  v_mfma_f32_16x16x32_bf16 v[48:51], v[108:111], v[88:91], v[48:51]
  ds_read_b128 v[152:155], v4 offset:18432
  ds_read_b128 v[156:159], v4 offset:19456
  s_waitcnt lgkmcnt(0)
  s_barrier
  v_and_b32 v12, 15, v1
  v_lshrrev_b32 v13, 4, v1
  v_mul_u32_u24 v14, 640, v13
  v_lshl_add_u32 v14, v12, 3, v14
  s_mul_i32 s58, s86, 160
  s_mul_i32 s59, s69, 20
  s_add_u32 s58, s58, s59
  s_lshl_b32 s58, s58, 7
  s_add_u32 s58, s58, 524288
  s_lshl_b32 s59, s86, 4
  v_add_u32 v15, s59, v12
  v_lshlrev_b32 v15, 4, v15
  buffer_load_dwordx2 v[172:173], v14, s[24:27], s58 offen offset:0 sc1
  buffer_load_dwordx2 v[174:175], v14, s[24:27], s58 offen offset:128 sc1
  buffer_load_dwordx2 v[176:177], v14, s[24:27], s58 offen offset:256 sc1
  buffer_load_dwordx2 v[178:179], v14, s[24:27], s58 offen offset:384 sc1
  buffer_load_dwordx2 v[180:181], v14, s[24:27], s58 offen offset:512 sc1
  buffer_load_dword v21, v15, s[24:27], 0 offen offset:4 sc1
  v_mfma_f32_16x16x32_bf16 v[32:35], v[116:119], v[112:115], v[32:35]
  ds_read_b128 v[64:67], v9 offset:0
  v_mfma_f32_16x16x32_bf16 v[36:39], v[120:123], v[112:115], v[36:39]
  ds_read_b128 v[68:71], v5 offset:0
  v_mfma_f32_16x16x32_bf16 v[40:43], v[124:127], v[112:115], v[40:43]
  ds_read_b128 v[72:75], v5 offset:1024
  v_mfma_f32_16x16x32_bf16 v[44:47], v[128:131], v[112:115], v[44:47]
  ds_read_b128 v[76:79], v5 offset:2048
  v_mfma_f32_16x16x32_bf16 v[48:51], v[132:135], v[112:115], v[48:51]
  ds_read_b128 v[80:83], v5 offset:3072
  ds_read_b128 v[84:87], v5 offset:4096
  v_mfma_f32_16x16x32_bf16 v[32:35], v[140:143], v[136:139], v[32:35]
  ds_read_b128 v[88:91], v9 offset:1024
  v_mfma_f32_16x16x32_bf16 v[36:39], v[144:147], v[136:139], v[36:39]
  ds_read_b128 v[92:95], v5 offset:5120
  v_mfma_f32_16x16x32_bf16 v[40:43], v[148:151], v[136:139], v[40:43]
  ds_read_b128 v[96:99], v5 offset:6144
  v_mfma_f32_16x16x32_bf16 v[44:47], v[152:155], v[136:139], v[44:47]
  ds_read_b128 v[100:103], v5 offset:7168
  v_mfma_f32_16x16x32_bf16 v[48:51], v[156:159], v[136:139], v[48:51]
  ds_read_b128 v[104:107], v5 offset:8192
  ds_read_b128 v[108:111], v5 offset:9216
  s_waitcnt lgkmcnt(6)
  v_mfma_f32_16x16x32_bf16 v[32:35], v[68:71], v[64:67], v[32:35]
  ds_read_b128 v[112:115], v9 offset:2048
  v_mfma_f32_16x16x32_bf16 v[36:39], v[72:75], v[64:67], v[36:39]
  ds_read_b128 v[116:119], v5 offset:10240
  v_mfma_f32_16x16x32_bf16 v[40:43], v[76:79], v[64:67], v[40:43]
  ds_read_b128 v[120:123], v5 offset:11264
  v_mfma_f32_16x16x32_bf16 v[44:47], v[80:83], v[64:67], v[44:47]
  ds_read_b128 v[124:127], v5 offset:12288
  v_mfma_f32_16x16x32_bf16 v[48:51], v[84:87], v[64:67], v[48:51]
  ds_read_b128 v[128:131], v5 offset:13312
  ds_read_b128 v[132:135], v5 offset:14336
  s_waitcnt lgkmcnt(6)
  v_mfma_f32_16x16x32_bf16 v[32:35], v[92:95], v[88:91], v[32:35]
  ds_read_b128 v[136:139], v9 offset:3072
  v_mfma_f32_16x16x32_bf16 v[36:39], v[96:99], v[88:91], v[36:39]
  ds_read_b128 v[140:143], v5 offset:15360
  v_mfma_f32_16x16x32_bf16 v[40:43], v[100:103], v[88:91], v[40:43]
  ds_read_b128 v[144:147], v5 offset:16384
  v_mfma_f32_16x16x32_bf16 v[44:47], v[104:107], v[88:91], v[44:47]
  ds_read_b128 v[148:151], v5 offset:17408
  v_mfma_f32_16x16x32_bf16 v[48:51], v[108:111], v[88:91], v[48:51]
  ds_read_b128 v[152:155], v5 offset:18432
  ds_read_b128 v[156:159], v5 offset:19456
  s_waitcnt lgkmcnt(0)
  s_cmp_eq_u32 s37, 0
  s_cbranch_scc1 L_parallel_sum__linear_kernel_hedgehog__mixer_channel_mlp__prompt_kernel_g_h2w
  s_waitcnt vmcnt(6)
L_parallel_sum__linear_kernel_hedgehog__mixer_channel_mlp__prompt_kernel_g_h2w:
  s_barrier
  s_cmp_eq_u32 s37, 0
  s_cbranch_scc1 L_parallel_sum__linear_kernel_hedgehog__mixer_channel_mlp__prompt_kernel_g_fh2_b
  s_cmp_eq_u32 s39, 0
  s_cbranch_scc0 L_parallel_sum__linear_kernel_hedgehog__mixer_channel_mlp__prompt_kernel_g_fh2
  s_lshl_b32 s41, s36, 1
  s_lshr_b32 s42, s38, 2
  s_add_u32 s41, s41, s42
  s_lshl_b32 s41, s41, 7
  s_and_b32 s42, s38, 3
  s_add_u32 s41, s41, s42
  s_add_u32 s41, s41, 20977664
  v_mov_b32 v2, s41
  v_mov_b32 v0, 1
  s_mov_b64 exec, 1
  buffer_store_byte v0, v2, s[24:27], 0 offen sc1
  s_mov_b64 exec, -1
L_parallel_sum__linear_kernel_hedgehog__mixer_channel_mlp__prompt_kernel_g_fh2:
L_parallel_sum__linear_kernel_hedgehog__mixer_channel_mlp__prompt_kernel_g_fh2_b:
  v_mfma_f32_16x16x32_bf16 v[32:35], v[116:119], v[112:115], v[32:35]
  ds_read_b128 v[64:67], v10 offset:0
  v_mfma_f32_16x16x32_bf16 v[36:39], v[120:123], v[112:115], v[36:39]
  ds_read_b128 v[68:71], v6 offset:0
  v_mfma_f32_16x16x32_bf16 v[40:43], v[124:127], v[112:115], v[40:43]
  ds_read_b128 v[72:75], v6 offset:1024
  v_mfma_f32_16x16x32_bf16 v[44:47], v[128:131], v[112:115], v[44:47]
  ds_read_b128 v[76:79], v6 offset:2048
  v_mfma_f32_16x16x32_bf16 v[48:51], v[132:135], v[112:115], v[48:51]
  ds_read_b128 v[80:83], v6 offset:3072
  ds_read_b128 v[84:87], v6 offset:4096
  v_mfma_f32_16x16x32_bf16 v[32:35], v[140:143], v[136:139], v[32:35]
  ds_read_b128 v[88:91], v10 offset:1024
  v_mfma_f32_16x16x32_bf16 v[36:39], v[144:147], v[136:139], v[36:39]
  ds_read_b128 v[92:95], v6 offset:5120
  v_mfma_f32_16x16x32_bf16 v[40:43], v[148:151], v[136:139], v[40:43]
  ds_read_b128 v[96:99], v6 offset:6144
  v_mfma_f32_16x16x32_bf16 v[44:47], v[152:155], v[136:139], v[44:47]
  ds_read_b128 v[100:103], v6 offset:7168
  v_mfma_f32_16x16x32_bf16 v[48:51], v[156:159], v[136:139], v[48:51]
  ds_read_b128 v[104:107], v6 offset:8192
  ds_read_b128 v[108:111], v6 offset:9216
  s_waitcnt lgkmcnt(6)
  v_mfma_f32_16x16x32_bf16 v[32:35], v[68:71], v[64:67], v[32:35]
  ds_read_b128 v[112:115], v10 offset:2048
  v_mfma_f32_16x16x32_bf16 v[36:39], v[72:75], v[64:67], v[36:39]
  ds_read_b128 v[116:119], v6 offset:10240
  v_mfma_f32_16x16x32_bf16 v[40:43], v[76:79], v[64:67], v[40:43]
  ds_read_b128 v[120:123], v6 offset:11264
  v_mfma_f32_16x16x32_bf16 v[44:47], v[80:83], v[64:67], v[44:47]
  ds_read_b128 v[124:127], v6 offset:12288
  v_mfma_f32_16x16x32_bf16 v[48:51], v[84:87], v[64:67], v[48:51]
  ds_read_b128 v[128:131], v6 offset:13312
  ds_read_b128 v[132:135], v6 offset:14336
  s_waitcnt lgkmcnt(6)
  v_mfma_f32_16x16x32_bf16 v[32:35], v[92:95], v[88:91], v[32:35]
  ds_read_b128 v[136:139], v10 offset:3072
  v_mfma_f32_16x16x32_bf16 v[36:39], v[96:99], v[88:91], v[36:39]
  ds_read_b128 v[140:143], v6 offset:15360
  v_mfma_f32_16x16x32_bf16 v[40:43], v[100:103], v[88:91], v[40:43]
  ds_read_b128 v[144:147], v6 offset:16384
  v_mfma_f32_16x16x32_bf16 v[44:47], v[104:107], v[88:91], v[44:47]
  ds_read_b128 v[148:151], v6 offset:17408
  v_mfma_f32_16x16x32_bf16 v[48:51], v[108:111], v[88:91], v[48:51]
  ds_read_b128 v[152:155], v6 offset:18432
  ds_read_b128 v[156:159], v6 offset:19456
  s_waitcnt lgkmcnt(0)
  s_barrier
  v_mfma_f32_16x16x32_bf16 v[32:35], v[116:119], v[112:115], v[32:35]
  ds_read_b128 v[64:67], v11 offset:0
  v_mfma_f32_16x16x32_bf16 v[36:39], v[120:123], v[112:115], v[36:39]
  ds_read_b128 v[68:71], v7 offset:0
  v_mfma_f32_16x16x32_bf16 v[40:43], v[124:127], v[112:115], v[40:43]
  ds_read_b128 v[72:75], v7 offset:1024
  v_mfma_f32_16x16x32_bf16 v[44:47], v[128:131], v[112:115], v[44:47]
  ds_read_b128 v[76:79], v7 offset:2048
  v_mfma_f32_16x16x32_bf16 v[48:51], v[132:135], v[112:115], v[48:51]
  ds_read_b128 v[80:83], v7 offset:3072
  ds_read_b128 v[84:87], v7 offset:4096
  v_mfma_f32_16x16x32_bf16 v[32:35], v[140:143], v[136:139], v[32:35]
  ds_read_b128 v[88:91], v11 offset:1024
  v_mfma_f32_16x16x32_bf16 v[36:39], v[144:147], v[136:139], v[36:39]
  ds_read_b128 v[92:95], v7 offset:5120
  v_mfma_f32_16x16x32_bf16 v[40:43], v[148:151], v[136:139], v[40:43]
  ds_read_b128 v[96:99], v7 offset:6144
  v_mfma_f32_16x16x32_bf16 v[44:47], v[152:155], v[136:139], v[44:47]
  ds_read_b128 v[100:103], v7 offset:7168
  v_mfma_f32_16x16x32_bf16 v[48:51], v[156:159], v[136:139], v[48:51]
  ds_read_b128 v[104:107], v7 offset:8192
  ds_read_b128 v[108:111], v7 offset:9216
  ds_read_b64_tr_b16 v[112:113], v28 offset:0
  ds_read_b64_tr_b16 v[114:115], v28 offset:160
  ds_read_b64_tr_b16 v[116:117], v28 offset:320
  ds_read_b64_tr_b16 v[118:119], v28 offset:480
  ds_read_b64_tr_b16 v[120:121], v28 offset:640
  v_mov_b32 v122, 0
  v_mov_b32 v123, 0
  ds_read_b64_tr_b16 v[124:125], v28 offset:8
  ds_read_b64_tr_b16 v[126:127], v28 offset:168
  ds_read_b64_tr_b16 v[128:129], v28 offset:328
  ds_read_b64_tr_b16 v[130:131], v28 offset:488
  ds_read_b64_tr_b16 v[132:133], v28 offset:648
  v_mov_b32 v134, 0
  v_mov_b32 v135, 0
  ds_read_b64_tr_b16 v[136:137], v28 offset:16
  ds_read_b64_tr_b16 v[138:139], v28 offset:176
  ds_read_b64_tr_b16 v[140:141], v28 offset:336
  ds_read_b64_tr_b16 v[142:143], v28 offset:496
  ds_read_b64_tr_b16 v[144:145], v28 offset:656
  v_mov_b32 v146, 0
  v_mov_b32 v147, 0
  ds_read_b64_tr_b16 v[148:149], v28 offset:24
  ds_read_b64_tr_b16 v[150:151], v28 offset:184
  ds_read_b64_tr_b16 v[152:153], v28 offset:344
  ds_read_b64_tr_b16 v[154:155], v28 offset:504
  ds_read_b64_tr_b16 v[156:157], v28 offset:664
  v_mov_b32 v158, 0
  v_mov_b32 v159, 0
  ds_read_b64_tr_b16 v[160:161], v28 offset:32
  ds_read_b64_tr_b16 v[162:163], v28 offset:192
  ds_read_b64_tr_b16 v[164:165], v28 offset:352
  ds_read_b64_tr_b16 v[166:167], v28 offset:512
  ds_read_b64_tr_b16 v[168:169], v28 offset:672
  v_mov_b32 v170, 0
  v_mov_b32 v171, 0
  v_mov_b32 v182, 0
  v_mov_b32 v183, 0
  s_waitcnt vmcnt(0)
  s_waitcnt lgkmcnt(0)
  v_mfma_f32_16x16x32_bf16 v[184:187], v[112:115], v[172:175], 0
  v_mfma_f32_16x16x32_bf16 v[188:191], v[124:127], v[172:175], 0
  v_mfma_f32_16x16x32_bf16 v[192:195], v[136:139], v[172:175], 0
  v_mfma_f32_16x16x32_bf16 v[196:199], v[148:151], v[172:175], 0
  v_mfma_f32_16x16x32_bf16 v[200:203], v[160:163], v[172:175], 0
  v_mfma_f32_16x16x32_bf16 v[184:187], v[116:119], v[176:179], v[184:187]
  v_mfma_f32_16x16x32_bf16 v[188:191], v[128:131], v[176:179], v[188:191]
  v_mfma_f32_16x16x32_bf16 v[192:195], v[140:143], v[176:179], v[192:195]
  v_mfma_f32_16x16x32_bf16 v[196:199], v[152:155], v[176:179], v[196:199]
  v_mfma_f32_16x16x32_bf16 v[200:203], v[164:167], v[176:179], v[200:203]
  v_mfma_f32_16x16x32_bf16 v[184:187], v[120:123], v[180:183], v[184:187]
  v_mfma_f32_16x16x32_bf16 v[188:191], v[132:135], v[180:183], v[188:191]
  v_mfma_f32_16x16x32_bf16 v[192:195], v[144:147], v[180:183], v[192:195]
  v_mfma_f32_16x16x32_bf16 v[196:199], v[156:159], v[180:183], v[196:199]
  v_mfma_f32_16x16x32_bf16 v[200:203], v[168:171], v[180:183], v[200:203]
  s_nop 3
  v_max3_f32 v52, v184, v185, v186
  v_min3_f32 v53, v184, v185, v186
  v_max3_f32 v54, v187, v188, v189
  v_min3_f32 v55, v187, v188, v189
  v_max3_f32 v52, v52, v190, v191
  v_min3_f32 v53, v53, v190, v191
  v_max3_f32 v54, v54, v192, v193
  v_min3_f32 v55, v55, v192, v193
  v_max3_f32 v52, v52, v194, v195
  v_min3_f32 v53, v53, v194, v195
  v_max3_f32 v54, v54, v196, v197
  v_min3_f32 v55, v55, v196, v197
  v_max3_f32 v52, v52, v198, v199
  v_min3_f32 v53, v53, v198, v199
  v_max3_f32 v54, v54, v200, v201
  v_min3_f32 v55, v55, v200, v201
  v_max3_f32 v52, v52, v202, v203
  v_min3_f32 v53, v53, v202, v203
  v_max_f32 v52, v52, v54
  v_min_f32 v53, v53, v55
  v_mul_f32 v54, 0x3fb8aa3b, v21
  v_mov_b32 v55, v54
  v_mul_f32 v2, v52, v54
  v_mul_f32 v0, v53, v54
  v_sub_f32 v52, 0, v2
  v_sub_f32 v53, 0, v2
  v_pk_fma_f32 v[112:113], v[184:185], v[54:55], v[52:53]
  v_pk_fma_f32 v[114:115], v[186:187], v[54:55], v[52:53]
  v_pk_fma_f32 v[116:117], v[188:189], v[54:55], v[52:53]
  v_pk_fma_f32 v[118:119], v[190:191], v[54:55], v[52:53]
  v_pk_fma_f32 v[120:121], v[192:193], v[54:55], v[52:53]
  v_pk_fma_f32 v[122:123], v[194:195], v[54:55], v[52:53]
  v_pk_fma_f32 v[124:125], v[196:197], v[54:55], v[52:53]
  v_pk_fma_f32 v[126:127], v[198:199], v[54:55], v[52:53]
  v_pk_fma_f32 v[128:129], v[200:201], v[54:55], v[52:53]
  v_pk_fma_f32 v[130:131], v[202:203], v[54:55], v[52:53]
  v_mov_b32 v52, v0
  v_mov_b32 v53, v0
  v_pk_fma_f32 v[132:133], v[184:185], v[54:55], v[52:53] neg_lo:[1,0,0] neg_hi:[1,0,0]
  v_pk_fma_f32 v[134:135], v[186:187], v[54:55], v[52:53] neg_lo:[1,0,0] neg_hi:[1,0,0]
  v_pk_fma_f32 v[136:137], v[188:189], v[54:55], v[52:53] neg_lo:[1,0,0] neg_hi:[1,0,0]
  v_pk_fma_f32 v[138:139], v[190:191], v[54:55], v[52:53] neg_lo:[1,0,0] neg_hi:[1,0,0]
  v_pk_fma_f32 v[140:141], v[192:193], v[54:55], v[52:53] neg_lo:[1,0,0] neg_hi:[1,0,0]
  v_pk_fma_f32 v[142:143], v[194:195], v[54:55], v[52:53] neg_lo:[1,0,0] neg_hi:[1,0,0]
  v_pk_fma_f32 v[144:145], v[196:197], v[54:55], v[52:53] neg_lo:[1,0,0] neg_hi:[1,0,0]
  v_pk_fma_f32 v[146:147], v[198:199], v[54:55], v[52:53] neg_lo:[1,0,0] neg_hi:[1,0,0]
  v_pk_fma_f32 v[148:149], v[200:201], v[54:55], v[52:53] neg_lo:[1,0,0] neg_hi:[1,0,0]
  v_pk_fma_f32 v[150:151], v[202:203], v[54:55], v[52:53] neg_lo:[1,0,0] neg_hi:[1,0,0]
  v_exp_f32 v112, v112
  v_exp_f32 v113, v113
  v_exp_f32 v114, v114
  v_exp_f32 v115, v115
  v_exp_f32 v116, v116
  v_exp_f32 v117, v117
  v_exp_f32 v118, v118
  v_exp_f32 v119, v119
  v_exp_f32 v120, v120
  v_exp_f32 v121, v121
  v_exp_f32 v122, v122
  v_exp_f32 v123, v123
  v_exp_f32 v124, v124
  v_exp_f32 v125, v125
  v_exp_f32 v126, v126
  v_exp_f32 v127, v127
  v_exp_f32 v128, v128
  v_exp_f32 v129, v129
  v_exp_f32 v130, v130
  v_exp_f32 v131, v131
  v_exp_f32 v132, v132
  v_exp_f32 v133, v133
  v_exp_f32 v134, v134
  v_exp_f32 v135, v135
  v_exp_f32 v136, v136
  v_exp_f32 v137, v137
  v_exp_f32 v138, v138
  v_exp_f32 v139, v139
  v_exp_f32 v140, v140
  v_exp_f32 v141, v141
  v_exp_f32 v142, v142
  v_exp_f32 v143, v143
  v_exp_f32 v144, v144
  v_exp_f32 v145, v145
  v_exp_f32 v146, v146
  v_exp_f32 v147, v147
  v_exp_f32 v148, v148
  v_exp_f32 v149, v149
  v_exp_f32 v150, v150
  v_exp_f32 v151, v151
  v_pk_add_f32 v[52:53], v[112:113], v[114:115]
  v_pk_add_f32 v[54:55], v[132:133], v[134:135]
  v_pk_add_f32 v[52:53], v[52:53], v[116:117]
  v_pk_add_f32 v[54:55], v[54:55], v[136:137]
  v_pk_add_f32 v[52:53], v[52:53], v[118:119]
  v_pk_add_f32 v[54:55], v[54:55], v[138:139]
  v_pk_add_f32 v[52:53], v[52:53], v[120:121]
  v_pk_add_f32 v[54:55], v[54:55], v[140:141]
  v_pk_add_f32 v[52:53], v[52:53], v[122:123]
  v_pk_add_f32 v[54:55], v[54:55], v[142:143]
  v_pk_add_f32 v[52:53], v[52:53], v[124:125]
  v_pk_add_f32 v[54:55], v[54:55], v[144:145]
  v_pk_add_f32 v[52:53], v[52:53], v[126:127]
  v_pk_add_f32 v[54:55], v[54:55], v[146:147]
  v_pk_add_f32 v[52:53], v[52:53], v[128:129]
  v_pk_add_f32 v[54:55], v[54:55], v[148:149]
  v_pk_add_f32 v[52:53], v[52:53], v[130:131]
  v_pk_add_f32 v[54:55], v[54:55], v[150:151]
  v_add_f32 v52, v52, v53
  v_add_f32 v54, v54, v55
  v_rcp_f32 v52, v52
  v_rcp_f32 v54, v54
  v_mov_b32 v53, v52
  v_mov_b32 v55, v54
  v_pk_mul_f32 v[112:113], v[112:113], v[52:53]
  v_pk_mul_f32 v[132:133], v[132:133], v[54:55]
  v_pk_mul_f32 v[114:115], v[114:115], v[52:53]
  v_pk_mul_f32 v[134:135], v[134:135], v[54:55]
  v_pk_mul_f32 v[116:117], v[116:117], v[52:53]
  v_pk_mul_f32 v[136:137], v[136:137], v[54:55]
  v_pk_mul_f32 v[118:119], v[118:119], v[52:53]
  v_pk_mul_f32 v[138:139], v[138:139], v[54:55]
  v_pk_mul_f32 v[120:121], v[120:121], v[52:53]
  v_pk_mul_f32 v[140:141], v[140:141], v[54:55]
  v_pk_mul_f32 v[122:123], v[122:123], v[52:53]
  v_pk_mul_f32 v[142:143], v[142:143], v[54:55]
  v_pk_mul_f32 v[124:125], v[124:125], v[52:53]
  v_pk_mul_f32 v[144:145], v[144:145], v[54:55]
  v_pk_mul_f32 v[126:127], v[126:127], v[52:53]
  v_pk_mul_f32 v[146:147], v[146:147], v[54:55]
  v_pk_mul_f32 v[128:129], v[128:129], v[52:53]
  v_pk_mul_f32 v[148:149], v[148:149], v[54:55]
  v_pk_mul_f32 v[130:131], v[130:131], v[52:53]
  v_pk_mul_f32 v[150:151], v[150:151], v[54:55]
  v_cvt_pk_bf16_f32 v160, v112, v113
  v_cvt_pk_bf16_f32 v161, v114, v115
  v_cvt_pk_bf16_f32 v162, v116, v117
  v_cvt_pk_bf16_f32 v163, v118, v119
  v_cvt_pk_bf16_f32 v164, v120, v121
  v_cvt_pk_bf16_f32 v165, v122, v123
  v_cvt_pk_bf16_f32 v166, v124, v125
  v_cvt_pk_bf16_f32 v167, v126, v127
  v_cvt_pk_bf16_f32 v168, v128, v129
  v_cvt_pk_bf16_f32 v169, v130, v131
  v_cvt_pk_bf16_f32 v170, v132, v133
  v_cvt_pk_bf16_f32 v171, v134, v135
  v_cvt_pk_bf16_f32 v172, v136, v137
  v_cvt_pk_bf16_f32 v173, v138, v139
  v_cvt_pk_bf16_f32 v174, v140, v141
  v_cvt_pk_bf16_f32 v175, v142, v143
  v_cvt_pk_bf16_f32 v176, v144, v145
  v_cvt_pk_bf16_f32 v177, v146, v147
  v_cvt_pk_bf16_f32 v178, v148, v149
  v_cvt_pk_bf16_f32 v179, v150, v151
  v_mfma_f32_16x16x32_bf16 v[32:35], v[68:71], v[64:67], v[32:35]
  ds_read_b128 v[112:115], v11 offset:2048
  v_mfma_f32_16x16x32_bf16 v[36:39], v[72:75], v[64:67], v[36:39]
  ds_read_b128 v[116:119], v7 offset:10240
  v_mfma_f32_16x16x32_bf16 v[40:43], v[76:79], v[64:67], v[40:43]
  ds_read_b128 v[120:123], v7 offset:11264
  v_mfma_f32_16x16x32_bf16 v[44:47], v[80:83], v[64:67], v[44:47]
  ds_read_b128 v[124:127], v7 offset:12288
  v_mfma_f32_16x16x32_bf16 v[48:51], v[84:87], v[64:67], v[48:51]
  ds_read_b128 v[128:131], v7 offset:13312
  ds_read_b128 v[132:135], v7 offset:14336
  v_mfma_f32_16x16x32_bf16 v[32:35], v[92:95], v[88:91], v[32:35]
  ds_read_b128 v[136:139], v11 offset:3072
  v_mfma_f32_16x16x32_bf16 v[36:39], v[96:99], v[88:91], v[36:39]
  ds_read_b128 v[140:143], v7 offset:15360
  v_mfma_f32_16x16x32_bf16 v[40:43], v[100:103], v[88:91], v[40:43]
  ds_read_b128 v[144:147], v7 offset:16384
  v_mfma_f32_16x16x32_bf16 v[44:47], v[104:107], v[88:91], v[44:47]
  ds_read_b128 v[148:151], v7 offset:17408
  v_mfma_f32_16x16x32_bf16 v[48:51], v[108:111], v[88:91], v[48:51]
  ds_read_b128 v[152:155], v7 offset:18432
  ds_read_b128 v[156:159], v7 offset:19456
  s_waitcnt lgkmcnt(0)
  s_barrier
  v_mfma_f32_16x16x32_bf16 v[32:35], v[116:119], v[112:115], v[32:35]
  ds_read_b128 v[64:67], v8 offset:0
  v_mfma_f32_16x16x32_bf16 v[36:39], v[120:123], v[112:115], v[36:39]
  ds_read_b128 v[68:71], v4 offset:0
  v_mfma_f32_16x16x32_bf16 v[40:43], v[124:127], v[112:115], v[40:43]
  ds_read_b128 v[72:75], v4 offset:1024
  v_mfma_f32_16x16x32_bf16 v[44:47], v[128:131], v[112:115], v[44:47]
  ds_read_b128 v[76:79], v4 offset:2048
  v_mfma_f32_16x16x32_bf16 v[48:51], v[132:135], v[112:115], v[48:51]
  ds_read_b128 v[80:83], v4 offset:3072
  ds_read_b128 v[84:87], v4 offset:4096
  v_mfma_f32_16x16x32_bf16 v[32:35], v[140:143], v[136:139], v[32:35]
  ds_read_b128 v[88:91], v8 offset:1024
  v_mfma_f32_16x16x32_bf16 v[36:39], v[144:147], v[136:139], v[36:39]
  ds_read_b128 v[92:95], v4 offset:5120
  v_mfma_f32_16x16x32_bf16 v[40:43], v[148:151], v[136:139], v[40:43]
  ds_read_b128 v[96:99], v4 offset:6144
  v_mfma_f32_16x16x32_bf16 v[44:47], v[152:155], v[136:139], v[44:47]
  ds_read_b128 v[100:103], v4 offset:7168
  v_mfma_f32_16x16x32_bf16 v[48:51], v[156:159], v[136:139], v[48:51]
  ds_read_b128 v[104:107], v4 offset:8192
  ds_read_b128 v[108:111], v4 offset:9216
  s_waitcnt lgkmcnt(6)
  v_mfma_f32_16x16x32_bf16 v[32:35], v[68:71], v[64:67], v[32:35]
  ds_read_b128 v[112:115], v8 offset:2048
  v_mfma_f32_16x16x32_bf16 v[36:39], v[72:75], v[64:67], v[36:39]
  ds_read_b128 v[116:119], v4 offset:10240
  v_mfma_f32_16x16x32_bf16 v[40:43], v[76:79], v[64:67], v[40:43]
  ds_read_b128 v[120:123], v4 offset:11264
  v_mfma_f32_16x16x32_bf16 v[44:47], v[80:83], v[64:67], v[44:47]
  ds_read_b128 v[124:127], v4 offset:12288
  v_mfma_f32_16x16x32_bf16 v[48:51], v[84:87], v[64:67], v[48:51]
  ds_read_b128 v[128:131], v4 offset:13312
  ds_read_b128 v[132:135], v4 offset:14336
  s_waitcnt lgkmcnt(6)
  v_mfma_f32_16x16x32_bf16 v[32:35], v[92:95], v[88:91], v[32:35]
  ds_read_b128 v[136:139], v8 offset:3072
  v_mfma_f32_16x16x32_bf16 v[36:39], v[96:99], v[88:91], v[36:39]
  ds_read_b128 v[140:143], v4 offset:15360
  v_mfma_f32_16x16x32_bf16 v[40:43], v[100:103], v[88:91], v[40:43]
  ds_read_b128 v[144:147], v4 offset:16384
  v_mfma_f32_16x16x32_bf16 v[44:47], v[104:107], v[88:91], v[44:47]
  ds_read_b128 v[148:151], v4 offset:17408
  v_mfma_f32_16x16x32_bf16 v[48:51], v[108:111], v[88:91], v[48:51]
  ds_read_b128 v[152:155], v4 offset:18432
  ds_read_b128 v[156:159], v4 offset:19456
  s_waitcnt lgkmcnt(0)
  s_barrier
  v_mfma_f32_16x16x32_bf16 v[32:35], v[116:119], v[112:115], v[32:35]
  ds_read_b128 v[64:67], v9 offset:0
  v_mfma_f32_16x16x32_bf16 v[36:39], v[120:123], v[112:115], v[36:39]
  ds_read_b128 v[68:71], v5 offset:0
  v_mfma_f32_16x16x32_bf16 v[40:43], v[124:127], v[112:115], v[40:43]
  ds_read_b128 v[72:75], v5 offset:1024
  v_mfma_f32_16x16x32_bf16 v[44:47], v[128:131], v[112:115], v[44:47]
  ds_read_b128 v[76:79], v5 offset:2048
  v_mfma_f32_16x16x32_bf16 v[48:51], v[132:135], v[112:115], v[48:51]
  ds_read_b128 v[80:83], v5 offset:3072
  ds_read_b128 v[84:87], v5 offset:4096
  v_mfma_f32_16x16x32_bf16 v[32:35], v[140:143], v[136:139], v[32:35]
  ds_read_b128 v[88:91], v9 offset:1024
  v_mfma_f32_16x16x32_bf16 v[36:39], v[144:147], v[136:139], v[36:39]
  ds_read_b128 v[92:95], v5 offset:5120
  v_mfma_f32_16x16x32_bf16 v[40:43], v[148:151], v[136:139], v[40:43]
  ds_read_b128 v[96:99], v5 offset:6144
  v_mfma_f32_16x16x32_bf16 v[44:47], v[152:155], v[136:139], v[44:47]
  ds_read_b128 v[100:103], v5 offset:7168
  v_mfma_f32_16x16x32_bf16 v[48:51], v[156:159], v[136:139], v[48:51]
  ds_read_b128 v[104:107], v5 offset:8192
  ds_read_b128 v[108:111], v5 offset:9216
  s_waitcnt lgkmcnt(6)
  v_mfma_f32_16x16x32_bf16 v[32:35], v[68:71], v[64:67], v[32:35]
  ds_read_b128 v[112:115], v9 offset:2048
  v_mfma_f32_16x16x32_bf16 v[36:39], v[72:75], v[64:67], v[36:39]
  ds_read_b128 v[116:119], v5 offset:10240
  v_mfma_f32_16x16x32_bf16 v[40:43], v[76:79], v[64:67], v[40:43]
  ds_read_b128 v[120:123], v5 offset:11264
  v_mfma_f32_16x16x32_bf16 v[44:47], v[80:83], v[64:67], v[44:47]
  ds_read_b128 v[124:127], v5 offset:12288
  v_mfma_f32_16x16x32_bf16 v[48:51], v[84:87], v[64:67], v[48:51]
  ds_read_b128 v[128:131], v5 offset:13312
  ds_read_b128 v[132:135], v5 offset:14336
  s_waitcnt lgkmcnt(6)
  v_mfma_f32_16x16x32_bf16 v[32:35], v[92:95], v[88:91], v[32:35]
  ds_read_b128 v[136:139], v9 offset:3072
  v_mfma_f32_16x16x32_bf16 v[36:39], v[96:99], v[88:91], v[36:39]
  ds_read_b128 v[140:143], v5 offset:15360
  v_mfma_f32_16x16x32_bf16 v[40:43], v[100:103], v[88:91], v[40:43]
  ds_read_b128 v[144:147], v5 offset:16384
  v_mfma_f32_16x16x32_bf16 v[44:47], v[104:107], v[88:91], v[44:47]
  ds_read_b128 v[148:151], v5 offset:17408
  v_mfma_f32_16x16x32_bf16 v[48:51], v[108:111], v[88:91], v[48:51]
  ds_read_b128 v[152:155], v5 offset:18432
  ds_read_b128 v[156:159], v5 offset:19456
  s_waitcnt lgkmcnt(0)
  s_barrier
  v_mfma_f32_16x16x32_bf16 v[32:35], v[116:119], v[112:115], v[32:35]
  ds_read_b128 v[64:67], v10 offset:0
  v_mfma_f32_16x16x32_bf16 v[36:39], v[120:123], v[112:115], v[36:39]
  ds_read_b128 v[68:71], v6 offset:0
  v_mfma_f32_16x16x32_bf16 v[40:43], v[124:127], v[112:115], v[40:43]
  ds_read_b128 v[72:75], v6 offset:1024
  v_mfma_f32_16x16x32_bf16 v[44:47], v[128:131], v[112:115], v[44:47]
  ds_read_b128 v[76:79], v6 offset:2048
  v_mfma_f32_16x16x32_bf16 v[48:51], v[132:135], v[112:115], v[48:51]
  ds_read_b128 v[80:83], v6 offset:3072
  ds_read_b128 v[84:87], v6 offset:4096
  v_mfma_f32_16x16x32_bf16 v[32:35], v[140:143], v[136:139], v[32:35]
  ds_read_b128 v[88:91], v10 offset:1024
  v_mfma_f32_16x16x32_bf16 v[36:39], v[144:147], v[136:139], v[36:39]
  ds_read_b128 v[92:95], v6 offset:5120
  v_mfma_f32_16x16x32_bf16 v[40:43], v[148:151], v[136:139], v[40:43]
  ds_read_b128 v[96:99], v6 offset:6144
  v_mfma_f32_16x16x32_bf16 v[44:47], v[152:155], v[136:139], v[44:47]
  ds_read_b128 v[100:103], v6 offset:7168
  v_mfma_f32_16x16x32_bf16 v[48:51], v[156:159], v[136:139], v[48:51]
  ds_read_b128 v[104:107], v6 offset:8192
  ds_read_b128 v[108:111], v6 offset:9216
  s_waitcnt lgkmcnt(6)
  v_mfma_f32_16x16x32_bf16 v[32:35], v[68:71], v[64:67], v[32:35]
  ds_read_b128 v[112:115], v10 offset:2048
  v_mfma_f32_16x16x32_bf16 v[36:39], v[72:75], v[64:67], v[36:39]
  ds_read_b128 v[116:119], v6 offset:10240
  v_mfma_f32_16x16x32_bf16 v[40:43], v[76:79], v[64:67], v[40:43]
  ds_read_b128 v[120:123], v6 offset:11264
  v_mfma_f32_16x16x32_bf16 v[44:47], v[80:83], v[64:67], v[44:47]
  ds_read_b128 v[124:127], v6 offset:12288
  v_mfma_f32_16x16x32_bf16 v[48:51], v[84:87], v[64:67], v[48:51]
  ds_read_b128 v[128:131], v6 offset:13312
  ds_read_b128 v[132:135], v6 offset:14336
  s_waitcnt lgkmcnt(6)
  v_mfma_f32_16x16x32_bf16 v[32:35], v[92:95], v[88:91], v[32:35]
  ds_read_b128 v[136:139], v10 offset:3072
  v_mfma_f32_16x16x32_bf16 v[36:39], v[96:99], v[88:91], v[36:39]
  ds_read_b128 v[140:143], v6 offset:15360
  v_mfma_f32_16x16x32_bf16 v[40:43], v[100:103], v[88:91], v[40:43]
  ds_read_b128 v[144:147], v6 offset:16384
  v_mfma_f32_16x16x32_bf16 v[44:47], v[104:107], v[88:91], v[44:47]
  ds_read_b128 v[148:151], v6 offset:17408
  v_mfma_f32_16x16x32_bf16 v[48:51], v[108:111], v[88:91], v[48:51]
  ds_read_b128 v[152:155], v6 offset:18432
  ds_read_b128 v[156:159], v6 offset:19456
  s_waitcnt lgkmcnt(0)
  s_barrier
  v_mfma_f32_16x16x32_bf16 v[32:35], v[116:119], v[112:115], v[32:35]
  ds_read_b128 v[64:67], v11 offset:0
  v_mfma_f32_16x16x32_bf16 v[36:39], v[120:123], v[112:115], v[36:39]
  ds_read_b128 v[68:71], v7 offset:0
  v_mfma_f32_16x16x32_bf16 v[40:43], v[124:127], v[112:115], v[40:43]
  ds_read_b128 v[72:75], v7 offset:1024
  v_mfma_f32_16x16x32_bf16 v[44:47], v[128:131], v[112:115], v[44:47]
  ds_read_b128 v[76:79], v7 offset:2048
  v_mfma_f32_16x16x32_bf16 v[48:51], v[132:135], v[112:115], v[48:51]
  ds_read_b128 v[80:83], v7 offset:3072
  ds_read_b128 v[84:87], v7 offset:4096
  v_mfma_f32_16x16x32_bf16 v[32:35], v[140:143], v[136:139], v[32:35]
  ds_read_b128 v[88:91], v11 offset:1024
  v_mfma_f32_16x16x32_bf16 v[36:39], v[144:147], v[136:139], v[36:39]
  ds_read_b128 v[92:95], v7 offset:5120
  v_mfma_f32_16x16x32_bf16 v[40:43], v[148:151], v[136:139], v[40:43]
  ds_read_b128 v[96:99], v7 offset:6144
  v_mfma_f32_16x16x32_bf16 v[44:47], v[152:155], v[136:139], v[44:47]
  ds_read_b128 v[100:103], v7 offset:7168
  v_mfma_f32_16x16x32_bf16 v[48:51], v[156:159], v[136:139], v[48:51]
  ds_read_b128 v[104:107], v7 offset:8192
  ds_read_b128 v[108:111], v7 offset:9216
  ds_read_b64_tr_b16 v[180:181], v30 offset:0
  ds_read_b64_tr_b16 v[182:183], v30 offset:192
  ds_read_b64_tr_b16 v[200:201], v30 offset:8
  ds_read_b64_tr_b16 v[202:203], v30 offset:200
  ds_read_b64_tr_b16 v[184:185], v30 offset:384
  ds_read_b64_tr_b16 v[186:187], v30 offset:576
  ds_read_b64_tr_b16 v[204:205], v30 offset:392
  ds_read_b64_tr_b16 v[206:207], v30 offset:584
  ds_read_b64_tr_b16 v[188:189], v30 offset:768
  ds_read_b64_tr_b16 v[190:191], v30 offset:960
  ds_read_b64_tr_b16 v[208:209], v30 offset:776
  ds_read_b64_tr_b16 v[210:211], v30 offset:968
  ds_read_b64_tr_b16 v[192:193], v30 offset:1152
  ds_read_b64_tr_b16 v[194:195], v30 offset:1344
  ds_read_b64_tr_b16 v[212:213], v30 offset:1160
  ds_read_b64_tr_b16 v[214:215], v30 offset:1352
  ds_read_b64_tr_b16 v[196:197], v30 offset:1536
  ds_read_b64_tr_b16 v[198:199], v30 offset:1728
  ds_read_b64_tr_b16 v[216:217], v30 offset:1544
  ds_read_b64_tr_b16 v[218:219], v30 offset:1736
  s_waitcnt lgkmcnt(15)
  v_mfma_f32_16x16x32_bf16 v[220:223], v[180:183], v[160:163], 0
  v_mfma_f32_16x16x32_bf16 v[224:227], v[200:203], v[160:163], 0
  ds_read_b64_tr_b16 v[112:113], v30 offset:16
  ds_read_b64_tr_b16 v[114:115], v30 offset:208
  ds_read_b64_tr_b16 v[132:133], v30 offset:24
  ds_read_b64_tr_b16 v[134:135], v30 offset:216
  s_waitcnt lgkmcnt(15)
  v_mfma_f32_16x16x32_bf16 v[220:223], v[184:187], v[164:167], v[220:223]
  v_mfma_f32_16x16x32_bf16 v[224:227], v[204:207], v[164:167], v[224:227]
  ds_read_b64_tr_b16 v[116:117], v30 offset:400
  ds_read_b64_tr_b16 v[118:119], v30 offset:592
  ds_read_b64_tr_b16 v[136:137], v30 offset:408
  ds_read_b64_tr_b16 v[138:139], v30 offset:600
  s_waitcnt lgkmcnt(15)
  v_mfma_f32_16x16x32_bf16 v[220:223], v[188:191], v[168:171], v[220:223]
  v_mfma_f32_16x16x32_bf16 v[224:227], v[208:211], v[168:171], v[224:227]
  ds_read_b64_tr_b16 v[120:121], v30 offset:784
  ds_read_b64_tr_b16 v[122:123], v30 offset:976
  ds_read_b64_tr_b16 v[140:141], v30 offset:792
  ds_read_b64_tr_b16 v[142:143], v30 offset:984
  s_waitcnt lgkmcnt(15)
  v_mfma_f32_16x16x32_bf16 v[220:223], v[192:195], v[172:175], v[220:223]
  v_mfma_f32_16x16x32_bf16 v[224:227], v[212:215], v[172:175], v[224:227]
  ds_read_b64_tr_b16 v[124:125], v30 offset:1168
  ds_read_b64_tr_b16 v[126:127], v30 offset:1360
  ds_read_b64_tr_b16 v[144:145], v30 offset:1176
  ds_read_b64_tr_b16 v[146:147], v30 offset:1368
  s_waitcnt lgkmcnt(15)
  v_mfma_f32_16x16x32_bf16 v[220:223], v[196:199], v[176:179], v[220:223]
  v_mfma_f32_16x16x32_bf16 v[224:227], v[216:219], v[176:179], v[224:227]
  ds_read_b64_tr_b16 v[128:129], v30 offset:1552
  ds_read_b64_tr_b16 v[130:131], v30 offset:1744
  ds_read_b64_tr_b16 v[148:149], v30 offset:1560
  ds_read_b64_tr_b16 v[150:151], v30 offset:1752
  s_waitcnt lgkmcnt(15)
  v_mfma_f32_16x16x32_bf16 v[228:231], v[112:115], v[160:163], 0
  v_mfma_f32_16x16x32_bf16 v[232:235], v[132:135], v[160:163], 0
  ds_read_b64_tr_b16 v[180:181], v30 offset:32
  ds_read_b64_tr_b16 v[182:183], v30 offset:224
  ds_read_b64_tr_b16 v[200:201], v30 offset:40
  ds_read_b64_tr_b16 v[202:203], v30 offset:232
  s_waitcnt lgkmcnt(15)
  v_mfma_f32_16x16x32_bf16 v[228:231], v[116:119], v[164:167], v[228:231]
  v_mfma_f32_16x16x32_bf16 v[232:235], v[136:139], v[164:167], v[232:235]
  ds_read_b64_tr_b16 v[184:185], v30 offset:416
  ds_read_b64_tr_b16 v[186:187], v30 offset:608
  ds_read_b64_tr_b16 v[204:205], v30 offset:424
  ds_read_b64_tr_b16 v[206:207], v30 offset:616
  s_waitcnt lgkmcnt(15)
  v_mfma_f32_16x16x32_bf16 v[228:231], v[120:123], v[168:171], v[228:231]
  v_mfma_f32_16x16x32_bf16 v[232:235], v[140:143], v[168:171], v[232:235]
  ds_read_b64_tr_b16 v[188:189], v30 offset:800
  ds_read_b64_tr_b16 v[190:191], v30 offset:992
  ds_read_b64_tr_b16 v[208:209], v30 offset:808
  ds_read_b64_tr_b16 v[210:211], v30 offset:1000
  s_waitcnt lgkmcnt(15)
  v_mfma_f32_16x16x32_bf16 v[228:231], v[124:127], v[172:175], v[228:231]
  v_mfma_f32_16x16x32_bf16 v[232:235], v[144:147], v[172:175], v[232:235]
  ds_read_b64_tr_b16 v[192:193], v30 offset:1184
  ds_read_b64_tr_b16 v[194:195], v30 offset:1376
  ds_read_b64_tr_b16 v[212:213], v30 offset:1192
  ds_read_b64_tr_b16 v[214:215], v30 offset:1384
  s_waitcnt lgkmcnt(15)
  v_mfma_f32_16x16x32_bf16 v[228:231], v[128:131], v[176:179], v[228:231]
  v_mfma_f32_16x16x32_bf16 v[232:235], v[148:151], v[176:179], v[232:235]
  ds_read_b64_tr_b16 v[196:197], v30 offset:1568
  ds_read_b64_tr_b16 v[198:199], v30 offset:1760
  ds_read_b64_tr_b16 v[216:217], v30 offset:1576
  ds_read_b64_tr_b16 v[218:219], v30 offset:1768
  s_waitcnt lgkmcnt(15)
  v_mfma_f32_16x16x32_bf16 v[236:239], v[180:183], v[160:163], 0
  v_mfma_f32_16x16x32_bf16 v[240:243], v[200:203], v[160:163], 0
  s_waitcnt lgkmcnt(12)
  v_mfma_f32_16x16x32_bf16 v[236:239], v[184:187], v[164:167], v[236:239]
  v_mfma_f32_16x16x32_bf16 v[240:243], v[204:207], v[164:167], v[240:243]
  s_waitcnt lgkmcnt(8)
  v_mfma_f32_16x16x32_bf16 v[236:239], v[188:191], v[168:171], v[236:239]
  v_mfma_f32_16x16x32_bf16 v[240:243], v[208:211], v[168:171], v[240:243]
  s_waitcnt lgkmcnt(4)
  v_mfma_f32_16x16x32_bf16 v[236:239], v[192:195], v[172:175], v[236:239]
  v_mfma_f32_16x16x32_bf16 v[240:243], v[212:215], v[172:175], v[240:243]
  s_waitcnt lgkmcnt(0)
  v_mfma_f32_16x16x32_bf16 v[236:239], v[196:199], v[176:179], v[236:239]
  v_mfma_f32_16x16x32_bf16 v[240:243], v[216:219], v[176:179], v[240:243]
  s_nop 7
  v_add_f32 v52, 0x358637bd, v240
  v_rcp_f32 v52, v52
  s_nop 0
  v_mov_b32 v53, v52
  v_pk_mul_f32 v[220:221], v[220:221], v[52:53]
  v_pk_mul_f32 v[222:223], v[222:223], v[52:53]
  v_pk_mul_f32 v[224:225], v[224:225], v[52:53]
  v_pk_mul_f32 v[226:227], v[226:227], v[52:53]
  v_pk_mul_f32 v[228:229], v[228:229], v[52:53]
  v_pk_mul_f32 v[230:231], v[230:231], v[52:53]
  v_pk_mul_f32 v[232:233], v[232:233], v[52:53]
  v_pk_mul_f32 v[234:235], v[234:235], v[52:53]
  v_pk_mul_f32 v[236:237], v[236:237], v[52:53]
  v_pk_mul_f32 v[238:239], v[238:239], v[52:53]
  v_cvt_pk_bf16_f32 v244, v220, v221
  v_cvt_pk_bf16_f32 v245, v222, v223
  v_cvt_pk_bf16_f32 v246, v224, v225
  v_cvt_pk_bf16_f32 v247, v226, v227
  v_cvt_pk_bf16_f32 v248, v228, v229
  v_cvt_pk_bf16_f32 v249, v230, v231
  v_cvt_pk_bf16_f32 v250, v232, v233
  v_cvt_pk_bf16_f32 v251, v234, v235
  v_cvt_pk_bf16_f32 v252, v236, v237
  v_cvt_pk_bf16_f32 v253, v238, v239
  s_mul_i32 s58, s86, 74
  s_lshr_b32 s59, s69, 1
  s_mul_i32 s59, s59, 5
  s_add_u32 s58, s58, s59
  s_add_u32 s58, s58, 54
  s_lshl_b32 s58, s58, 10
  s_add_u32 s58, s58, 8388608
  s_bitcmp1_b32 s69, 0
  s_cbranch_scc1 L_parallel_sum__linear_kernel_hedgehog__mixer_channel_mlp__prompt_kernel_g_o_odd
  buffer_store_dwordx4 v[244:247], v22, s[24:27], s58 offen sc1
  buffer_store_dwordx4 v[248:251], v22, s[24:27], s58 offen offset:1024 sc1
  buffer_store_dwordx2 v[252:253], v22, s[24:27], s58 offen offset:2048 sc1
  s_branch L_parallel_sum__linear_kernel_hedgehog__mixer_channel_mlp__prompt_kernel_g_o_done
L_parallel_sum__linear_kernel_hedgehog__mixer_channel_mlp__prompt_kernel_g_o_odd:
  buffer_store_dwordx2 v[244:245], v22, s[24:27], s58 offen offset:2056 sc1
  buffer_store_dwordx4 v[246:249], v22, s[24:27], s58 offen offset:3072 sc1
  s_add_u32 s58, s58, 4096
  buffer_store_dwordx4 v[250:253], v22, s[24:27], s58 offen sc1
L_parallel_sum__linear_kernel_hedgehog__mixer_channel_mlp__prompt_kernel_g_o_done:
  v_mfma_f32_16x16x32_bf16 v[32:35], v[68:71], v[64:67], v[32:35]
  ds_read_b128 v[112:115], v11 offset:2048
  v_mfma_f32_16x16x32_bf16 v[36:39], v[72:75], v[64:67], v[36:39]
  ds_read_b128 v[116:119], v7 offset:10240
  v_mfma_f32_16x16x32_bf16 v[40:43], v[76:79], v[64:67], v[40:43]
  ds_read_b128 v[120:123], v7 offset:11264
  v_mfma_f32_16x16x32_bf16 v[44:47], v[80:83], v[64:67], v[44:47]
  ds_read_b128 v[124:127], v7 offset:12288
  v_mfma_f32_16x16x32_bf16 v[48:51], v[84:87], v[64:67], v[48:51]
  ds_read_b128 v[128:131], v7 offset:13312
  ds_read_b128 v[132:135], v7 offset:14336
  v_mfma_f32_16x16x32_bf16 v[32:35], v[92:95], v[88:91], v[32:35]
  ds_read_b128 v[136:139], v11 offset:3072
  v_mfma_f32_16x16x32_bf16 v[36:39], v[96:99], v[88:91], v[36:39]
  ds_read_b128 v[140:143], v7 offset:15360
  v_mfma_f32_16x16x32_bf16 v[40:43], v[100:103], v[88:91], v[40:43]
  ds_read_b128 v[144:147], v7 offset:16384
  v_mfma_f32_16x16x32_bf16 v[44:47], v[104:107], v[88:91], v[44:47]
  ds_read_b128 v[148:151], v7 offset:17408
  v_mfma_f32_16x16x32_bf16 v[48:51], v[108:111], v[88:91], v[48:51]
  ds_read_b128 v[152:155], v7 offset:18432
  ds_read_b128 v[156:159], v7 offset:19456
  s_waitcnt lgkmcnt(0)
  s_barrier
  v_mfma_f32_16x16x32_bf16 v[32:35], v[116:119], v[112:115], v[32:35]
  ds_read_b128 v[64:67], v8 offset:0
  v_mfma_f32_16x16x32_bf16 v[36:39], v[120:123], v[112:115], v[36:39]
  ds_read_b128 v[68:71], v4 offset:0
  v_mfma_f32_16x16x32_bf16 v[40:43], v[124:127], v[112:115], v[40:43]
  ds_read_b128 v[72:75], v4 offset:1024
  v_mfma_f32_16x16x32_bf16 v[44:47], v[128:131], v[112:115], v[44:47]
  ds_read_b128 v[76:79], v4 offset:2048
  v_mfma_f32_16x16x32_bf16 v[48:51], v[132:135], v[112:115], v[48:51]
  ds_read_b128 v[80:83], v4 offset:3072
  ds_read_b128 v[84:87], v4 offset:4096
  v_mfma_f32_16x16x32_bf16 v[32:35], v[140:143], v[136:139], v[32:35]
  ds_read_b128 v[88:91], v8 offset:1024
  v_mfma_f32_16x16x32_bf16 v[36:39], v[144:147], v[136:139], v[36:39]
  ds_read_b128 v[92:95], v4 offset:5120
  v_mfma_f32_16x16x32_bf16 v[40:43], v[148:151], v[136:139], v[40:43]
  ds_read_b128 v[96:99], v4 offset:6144
  v_mfma_f32_16x16x32_bf16 v[44:47], v[152:155], v[136:139], v[44:47]
  ds_read_b128 v[100:103], v4 offset:7168
  v_mfma_f32_16x16x32_bf16 v[48:51], v[156:159], v[136:139], v[48:51]
  ds_read_b128 v[104:107], v4 offset:8192
  ds_read_b128 v[108:111], v4 offset:9216
  s_waitcnt vmcnt(0)
  s_lshl_b32 s41, s86, 1
  s_lshr_b32 s42, s69, 2
  s_add_u32 s41, s41, s42
  s_lshl_b32 s41, s41, 7
  s_and_b32 s42, s69, 3
  s_add_u32 s41, s41, s42
  s_add_u32 s41, s41, 21018624
  v_mov_b32 v2, s41
  v_mov_b32 v0, 1
  s_mov_b64 exec, 1
  buffer_store_byte v0, v2, s[24:27], 0 offen sc1
  s_mov_b64 exec, -1
  s_waitcnt lgkmcnt(6)
  v_mfma_f32_16x16x32_bf16 v[32:35], v[68:71], v[64:67], v[32:35]
  ds_read_b128 v[112:115], v8 offset:2048
  v_mfma_f32_16x16x32_bf16 v[36:39], v[72:75], v[64:67], v[36:39]
  ds_read_b128 v[116:119], v4 offset:10240
  v_mfma_f32_16x16x32_bf16 v[40:43], v[76:79], v[64:67], v[40:43]
  ds_read_b128 v[120:123], v4 offset:11264
  v_mfma_f32_16x16x32_bf16 v[44:47], v[80:83], v[64:67], v[44:47]
  ds_read_b128 v[124:127], v4 offset:12288
  v_mfma_f32_16x16x32_bf16 v[48:51], v[84:87], v[64:67], v[48:51]
  ds_read_b128 v[128:131], v4 offset:13312
  ds_read_b128 v[132:135], v4 offset:14336
  s_waitcnt lgkmcnt(6)
  v_mfma_f32_16x16x32_bf16 v[32:35], v[92:95], v[88:91], v[32:35]
  ds_read_b128 v[136:139], v8 offset:3072
  v_mfma_f32_16x16x32_bf16 v[36:39], v[96:99], v[88:91], v[36:39]
  ds_read_b128 v[140:143], v4 offset:15360
  v_mfma_f32_16x16x32_bf16 v[40:43], v[100:103], v[88:91], v[40:43]
  ds_read_b128 v[144:147], v4 offset:16384
  v_mfma_f32_16x16x32_bf16 v[44:47], v[104:107], v[88:91], v[44:47]
  ds_read_b128 v[148:151], v4 offset:17408
  v_mfma_f32_16x16x32_bf16 v[48:51], v[108:111], v[88:91], v[48:51]
  ds_read_b128 v[152:155], v4 offset:18432
  ds_read_b128 v[156:159], v4 offset:19456
  s_waitcnt lgkmcnt(0)
  s_barrier
  v_mfma_f32_16x16x32_bf16 v[32:35], v[116:119], v[112:115], v[32:35]
  ds_read_b128 v[64:67], v9 offset:0
  v_mfma_f32_16x16x32_bf16 v[36:39], v[120:123], v[112:115], v[36:39]
  ds_read_b128 v[68:71], v5 offset:0
  v_mfma_f32_16x16x32_bf16 v[40:43], v[124:127], v[112:115], v[40:43]
  ds_read_b128 v[72:75], v5 offset:1024
  v_mfma_f32_16x16x32_bf16 v[44:47], v[128:131], v[112:115], v[44:47]
  ds_read_b128 v[76:79], v5 offset:2048
  v_mfma_f32_16x16x32_bf16 v[48:51], v[132:135], v[112:115], v[48:51]
  ds_read_b128 v[80:83], v5 offset:3072
  ds_read_b128 v[84:87], v5 offset:4096
  v_mfma_f32_16x16x32_bf16 v[32:35], v[140:143], v[136:139], v[32:35]
  ds_read_b128 v[88:91], v9 offset:1024
  v_mfma_f32_16x16x32_bf16 v[36:39], v[144:147], v[136:139], v[36:39]
  ds_read_b128 v[92:95], v5 offset:5120
  v_mfma_f32_16x16x32_bf16 v[40:43], v[148:151], v[136:139], v[40:43]
  ds_read_b128 v[96:99], v5 offset:6144
  v_mfma_f32_16x16x32_bf16 v[44:47], v[152:155], v[136:139], v[44:47]
  ds_read_b128 v[100:103], v5 offset:7168
  v_mfma_f32_16x16x32_bf16 v[48:51], v[156:159], v[136:139], v[48:51]
  ds_read_b128 v[104:107], v5 offset:8192
  ds_read_b128 v[108:111], v5 offset:9216
  s_waitcnt lgkmcnt(6)
  v_mfma_f32_16x16x32_bf16 v[32:35], v[68:71], v[64:67], v[32:35]
  ds_read_b128 v[112:115], v9 offset:2048
  v_mfma_f32_16x16x32_bf16 v[36:39], v[72:75], v[64:67], v[36:39]
  ds_read_b128 v[116:119], v5 offset:10240
  v_mfma_f32_16x16x32_bf16 v[40:43], v[76:79], v[64:67], v[40:43]
  ds_read_b128 v[120:123], v5 offset:11264
  v_mfma_f32_16x16x32_bf16 v[44:47], v[80:83], v[64:67], v[44:47]
  ds_read_b128 v[124:127], v5 offset:12288
  v_mfma_f32_16x16x32_bf16 v[48:51], v[84:87], v[64:67], v[48:51]
  ds_read_b128 v[128:131], v5 offset:13312
  ds_read_b128 v[132:135], v5 offset:14336
  s_waitcnt lgkmcnt(6)
  v_mfma_f32_16x16x32_bf16 v[32:35], v[92:95], v[88:91], v[32:35]
  ds_read_b128 v[136:139], v9 offset:3072
  v_mfma_f32_16x16x32_bf16 v[36:39], v[96:99], v[88:91], v[36:39]
  ds_read_b128 v[140:143], v5 offset:15360
  v_mfma_f32_16x16x32_bf16 v[40:43], v[100:103], v[88:91], v[40:43]
  ds_read_b128 v[144:147], v5 offset:16384
  v_mfma_f32_16x16x32_bf16 v[44:47], v[104:107], v[88:91], v[44:47]
  ds_read_b128 v[148:151], v5 offset:17408
  v_mfma_f32_16x16x32_bf16 v[48:51], v[108:111], v[88:91], v[48:51]
  ds_read_b128 v[152:155], v5 offset:18432
  ds_read_b128 v[156:159], v5 offset:19456
  s_waitcnt lgkmcnt(0)
  s_barrier
  v_mfma_f32_16x16x32_bf16 v[32:35], v[116:119], v[112:115], v[32:35]
  ds_read_b128 v[64:67], v10 offset:0
  v_mfma_f32_16x16x32_bf16 v[36:39], v[120:123], v[112:115], v[36:39]
  ds_read_b128 v[68:71], v6 offset:0
  v_mfma_f32_16x16x32_bf16 v[40:43], v[124:127], v[112:115], v[40:43]
  ds_read_b128 v[72:75], v6 offset:1024
  v_mfma_f32_16x16x32_bf16 v[44:47], v[128:131], v[112:115], v[44:47]
  ds_read_b128 v[76:79], v6 offset:2048
  v_mfma_f32_16x16x32_bf16 v[48:51], v[132:135], v[112:115], v[48:51]
  ds_read_b128 v[80:83], v6 offset:3072
  ds_read_b128 v[84:87], v6 offset:4096
  v_mfma_f32_16x16x32_bf16 v[32:35], v[140:143], v[136:139], v[32:35]
  ds_read_b128 v[88:91], v10 offset:1024
  v_mfma_f32_16x16x32_bf16 v[36:39], v[144:147], v[136:139], v[36:39]
  ds_read_b128 v[92:95], v6 offset:5120
  v_mfma_f32_16x16x32_bf16 v[40:43], v[148:151], v[136:139], v[40:43]
  ds_read_b128 v[96:99], v6 offset:6144
  v_mfma_f32_16x16x32_bf16 v[44:47], v[152:155], v[136:139], v[44:47]
  ds_read_b128 v[100:103], v6 offset:7168
  v_mfma_f32_16x16x32_bf16 v[48:51], v[156:159], v[136:139], v[48:51]
  ds_read_b128 v[104:107], v6 offset:8192
  ds_read_b128 v[108:111], v6 offset:9216
  s_waitcnt lgkmcnt(6)
  v_mfma_f32_16x16x32_bf16 v[32:35], v[68:71], v[64:67], v[32:35]
  ds_read_b128 v[112:115], v10 offset:2048
  v_mfma_f32_16x16x32_bf16 v[36:39], v[72:75], v[64:67], v[36:39]
  ds_read_b128 v[116:119], v6 offset:10240
  v_mfma_f32_16x16x32_bf16 v[40:43], v[76:79], v[64:67], v[40:43]
  ds_read_b128 v[120:123], v6 offset:11264
  v_mfma_f32_16x16x32_bf16 v[44:47], v[80:83], v[64:67], v[44:47]
  ds_read_b128 v[124:127], v6 offset:12288
  v_mfma_f32_16x16x32_bf16 v[48:51], v[84:87], v[64:67], v[48:51]
  ds_read_b128 v[128:131], v6 offset:13312
  ds_read_b128 v[132:135], v6 offset:14336
  s_waitcnt lgkmcnt(6)
  v_mfma_f32_16x16x32_bf16 v[32:35], v[92:95], v[88:91], v[32:35]
  ds_read_b128 v[136:139], v10 offset:3072
  v_mfma_f32_16x16x32_bf16 v[36:39], v[96:99], v[88:91], v[36:39]
  ds_read_b128 v[140:143], v6 offset:15360
  v_mfma_f32_16x16x32_bf16 v[40:43], v[100:103], v[88:91], v[40:43]
  ds_read_b128 v[144:147], v6 offset:16384
  v_mfma_f32_16x16x32_bf16 v[44:47], v[104:107], v[88:91], v[44:47]
  ds_read_b128 v[148:151], v6 offset:17408
  v_mfma_f32_16x16x32_bf16 v[48:51], v[108:111], v[88:91], v[48:51]
  ds_read_b128 v[152:155], v6 offset:18432
  ds_read_b128 v[156:159], v6 offset:19456
  s_waitcnt lgkmcnt(0)
  s_barrier
  v_mfma_f32_16x16x32_bf16 v[32:35], v[116:119], v[112:115], v[32:35]
  ds_read_b128 v[64:67], v11 offset:0
  v_mfma_f32_16x16x32_bf16 v[36:39], v[120:123], v[112:115], v[36:39]
  ds_read_b128 v[68:71], v7 offset:0
  v_mfma_f32_16x16x32_bf16 v[40:43], v[124:127], v[112:115], v[40:43]
  ds_read_b128 v[72:75], v7 offset:1024
  v_mfma_f32_16x16x32_bf16 v[44:47], v[128:131], v[112:115], v[44:47]
  ds_read_b128 v[76:79], v7 offset:2048
  v_mfma_f32_16x16x32_bf16 v[48:51], v[132:135], v[112:115], v[48:51]
  ds_read_b128 v[80:83], v7 offset:3072
  ds_read_b128 v[84:87], v7 offset:4096
  v_mfma_f32_16x16x32_bf16 v[32:35], v[140:143], v[136:139], v[32:35]
  ds_read_b128 v[88:91], v11 offset:1024
  v_mfma_f32_16x16x32_bf16 v[36:39], v[144:147], v[136:139], v[36:39]
  ds_read_b128 v[92:95], v7 offset:5120
  v_mfma_f32_16x16x32_bf16 v[40:43], v[148:151], v[136:139], v[40:43]
  ds_read_b128 v[96:99], v7 offset:6144
  v_mfma_f32_16x16x32_bf16 v[44:47], v[152:155], v[136:139], v[44:47]
  ds_read_b128 v[100:103], v7 offset:7168
  v_mfma_f32_16x16x32_bf16 v[48:51], v[156:159], v[136:139], v[48:51]
  ds_read_b128 v[104:107], v7 offset:8192
  ds_read_b128 v[108:111], v7 offset:9216
  s_waitcnt lgkmcnt(6)
  v_mfma_f32_16x16x32_bf16 v[32:35], v[68:71], v[64:67], v[32:35]
  ds_read_b128 v[112:115], v11 offset:2048
  v_mfma_f32_16x16x32_bf16 v[36:39], v[72:75], v[64:67], v[36:39]
  ds_read_b128 v[116:119], v7 offset:10240
  v_mfma_f32_16x16x32_bf16 v[40:43], v[76:79], v[64:67], v[40:43]
  ds_read_b128 v[120:123], v7 offset:11264
  v_mfma_f32_16x16x32_bf16 v[44:47], v[80:83], v[64:67], v[44:47]
  ds_read_b128 v[124:127], v7 offset:12288
  v_mfma_f32_16x16x32_bf16 v[48:51], v[84:87], v[64:67], v[48:51]
  ds_read_b128 v[128:131], v7 offset:13312
  ds_read_b128 v[132:135], v7 offset:14336
  s_waitcnt lgkmcnt(6)
  v_mfma_f32_16x16x32_bf16 v[32:35], v[92:95], v[88:91], v[32:35]
  ds_read_b128 v[136:139], v11 offset:3072
  v_mfma_f32_16x16x32_bf16 v[36:39], v[96:99], v[88:91], v[36:39]
  ds_read_b128 v[140:143], v7 offset:15360
  v_mfma_f32_16x16x32_bf16 v[40:43], v[100:103], v[88:91], v[40:43]
  ds_read_b128 v[144:147], v7 offset:16384
  v_mfma_f32_16x16x32_bf16 v[44:47], v[104:107], v[88:91], v[44:47]
  ds_read_b128 v[148:151], v7 offset:17408
  v_mfma_f32_16x16x32_bf16 v[48:51], v[108:111], v[88:91], v[48:51]
  ds_read_b128 v[152:155], v7 offset:18432
  ds_read_b128 v[156:159], v7 offset:19456
  s_waitcnt lgkmcnt(0)
  s_barrier
  v_mfma_f32_16x16x32_bf16 v[32:35], v[116:119], v[112:115], v[32:35]
  ds_read_b128 v[64:67], v8 offset:0
  v_mfma_f32_16x16x32_bf16 v[36:39], v[120:123], v[112:115], v[36:39]
  ds_read_b128 v[68:71], v4 offset:0
  v_mfma_f32_16x16x32_bf16 v[40:43], v[124:127], v[112:115], v[40:43]
  ds_read_b128 v[72:75], v4 offset:1024
  v_mfma_f32_16x16x32_bf16 v[44:47], v[128:131], v[112:115], v[44:47]
  ds_read_b128 v[76:79], v4 offset:2048
  v_mfma_f32_16x16x32_bf16 v[48:51], v[132:135], v[112:115], v[48:51]
  ds_read_b128 v[80:83], v4 offset:3072
  ds_read_b128 v[84:87], v4 offset:4096
  v_mfma_f32_16x16x32_bf16 v[32:35], v[140:143], v[136:139], v[32:35]
  ds_read_b128 v[88:91], v8 offset:1024
  v_mfma_f32_16x16x32_bf16 v[36:39], v[144:147], v[136:139], v[36:39]
  ds_read_b128 v[92:95], v4 offset:5120
  v_mfma_f32_16x16x32_bf16 v[40:43], v[148:151], v[136:139], v[40:43]
  ds_read_b128 v[96:99], v4 offset:6144
  v_mfma_f32_16x16x32_bf16 v[44:47], v[152:155], v[136:139], v[44:47]
  ds_read_b128 v[100:103], v4 offset:7168
  v_mfma_f32_16x16x32_bf16 v[48:51], v[156:159], v[136:139], v[48:51]
  ds_read_b128 v[104:107], v4 offset:8192
  ds_read_b128 v[108:111], v4 offset:9216
  s_waitcnt lgkmcnt(6)
  v_mfma_f32_16x16x32_bf16 v[32:35], v[68:71], v[64:67], v[32:35]
  ds_read_b128 v[112:115], v8 offset:2048
  v_mfma_f32_16x16x32_bf16 v[36:39], v[72:75], v[64:67], v[36:39]
  ds_read_b128 v[116:119], v4 offset:10240
  v_mfma_f32_16x16x32_bf16 v[40:43], v[76:79], v[64:67], v[40:43]
  ds_read_b128 v[120:123], v4 offset:11264
  v_mfma_f32_16x16x32_bf16 v[44:47], v[80:83], v[64:67], v[44:47]
  ds_read_b128 v[124:127], v4 offset:12288
  v_mfma_f32_16x16x32_bf16 v[48:51], v[84:87], v[64:67], v[48:51]
  ds_read_b128 v[128:131], v4 offset:13312
  ds_read_b128 v[132:135], v4 offset:14336
  s_waitcnt lgkmcnt(6)
  v_mfma_f32_16x16x32_bf16 v[32:35], v[92:95], v[88:91], v[32:35]
  ds_read_b128 v[136:139], v8 offset:3072
  v_mfma_f32_16x16x32_bf16 v[36:39], v[96:99], v[88:91], v[36:39]
  ds_read_b128 v[140:143], v4 offset:15360
  v_mfma_f32_16x16x32_bf16 v[40:43], v[100:103], v[88:91], v[40:43]
  ds_read_b128 v[144:147], v4 offset:16384
  v_mfma_f32_16x16x32_bf16 v[44:47], v[104:107], v[88:91], v[44:47]
  ds_read_b128 v[148:151], v4 offset:17408
  v_mfma_f32_16x16x32_bf16 v[48:51], v[108:111], v[88:91], v[48:51]
  ds_read_b128 v[152:155], v4 offset:18432
  ds_read_b128 v[156:159], v4 offset:19456
  s_waitcnt lgkmcnt(0)
  s_barrier
  v_mfma_f32_16x16x32_bf16 v[32:35], v[116:119], v[112:115], v[32:35]
  ds_read_b128 v[64:67], v9 offset:0
  v_mfma_f32_16x16x32_bf16 v[36:39], v[120:123], v[112:115], v[36:39]
  ds_read_b128 v[68:71], v5 offset:0
  v_mfma_f32_16x16x32_bf16 v[40:43], v[124:127], v[112:115], v[40:43]
  ds_read_b128 v[72:75], v5 offset:1024
  v_mfma_f32_16x16x32_bf16 v[44:47], v[128:131], v[112:115], v[44:47]
  ds_read_b128 v[76:79], v5 offset:2048
  v_mfma_f32_16x16x32_bf16 v[48:51], v[132:135], v[112:115], v[48:51]
  ds_read_b128 v[80:83], v5 offset:3072
  ds_read_b128 v[84:87], v5 offset:4096
  v_mfma_f32_16x16x32_bf16 v[32:35], v[140:143], v[136:139], v[32:35]
  ds_read_b128 v[88:91], v9 offset:1024
  v_mfma_f32_16x16x32_bf16 v[36:39], v[144:147], v[136:139], v[36:39]
  ds_read_b128 v[92:95], v5 offset:5120
  v_mfma_f32_16x16x32_bf16 v[40:43], v[148:151], v[136:139], v[40:43]
  ds_read_b128 v[96:99], v5 offset:6144
  v_mfma_f32_16x16x32_bf16 v[44:47], v[152:155], v[136:139], v[44:47]
  ds_read_b128 v[100:103], v5 offset:7168
  v_mfma_f32_16x16x32_bf16 v[48:51], v[156:159], v[136:139], v[48:51]
  ds_read_b128 v[104:107], v5 offset:8192
  ds_read_b128 v[108:111], v5 offset:9216
  s_waitcnt lgkmcnt(6)
  v_mfma_f32_16x16x32_bf16 v[32:35], v[68:71], v[64:67], v[32:35]
  ds_read_b128 v[112:115], v9 offset:2048
  v_mfma_f32_16x16x32_bf16 v[36:39], v[72:75], v[64:67], v[36:39]
  ds_read_b128 v[116:119], v5 offset:10240
  v_mfma_f32_16x16x32_bf16 v[40:43], v[76:79], v[64:67], v[40:43]
  ds_read_b128 v[120:123], v5 offset:11264
  v_mfma_f32_16x16x32_bf16 v[44:47], v[80:83], v[64:67], v[44:47]
  ds_read_b128 v[124:127], v5 offset:12288
  v_mfma_f32_16x16x32_bf16 v[48:51], v[84:87], v[64:67], v[48:51]
  ds_read_b128 v[128:131], v5 offset:13312
  ds_read_b128 v[132:135], v5 offset:14336
  s_waitcnt lgkmcnt(6)
  v_mfma_f32_16x16x32_bf16 v[32:35], v[92:95], v[88:91], v[32:35]
  ds_read_b128 v[136:139], v9 offset:3072
  v_mfma_f32_16x16x32_bf16 v[36:39], v[96:99], v[88:91], v[36:39]
  ds_read_b128 v[140:143], v5 offset:15360
  v_mfma_f32_16x16x32_bf16 v[40:43], v[100:103], v[88:91], v[40:43]
  ds_read_b128 v[144:147], v5 offset:16384
  v_mfma_f32_16x16x32_bf16 v[44:47], v[104:107], v[88:91], v[44:47]
  ds_read_b128 v[148:151], v5 offset:17408
  v_mfma_f32_16x16x32_bf16 v[48:51], v[108:111], v[88:91], v[48:51]
  ds_read_b128 v[152:155], v5 offset:18432
  ds_read_b128 v[156:159], v5 offset:19456
  s_waitcnt lgkmcnt(0)
  s_barrier
  v_mfma_f32_16x16x32_bf16 v[32:35], v[116:119], v[112:115], v[32:35]
  ds_read_b128 v[64:67], v10 offset:0
  v_mfma_f32_16x16x32_bf16 v[36:39], v[120:123], v[112:115], v[36:39]
  ds_read_b128 v[68:71], v6 offset:0
  v_mfma_f32_16x16x32_bf16 v[40:43], v[124:127], v[112:115], v[40:43]
  ds_read_b128 v[72:75], v6 offset:1024
  v_mfma_f32_16x16x32_bf16 v[44:47], v[128:131], v[112:115], v[44:47]
  ds_read_b128 v[76:79], v6 offset:2048
  v_mfma_f32_16x16x32_bf16 v[48:51], v[132:135], v[112:115], v[48:51]
  ds_read_b128 v[80:83], v6 offset:3072
  ds_read_b128 v[84:87], v6 offset:4096
  v_mfma_f32_16x16x32_bf16 v[32:35], v[140:143], v[136:139], v[32:35]
  ds_read_b128 v[88:91], v10 offset:1024
  v_mfma_f32_16x16x32_bf16 v[36:39], v[144:147], v[136:139], v[36:39]
  ds_read_b128 v[92:95], v6 offset:5120
  v_mfma_f32_16x16x32_bf16 v[40:43], v[148:151], v[136:139], v[40:43]
  ds_read_b128 v[96:99], v6 offset:6144
  v_mfma_f32_16x16x32_bf16 v[44:47], v[152:155], v[136:139], v[44:47]
  ds_read_b128 v[100:103], v6 offset:7168
  v_mfma_f32_16x16x32_bf16 v[48:51], v[156:159], v[136:139], v[48:51]
  ds_read_b128 v[104:107], v6 offset:8192
  ds_read_b128 v[108:111], v6 offset:9216
  s_waitcnt lgkmcnt(6)
  v_mfma_f32_16x16x32_bf16 v[32:35], v[68:71], v[64:67], v[32:35]
  ds_read_b128 v[112:115], v10 offset:2048
  v_mfma_f32_16x16x32_bf16 v[36:39], v[72:75], v[64:67], v[36:39]
  ds_read_b128 v[116:119], v6 offset:10240
  v_mfma_f32_16x16x32_bf16 v[40:43], v[76:79], v[64:67], v[40:43]
  ds_read_b128 v[120:123], v6 offset:11264
  v_mfma_f32_16x16x32_bf16 v[44:47], v[80:83], v[64:67], v[44:47]
  ds_read_b128 v[124:127], v6 offset:12288
  v_mfma_f32_16x16x32_bf16 v[48:51], v[84:87], v[64:67], v[48:51]
  ds_read_b128 v[128:131], v6 offset:13312
  ds_read_b128 v[132:135], v6 offset:14336
  s_waitcnt lgkmcnt(6)
  v_mfma_f32_16x16x32_bf16 v[32:35], v[92:95], v[88:91], v[32:35]
  ds_read_b128 v[136:139], v10 offset:3072
  v_mfma_f32_16x16x32_bf16 v[36:39], v[96:99], v[88:91], v[36:39]
  ds_read_b128 v[140:143], v6 offset:15360
  v_mfma_f32_16x16x32_bf16 v[40:43], v[100:103], v[88:91], v[40:43]
  ds_read_b128 v[144:147], v6 offset:16384
  v_mfma_f32_16x16x32_bf16 v[44:47], v[104:107], v[88:91], v[44:47]
  ds_read_b128 v[148:151], v6 offset:17408
  v_mfma_f32_16x16x32_bf16 v[48:51], v[108:111], v[88:91], v[48:51]
  ds_read_b128 v[152:155], v6 offset:18432
  ds_read_b128 v[156:159], v6 offset:19456
  s_waitcnt lgkmcnt(0)
  s_barrier
  v_mfma_f32_16x16x32_bf16 v[32:35], v[116:119], v[112:115], v[32:35]
  ds_read_b128 v[64:67], v11 offset:0
  v_mfma_f32_16x16x32_bf16 v[36:39], v[120:123], v[112:115], v[36:39]
  ds_read_b128 v[68:71], v7 offset:0
  v_mfma_f32_16x16x32_bf16 v[40:43], v[124:127], v[112:115], v[40:43]
  ds_read_b128 v[72:75], v7 offset:1024
  v_mfma_f32_16x16x32_bf16 v[44:47], v[128:131], v[112:115], v[44:47]
  ds_read_b128 v[76:79], v7 offset:2048
  v_mfma_f32_16x16x32_bf16 v[48:51], v[132:135], v[112:115], v[48:51]
  ds_read_b128 v[80:83], v7 offset:3072
  ds_read_b128 v[84:87], v7 offset:4096
  v_mfma_f32_16x16x32_bf16 v[32:35], v[140:143], v[136:139], v[32:35]
  ds_read_b128 v[88:91], v11 offset:1024
  v_mfma_f32_16x16x32_bf16 v[36:39], v[144:147], v[136:139], v[36:39]
  ds_read_b128 v[92:95], v7 offset:5120
  v_mfma_f32_16x16x32_bf16 v[40:43], v[148:151], v[136:139], v[40:43]
  ds_read_b128 v[96:99], v7 offset:6144
  v_mfma_f32_16x16x32_bf16 v[44:47], v[152:155], v[136:139], v[44:47]
  ds_read_b128 v[100:103], v7 offset:7168
  v_mfma_f32_16x16x32_bf16 v[48:51], v[156:159], v[136:139], v[48:51]
  ds_read_b128 v[104:107], v7 offset:8192
  ds_read_b128 v[108:111], v7 offset:9216
  s_waitcnt lgkmcnt(6)
  v_mfma_f32_16x16x32_bf16 v[32:35], v[68:71], v[64:67], v[32:35]
  ds_read_b128 v[112:115], v11 offset:2048
  v_mfma_f32_16x16x32_bf16 v[36:39], v[72:75], v[64:67], v[36:39]
  ds_read_b128 v[116:119], v7 offset:10240
  v_mfma_f32_16x16x32_bf16 v[40:43], v[76:79], v[64:67], v[40:43]
  ds_read_b128 v[120:123], v7 offset:11264
  v_mfma_f32_16x16x32_bf16 v[44:47], v[80:83], v[64:67], v[44:47]
  ds_read_b128 v[124:127], v7 offset:12288
  v_mfma_f32_16x16x32_bf16 v[48:51], v[84:87], v[64:67], v[48:51]
  ds_read_b128 v[128:131], v7 offset:13312
  ds_read_b128 v[132:135], v7 offset:14336
  s_waitcnt lgkmcnt(6)
  v_mfma_f32_16x16x32_bf16 v[32:35], v[92:95], v[88:91], v[32:35]
  ds_read_b128 v[136:139], v11 offset:3072
  v_mfma_f32_16x16x32_bf16 v[36:39], v[96:99], v[88:91], v[36:39]
  ds_read_b128 v[140:143], v7 offset:15360
  v_mfma_f32_16x16x32_bf16 v[40:43], v[100:103], v[88:91], v[40:43]
  ds_read_b128 v[144:147], v7 offset:16384
  v_mfma_f32_16x16x32_bf16 v[44:47], v[104:107], v[88:91], v[44:47]
  ds_read_b128 v[148:151], v7 offset:17408
  v_mfma_f32_16x16x32_bf16 v[48:51], v[108:111], v[88:91], v[48:51]
  ds_read_b128 v[152:155], v7 offset:18432
  ds_read_b128 v[156:159], v7 offset:19456
  s_waitcnt lgkmcnt(0)
  s_barrier
  v_mfma_f32_16x16x32_bf16 v[32:35], v[116:119], v[112:115], v[32:35]
  ds_read_b128 v[64:67], v8 offset:0
  v_mfma_f32_16x16x32_bf16 v[36:39], v[120:123], v[112:115], v[36:39]
  ds_read_b128 v[68:71], v4 offset:0
  v_mfma_f32_16x16x32_bf16 v[40:43], v[124:127], v[112:115], v[40:43]
  ds_read_b128 v[72:75], v4 offset:1024
  v_mfma_f32_16x16x32_bf16 v[44:47], v[128:131], v[112:115], v[44:47]
  ds_read_b128 v[76:79], v4 offset:2048
  v_mfma_f32_16x16x32_bf16 v[48:51], v[132:135], v[112:115], v[48:51]
  ds_read_b128 v[80:83], v4 offset:3072
  ds_read_b128 v[84:87], v4 offset:4096
  v_mfma_f32_16x16x32_bf16 v[32:35], v[140:143], v[136:139], v[32:35]
  ds_read_b128 v[88:91], v8 offset:1024
  v_mfma_f32_16x16x32_bf16 v[36:39], v[144:147], v[136:139], v[36:39]
  ds_read_b128 v[92:95], v4 offset:5120
  v_mfma_f32_16x16x32_bf16 v[40:43], v[148:151], v[136:139], v[40:43]
  ds_read_b128 v[96:99], v4 offset:6144
  v_mfma_f32_16x16x32_bf16 v[44:47], v[152:155], v[136:139], v[44:47]
  ds_read_b128 v[100:103], v4 offset:7168
  v_mfma_f32_16x16x32_bf16 v[48:51], v[156:159], v[136:139], v[48:51]
  ds_read_b128 v[104:107], v4 offset:8192
  ds_read_b128 v[108:111], v4 offset:9216
  s_waitcnt lgkmcnt(6)
  v_mfma_f32_16x16x32_bf16 v[32:35], v[68:71], v[64:67], v[32:35]
  ds_read_b128 v[112:115], v8 offset:2048
  v_mfma_f32_16x16x32_bf16 v[36:39], v[72:75], v[64:67], v[36:39]
  ds_read_b128 v[116:119], v4 offset:10240
  v_mfma_f32_16x16x32_bf16 v[40:43], v[76:79], v[64:67], v[40:43]
  ds_read_b128 v[120:123], v4 offset:11264
  v_mfma_f32_16x16x32_bf16 v[44:47], v[80:83], v[64:67], v[44:47]
  ds_read_b128 v[124:127], v4 offset:12288
  v_mfma_f32_16x16x32_bf16 v[48:51], v[84:87], v[64:67], v[48:51]
  ds_read_b128 v[128:131], v4 offset:13312
  ds_read_b128 v[132:135], v4 offset:14336
  s_waitcnt lgkmcnt(6)
  v_mfma_f32_16x16x32_bf16 v[32:35], v[92:95], v[88:91], v[32:35]
  ds_read_b128 v[136:139], v8 offset:3072
  v_mfma_f32_16x16x32_bf16 v[36:39], v[96:99], v[88:91], v[36:39]
  ds_read_b128 v[140:143], v4 offset:15360
  v_mfma_f32_16x16x32_bf16 v[40:43], v[100:103], v[88:91], v[40:43]
  ds_read_b128 v[144:147], v4 offset:16384
  v_mfma_f32_16x16x32_bf16 v[44:47], v[104:107], v[88:91], v[44:47]
  ds_read_b128 v[148:151], v4 offset:17408
  v_mfma_f32_16x16x32_bf16 v[48:51], v[108:111], v[88:91], v[48:51]
  ds_read_b128 v[152:155], v4 offset:18432
  ds_read_b128 v[156:159], v4 offset:19456
  s_waitcnt lgkmcnt(0)
  s_barrier
  v_mfma_f32_16x16x32_bf16 v[32:35], v[116:119], v[112:115], v[32:35]
  ds_read_b128 v[64:67], v9 offset:0
  v_mfma_f32_16x16x32_bf16 v[36:39], v[120:123], v[112:115], v[36:39]
  ds_read_b128 v[68:71], v5 offset:0
  v_mfma_f32_16x16x32_bf16 v[40:43], v[124:127], v[112:115], v[40:43]
  ds_read_b128 v[72:75], v5 offset:1024
  v_mfma_f32_16x16x32_bf16 v[44:47], v[128:131], v[112:115], v[44:47]
  ds_read_b128 v[76:79], v5 offset:2048
  v_mfma_f32_16x16x32_bf16 v[48:51], v[132:135], v[112:115], v[48:51]
  ds_read_b128 v[80:83], v5 offset:3072
  ds_read_b128 v[84:87], v5 offset:4096
  v_mfma_f32_16x16x32_bf16 v[32:35], v[140:143], v[136:139], v[32:35]
  ds_read_b128 v[88:91], v9 offset:1024
  v_mfma_f32_16x16x32_bf16 v[36:39], v[144:147], v[136:139], v[36:39]
  ds_read_b128 v[92:95], v5 offset:5120
  v_mfma_f32_16x16x32_bf16 v[40:43], v[148:151], v[136:139], v[40:43]
  ds_read_b128 v[96:99], v5 offset:6144
  v_mfma_f32_16x16x32_bf16 v[44:47], v[152:155], v[136:139], v[44:47]
  ds_read_b128 v[100:103], v5 offset:7168
  v_mfma_f32_16x16x32_bf16 v[48:51], v[156:159], v[136:139], v[48:51]
  ds_read_b128 v[104:107], v5 offset:8192
  ds_read_b128 v[108:111], v5 offset:9216
  s_waitcnt lgkmcnt(6)
  v_mfma_f32_16x16x32_bf16 v[32:35], v[68:71], v[64:67], v[32:35]
  ds_read_b128 v[112:115], v9 offset:2048
  v_mfma_f32_16x16x32_bf16 v[36:39], v[72:75], v[64:67], v[36:39]
  ds_read_b128 v[116:119], v5 offset:10240
  v_mfma_f32_16x16x32_bf16 v[40:43], v[76:79], v[64:67], v[40:43]
  ds_read_b128 v[120:123], v5 offset:11264
  v_mfma_f32_16x16x32_bf16 v[44:47], v[80:83], v[64:67], v[44:47]
  ds_read_b128 v[124:127], v5 offset:12288
  v_mfma_f32_16x16x32_bf16 v[48:51], v[84:87], v[64:67], v[48:51]
  ds_read_b128 v[128:131], v5 offset:13312
  ds_read_b128 v[132:135], v5 offset:14336
  s_waitcnt lgkmcnt(6)
  v_mfma_f32_16x16x32_bf16 v[32:35], v[92:95], v[88:91], v[32:35]
  ds_read_b128 v[136:139], v9 offset:3072
  v_mfma_f32_16x16x32_bf16 v[36:39], v[96:99], v[88:91], v[36:39]
  ds_read_b128 v[140:143], v5 offset:15360
  v_mfma_f32_16x16x32_bf16 v[40:43], v[100:103], v[88:91], v[40:43]
  ds_read_b128 v[144:147], v5 offset:16384
  v_mfma_f32_16x16x32_bf16 v[44:47], v[104:107], v[88:91], v[44:47]
  ds_read_b128 v[148:151], v5 offset:17408
  v_mfma_f32_16x16x32_bf16 v[48:51], v[108:111], v[88:91], v[48:51]
  ds_read_b128 v[152:155], v5 offset:18432
  ds_read_b128 v[156:159], v5 offset:19456
  s_waitcnt lgkmcnt(0)
  s_barrier
  v_mfma_f32_16x16x32_bf16 v[32:35], v[116:119], v[112:115], v[32:35]
  ds_read_b128 v[64:67], v10 offset:0
  v_mfma_f32_16x16x32_bf16 v[36:39], v[120:123], v[112:115], v[36:39]
  ds_read_b128 v[68:71], v6 offset:0
  v_mfma_f32_16x16x32_bf16 v[40:43], v[124:127], v[112:115], v[40:43]
  ds_read_b128 v[72:75], v6 offset:1024
  v_mfma_f32_16x16x32_bf16 v[44:47], v[128:131], v[112:115], v[44:47]
  ds_read_b128 v[76:79], v6 offset:2048
  v_mfma_f32_16x16x32_bf16 v[48:51], v[132:135], v[112:115], v[48:51]
  ds_read_b128 v[80:83], v6 offset:3072
  ds_read_b128 v[84:87], v6 offset:4096
  v_mfma_f32_16x16x32_bf16 v[32:35], v[140:143], v[136:139], v[32:35]
  ds_read_b128 v[88:91], v10 offset:1024
  v_mfma_f32_16x16x32_bf16 v[36:39], v[144:147], v[136:139], v[36:39]
  ds_read_b128 v[92:95], v6 offset:5120
  v_mfma_f32_16x16x32_bf16 v[40:43], v[148:151], v[136:139], v[40:43]
  ds_read_b128 v[96:99], v6 offset:6144
  v_mfma_f32_16x16x32_bf16 v[44:47], v[152:155], v[136:139], v[44:47]
  ds_read_b128 v[100:103], v6 offset:7168
  v_mfma_f32_16x16x32_bf16 v[48:51], v[156:159], v[136:139], v[48:51]
  ds_read_b128 v[104:107], v6 offset:8192
  ds_read_b128 v[108:111], v6 offset:9216
  s_waitcnt lgkmcnt(0)
  v_mfma_f32_16x16x32_bf16 v[32:35], v[68:71], v[64:67], v[32:35]
  v_mfma_f32_16x16x32_bf16 v[36:39], v[72:75], v[64:67], v[36:39]
  v_mfma_f32_16x16x32_bf16 v[40:43], v[76:79], v[64:67], v[40:43]
  v_mfma_f32_16x16x32_bf16 v[44:47], v[80:83], v[64:67], v[44:47]
  v_mfma_f32_16x16x32_bf16 v[48:51], v[84:87], v[64:67], v[48:51]
  v_mfma_f32_16x16x32_bf16 v[32:35], v[92:95], v[88:91], v[32:35]
  v_mfma_f32_16x16x32_bf16 v[36:39], v[96:99], v[88:91], v[36:39]
  v_mfma_f32_16x16x32_bf16 v[40:43], v[100:103], v[88:91], v[40:43]
  v_mfma_f32_16x16x32_bf16 v[44:47], v[104:107], v[88:91], v[44:47]
  v_mfma_f32_16x16x32_bf16 v[48:51], v[108:111], v[88:91], v[48:51]
  s_lshl_b32 s44, s39, 4
  v_add_u32 v52, s44, v16
  v_mul_u32_u24 v52, 160, v52
  v_lshl_add_u32 v52, v17, 3, v52
  v_add_u32 v52, 83968, v52
  v_lshlrev_b32 v53, 3, v17
  v_add_u32 v53, 161280, v53
  ds_read_b64 v[64:65], v52 offset:0
  ds_read_b64 v[76:77], v53 offset:0
  ds_read_b64 v[66:67], v52 offset:32
  ds_read_b64 v[78:79], v53 offset:32
  ds_read_b64 v[68:69], v52 offset:64
  ds_read_b64 v[80:81], v53 offset:64
  ds_read_b64 v[70:71], v52 offset:96
  ds_read_b64 v[82:83], v53 offset:96
  ds_read_b64 v[72:73], v52 offset:128
  ds_read_b64 v[84:85], v53 offset:128
  v_add_u32 v88, 0, v1
  v_mul_u32_u24 v91, 6554, v88
  v_lshrrev_b32 v91, 16, v91
  v_mul_u32_u24 v92, 10, v91
  v_sub_u32 v92, v88, v92
  s_lshl_b32 s44, s39, 4
  v_add_u32 v93, s44, v91
  v_mul_u32_u24 v94, 160, v93
  v_lshl_add_u32 v94, v92, 4, v94
  v_add_u32 v94, 83968, v94
  s_lshl_b32 s44, s86, 4
  v_add_u32 v91, s44, v91
  v_mul_u32_u24 v91, 1280, v91
  v_lshl_add_u32 v91, v92, 4, v91
  s_mul_i32 s44, s69, 160
  v_add_u32 v97, s44, v91
  v_add_u32 v89, 64, v1
  v_mul_u32_u24 v91, 6554, v89
  v_lshrrev_b32 v91, 16, v91
  v_mul_u32_u24 v92, 10, v91
  v_sub_u32 v92, v89, v92
  s_lshl_b32 s44, s39, 4
  v_add_u32 v93, s44, v91
  v_mul_u32_u24 v95, 160, v93
  v_lshl_add_u32 v95, v92, 4, v95
  v_add_u32 v95, 83968, v95
  s_lshl_b32 s44, s86, 4
  v_add_u32 v91, s44, v91
  v_mul_u32_u24 v91, 1280, v91
  v_lshl_add_u32 v91, v92, 4, v91
  s_mul_i32 s44, s69, 160
  v_add_u32 v98, s44, v91
  v_add_u32 v90, 128, v1
  v_mul_u32_u24 v91, 6554, v90
  v_lshrrev_b32 v91, 16, v91
  v_mul_u32_u24 v92, 10, v91
  v_sub_u32 v92, v90, v92
  s_lshl_b32 s44, s39, 4
  v_add_u32 v93, s44, v91
  v_mul_u32_u24 v96, 160, v93
  v_lshl_add_u32 v96, v92, 4, v96
  v_add_u32 v96, 83968, v96
  s_lshl_b32 s44, s86, 4
  v_add_u32 v91, s44, v91
  v_mul_u32_u24 v91, 1280, v91
  v_lshl_add_u32 v91, v92, 4, v91
  s_mul_i32 s44, s69, 160
  v_add_u32 v99, s44, v91
  v_mov_b32 v91, 0x7fff0000
  v_cmp_gt_u32 vcc, 160, v90
  s_nop 1
  v_cndmask_b32 v99, v91, v99, vcc
  v_mov_b32 v91, 83968
  v_cndmask_b32 v96, v91, v96, vcc
  s_waitcnt lgkmcnt(0)
  v_lshlrev_b32 v54, 16, v64
  v_and_b32 v55, 0xffff0000, v64
  v_lshlrev_b32 v56, 16, v65
  v_and_b32 v57, 0xffff0000, v65
  v_lshlrev_b32 v58, 16, v76
  v_and_b32 v59, 0xffff0000, v76
  v_lshlrev_b32 v60, 16, v77
  v_and_b32 v61, 0xffff0000, v77
  v_pk_add_f32 v[54:55], v[54:55], v[58:59]
  v_pk_add_f32 v[56:57], v[56:57], v[60:61]
  v_pk_add_f32 v[32:33], v[32:33], v[54:55]
  v_pk_add_f32 v[34:35], v[34:35], v[56:57]
  v_cvt_pk_bf16_f32 v62, v32, v33
  v_cvt_pk_bf16_f32 v63, v34, v35
  ds_write_b64 v52, v[62:63] offset:0
  v_lshlrev_b32 v54, 16, v66
  v_and_b32 v55, 0xffff0000, v66
  v_lshlrev_b32 v56, 16, v67
  v_and_b32 v57, 0xffff0000, v67
  v_lshlrev_b32 v58, 16, v78
  v_and_b32 v59, 0xffff0000, v78
  v_lshlrev_b32 v60, 16, v79
  v_and_b32 v61, 0xffff0000, v79
  v_pk_add_f32 v[54:55], v[54:55], v[58:59]
  v_pk_add_f32 v[56:57], v[56:57], v[60:61]
  v_pk_add_f32 v[36:37], v[36:37], v[54:55]
  v_pk_add_f32 v[38:39], v[38:39], v[56:57]
  v_cvt_pk_bf16_f32 v62, v36, v37
  v_cvt_pk_bf16_f32 v63, v38, v39
  ds_write_b64 v52, v[62:63] offset:32
  v_lshlrev_b32 v54, 16, v68
  v_and_b32 v55, 0xffff0000, v68
  v_lshlrev_b32 v56, 16, v69
  v_and_b32 v57, 0xffff0000, v69
  v_lshlrev_b32 v58, 16, v80
  v_and_b32 v59, 0xffff0000, v80
  v_lshlrev_b32 v60, 16, v81
  v_and_b32 v61, 0xffff0000, v81
  v_pk_add_f32 v[54:55], v[54:55], v[58:59]
  v_pk_add_f32 v[56:57], v[56:57], v[60:61]
  v_pk_add_f32 v[40:41], v[40:41], v[54:55]
  v_pk_add_f32 v[42:43], v[42:43], v[56:57]
  v_cvt_pk_bf16_f32 v62, v40, v41
  v_cvt_pk_bf16_f32 v63, v42, v43
  ds_write_b64 v52, v[62:63] offset:64
  v_lshlrev_b32 v54, 16, v70
  v_and_b32 v55, 0xffff0000, v70
  v_lshlrev_b32 v56, 16, v71
  v_and_b32 v57, 0xffff0000, v71
  v_lshlrev_b32 v58, 16, v82
  v_and_b32 v59, 0xffff0000, v82
  v_lshlrev_b32 v60, 16, v83
  v_and_b32 v61, 0xffff0000, v83
  v_pk_add_f32 v[54:55], v[54:55], v[58:59]
  v_pk_add_f32 v[56:57], v[56:57], v[60:61]
  v_pk_add_f32 v[44:45], v[44:45], v[54:55]
  v_pk_add_f32 v[46:47], v[46:47], v[56:57]
  v_cvt_pk_bf16_f32 v62, v44, v45
  v_cvt_pk_bf16_f32 v63, v46, v47
  ds_write_b64 v52, v[62:63] offset:96
  v_lshlrev_b32 v54, 16, v72
  v_and_b32 v55, 0xffff0000, v72
  v_lshlrev_b32 v56, 16, v73
  v_and_b32 v57, 0xffff0000, v73
  v_lshlrev_b32 v58, 16, v84
  v_and_b32 v59, 0xffff0000, v84
  v_lshlrev_b32 v60, 16, v85
  v_and_b32 v61, 0xffff0000, v85
  v_pk_add_f32 v[54:55], v[54:55], v[58:59]
  v_pk_add_f32 v[56:57], v[56:57], v[60:61]
  v_pk_add_f32 v[48:49], v[48:49], v[54:55]
  v_pk_add_f32 v[50:51], v[50:51], v[56:57]
  v_cvt_pk_bf16_f32 v62, v48, v49
  v_cvt_pk_bf16_f32 v63, v50, v51
  ds_write_b64 v52, v[62:63] offset:128
  s_waitcnt lgkmcnt(0)
  ds_read_b128 v[100:103], v94
  ds_read_b128 v[104:107], v95
  ds_read_b128 v[108:111], v96
  s_waitcnt lgkmcnt(2)
  buffer_store_dwordx4 v[100:103], v97, s[60:63], 0 offen sc1
  s_waitcnt lgkmcnt(1)
  buffer_store_dwordx4 v[104:107], v98, s[60:63], 0 offen sc1
  s_waitcnt lgkmcnt(0)
  buffer_store_dwordx4 v[108:111], v99, s[60:63], 0 offen sc1
  s_endpgm
L_parallel_sum__linear_kernel_hedgehog__mixer_channel_mlp__prompt_kernel_cb_kv:
  v_and_b32 v16, 15, v1
  v_lshrrev_b32 v17, 4, v1
  s_lshl_b32 s45, s86, 4
  v_add_u32 v19, s45, v16
  v_mul_u32_u24 v24, 1280, v19
  s_mul_i32 s45, s69, 160
  v_lshl_add_u32 v25, v17, 3, s45
  v_add_u32 v24, v24, v25
  v_lshlrev_b32 v22, 4, v1
  s_lshl_b32 s44, s39, 12
  s_add_u32 s44, s44, 20480
  v_add_u32 v4, 0, v22
  v_add_u32 v8, s44, v4
  v_add_u32 v5, 36864, v22
  v_add_u32 v9, s44, v5
  v_add_u32 v6, 73728, v22
  v_add_u32 v10, s44, v6
  v_add_u32 v7, 110592, v22
  v_add_u32 v11, s44, v7
  v_mov_b32 v32, 0
  v_mov_b32 v33, 0
  v_mov_b32 v34, 0
  v_mov_b32 v35, 0
  v_mov_b32 v36, 0
  v_mov_b32 v37, 0
  v_mov_b32 v38, 0
  v_mov_b32 v39, 0
  v_mov_b32 v40, 0
  v_mov_b32 v41, 0
  v_mov_b32 v42, 0
  v_mov_b32 v43, 0
  v_mov_b32 v44, 0
  v_mov_b32 v45, 0
  v_mov_b32 v46, 0
  v_mov_b32 v47, 0
  v_mov_b32 v48, 0
  v_mov_b32 v49, 0
  v_mov_b32 v50, 0
  v_mov_b32 v51, 0
  v_lshrrev_b32 v26, 2, v1
  v_and_b32 v26, 3, v26
  v_and_b32 v27, 3, v1
  v_lshlrev_b32 v28, 10, v17
  v_mul_u32_u24 v29, 40, v26
  v_add_u32 v28, v28, v29
  v_add_u32 v28, 147456, v28
  v_mov_b32 v29, 159232
  v_cmp_eq_u32 vcc, v27, v17
  s_nop 1
  v_cndmask_b32 v28, v29, v28, vcc
  v_mul_u32_u24 v30, 1920, v17
  v_mul_u32_u24 v31, 48, v26
  v_add_u32 v30, v30, v31
  v_add_u32 v30, 151552, v30
  v_cndmask_b32 v30, v29, v30, vcc
  s_waitcnt vmcnt(0)
  s_lshl_b32 s41, s38, 4
  s_add_u32 s41, s41, s36
  s_lshl_b32 s41, s41, 7
  s_add_u32 s41, s41, s39
  s_add_u32 s41, s41, 20998144
  v_mov_b32 v2, s41
  v_mov_b32 v0, 1
  s_mov_b64 exec, 1
  buffer_store_byte v0, v2, s[24:27], 0 offen sc1
  s_mov_b64 exec, -1
  s_lshl_b32 s41, s37, 2
  s_or_b32 s41, s41, s39
  s_cmp_eq_u32 s41, 0
  s_cbranch_scc0 L_parallel_sum__linear_kernel_hedgehog__mixer_channel_mlp__prompt_kernel_k_rp_x
  s_lshl_b32 s41, s38, 11
  s_add_u32 s41, s41, 20998144
  v_min_u32 v15, 15, v1
  v_lshlrev_b32 v15, 7, v15
  v_add_u32 v15, s41, v15
  buffer_load_dword v14, v15, s[24:27], 0 offen sc1
L_parallel_sum__linear_kernel_hedgehog__mixer_channel_mlp__prompt_kernel_k_rp_x:
  s_lshl_b32 s41, s37, 2
  s_or_b32 s41, s41, s39
  s_cmp_eq_u32 s41, 0
  s_cbranch_scc0 L_parallel_sum__linear_kernel_hedgehog__mixer_channel_mlp__prompt_kernel_k_ri_x
  s_waitcnt vmcnt(0)
L_parallel_sum__linear_kernel_hedgehog__mixer_channel_mlp__prompt_kernel_k_ri_t:
  v_cmp_ne_u32 vcc, 0x01010101, v14
  s_nop 0
  s_cmp_eq_u64 vcc, 0
  s_cbranch_scc1 L_parallel_sum__linear_kernel_hedgehog__mixer_channel_mlp__prompt_kernel_k_ri_ok

  s_sleep 1
  buffer_load_dword v14, v15, s[24:27], 0 offen sc1
  s_waitcnt vmcnt(0)
  s_branch L_parallel_sum__linear_kernel_hedgehog__mixer_channel_mlp__prompt_kernel_k_ri_t
L_parallel_sum__linear_kernel_hedgehog__mixer_channel_mlp__prompt_kernel_k_ri_ok:
  v_lshlrev_b32 v18, 4, v1
  v_mov_b32 v19, 0x7fff0000
  v_cmp_gt_u32 vcc, 60, v1
  s_nop 1
  v_cndmask_b32 v18, v19, v18, vcc
  s_lshl_b32 s41, s38, 4
  s_mul_i32 s41, s41, 15360
  s_mul_i32 s42, s36, 960
  s_add_u32 s41, s41, s42
  s_add_u32 s41, s41, 18874368
  buffer_load_dwordx4 v[160:163], v18, s[24:27], s41 offen sc1
  s_add_u32 s41, s41, 15360
  buffer_load_dwordx4 v[164:167], v18, s[24:27], s41 offen sc1
  s_add_u32 s41, s41, 15360
  buffer_load_dwordx4 v[168:171], v18, s[24:27], s41 offen sc1
  s_add_u32 s41, s41, 15360
  buffer_load_dwordx4 v[172:175], v18, s[24:27], s41 offen sc1
  s_add_u32 s41, s41, 15360
  buffer_load_dwordx4 v[176:179], v18, s[24:27], s41 offen sc1
  s_add_u32 s41, s41, 15360
  buffer_load_dwordx4 v[180:183], v18, s[24:27], s41 offen sc1
  s_add_u32 s41, s41, 15360
  buffer_load_dwordx4 v[184:187], v18, s[24:27], s41 offen sc1
  s_add_u32 s41, s41, 15360
  buffer_load_dwordx4 v[188:191], v18, s[24:27], s41 offen sc1
  s_add_u32 s41, s41, 15360
  buffer_load_dwordx4 v[192:195], v18, s[24:27], s41 offen sc1
  s_add_u32 s41, s41, 15360
  buffer_load_dwordx4 v[196:199], v18, s[24:27], s41 offen sc1
  s_add_u32 s41, s41, 15360
  buffer_load_dwordx4 v[200:203], v18, s[24:27], s41 offen sc1
  s_add_u32 s41, s41, 15360
  buffer_load_dwordx4 v[204:207], v18, s[24:27], s41 offen sc1
  s_add_u32 s41, s41, 15360
  buffer_load_dwordx4 v[208:211], v18, s[24:27], s41 offen sc1
  s_add_u32 s41, s41, 15360
  buffer_load_dwordx4 v[212:215], v18, s[24:27], s41 offen sc1
  s_add_u32 s41, s41, 15360
  buffer_load_dwordx4 v[216:219], v18, s[24:27], s41 offen sc1
  s_add_u32 s41, s41, 15360
  buffer_load_dwordx4 v[220:223], v18, s[24:27], s41 offen sc1
  s_add_u32 s41, s41, 15360
L_parallel_sum__linear_kernel_hedgehog__mixer_channel_mlp__prompt_kernel_k_ri_x:
  s_lshl_b32 s41, s37, 2
  s_or_b32 s41, s41, s39
  s_cmp_eq_u32 s41, 0
  s_cbranch_scc0 L_parallel_sum__linear_kernel_hedgehog__mixer_channel_mlp__prompt_kernel_k_rs_x
  s_waitcnt vmcnt(0)
  v_pk_add_f32 v[160:161], v[160:161], v[164:165]
  v_pk_add_f32 v[162:163], v[162:163], v[166:167]
  v_pk_add_f32 v[168:169], v[168:169], v[172:173]
  v_pk_add_f32 v[170:171], v[170:171], v[174:175]
  v_pk_add_f32 v[176:177], v[176:177], v[180:181]
  v_pk_add_f32 v[178:179], v[178:179], v[182:183]
  v_pk_add_f32 v[184:185], v[184:185], v[188:189]
  v_pk_add_f32 v[186:187], v[186:187], v[190:191]
  v_pk_add_f32 v[192:193], v[192:193], v[196:197]
  v_pk_add_f32 v[194:195], v[194:195], v[198:199]
  v_pk_add_f32 v[200:201], v[200:201], v[204:205]
  v_pk_add_f32 v[202:203], v[202:203], v[206:207]
  v_pk_add_f32 v[208:209], v[208:209], v[212:213]
  v_pk_add_f32 v[210:211], v[210:211], v[214:215]
  v_pk_add_f32 v[216:217], v[216:217], v[220:221]
  v_pk_add_f32 v[218:219], v[218:219], v[222:223]
  v_pk_add_f32 v[160:161], v[160:161], v[168:169]
  v_pk_add_f32 v[162:163], v[162:163], v[170:171]
  v_pk_add_f32 v[176:177], v[176:177], v[184:185]
  v_pk_add_f32 v[178:179], v[178:179], v[186:187]
  v_pk_add_f32 v[192:193], v[192:193], v[200:201]
  v_pk_add_f32 v[194:195], v[194:195], v[202:203]
  v_pk_add_f32 v[208:209], v[208:209], v[216:217]
  v_pk_add_f32 v[210:211], v[210:211], v[218:219]
  v_pk_add_f32 v[160:161], v[160:161], v[176:177]
  v_pk_add_f32 v[162:163], v[162:163], v[178:179]
  v_pk_add_f32 v[192:193], v[192:193], v[208:209]
  v_pk_add_f32 v[194:195], v[194:195], v[210:211]
  v_pk_add_f32 v[160:161], v[160:161], v[192:193]
  v_pk_add_f32 v[162:163], v[162:163], v[194:195]
  v_cvt_pk_bf16_f32 v160, v160, v161
  v_cvt_pk_bf16_f32 v161, v162, v163
  v_lshlrev_b32 v18, 3, v1
  v_mov_b32 v19, 0x7fff0000
  v_cmp_gt_u32 vcc, 60, v1
  s_nop 1
  v_cndmask_b32 v18, v19, v18, vcc
  s_mul_i32 s41, s38, 7680
  s_mul_i32 s42, s36, 480
  s_add_u32 s41, s41, s42
  s_add_u32 s41, s41, 262144
  buffer_store_dwordx2 v[160:161], v18, s[24:27], s41 offen sc1
L_parallel_sum__linear_kernel_hedgehog__mixer_channel_mlp__prompt_kernel_k_rs_x:
  s_barrier
  ds_read_b128 v[64:67], v8 offset:0
  ds_read_b128 v[68:71], v4 offset:0
  ds_read_b128 v[72:75], v4 offset:1024
  ds_read_b128 v[76:79], v4 offset:2048
  ds_read_b128 v[80:83], v4 offset:3072
  ds_read_b128 v[84:87], v4 offset:4096
  ds_read_b128 v[88:91], v8 offset:1024
  ds_read_b128 v[92:95], v4 offset:5120
  ds_read_b128 v[96:99], v4 offset:6144
  ds_read_b128 v[100:103], v4 offset:7168
  ds_read_b128 v[104:107], v4 offset:8192
  ds_read_b128 v[108:111], v4 offset:9216
  s_waitcnt lgkmcnt(6)
  v_mfma_f32_16x16x32_bf16 v[32:35], v[68:71], v[64:67], v[32:35]
  ds_read_b128 v[112:115], v8 offset:2048
  v_mfma_f32_16x16x32_bf16 v[36:39], v[72:75], v[64:67], v[36:39]
  ds_read_b128 v[116:119], v4 offset:10240
  v_mfma_f32_16x16x32_bf16 v[40:43], v[76:79], v[64:67], v[40:43]
  ds_read_b128 v[120:123], v4 offset:11264
  v_mfma_f32_16x16x32_bf16 v[44:47], v[80:83], v[64:67], v[44:47]
  ds_read_b128 v[124:127], v4 offset:12288
  v_mfma_f32_16x16x32_bf16 v[48:51], v[84:87], v[64:67], v[48:51]
  ds_read_b128 v[128:131], v4 offset:13312
  ds_read_b128 v[132:135], v4 offset:14336
  s_waitcnt lgkmcnt(6)
  v_mfma_f32_16x16x32_bf16 v[32:35], v[92:95], v[88:91], v[32:35]
  ds_read_b128 v[136:139], v8 offset:3072
  v_mfma_f32_16x16x32_bf16 v[36:39], v[96:99], v[88:91], v[36:39]
  ds_read_b128 v[140:143], v4 offset:15360
  v_mfma_f32_16x16x32_bf16 v[40:43], v[100:103], v[88:91], v[40:43]
  ds_read_b128 v[144:147], v4 offset:16384
  v_mfma_f32_16x16x32_bf16 v[44:47], v[104:107], v[88:91], v[44:47]
  ds_read_b128 v[148:151], v4 offset:17408
  v_mfma_f32_16x16x32_bf16 v[48:51], v[108:111], v[88:91], v[48:51]
  ds_read_b128 v[152:155], v4 offset:18432
  ds_read_b128 v[156:159], v4 offset:19456
  s_waitcnt lgkmcnt(0)
  s_barrier
  v_and_b32 v12, 15, v1
  v_lshrrev_b32 v13, 4, v1
  v_mul_u32_u24 v14, 640, v13
  v_lshl_add_u32 v14, v12, 3, v14
  s_mul_i32 s58, s86, 160
  s_mul_i32 s59, s69, 20
  s_add_u32 s58, s58, s59
  s_lshl_b32 s58, s58, 7
  s_add_u32 s58, s58, 524288
  s_lshl_b32 s59, s86, 4
  v_add_u32 v15, s59, v12
  v_lshlrev_b32 v15, 4, v15
  buffer_load_dwordx2 v[172:173], v14, s[24:27], s58 offen offset:0 sc1
  buffer_load_dwordx2 v[174:175], v14, s[24:27], s58 offen offset:128 sc1
  buffer_load_dwordx2 v[176:177], v14, s[24:27], s58 offen offset:256 sc1
  buffer_load_dwordx2 v[178:179], v14, s[24:27], s58 offen offset:384 sc1
  buffer_load_dwordx2 v[180:181], v14, s[24:27], s58 offen offset:512 sc1
  buffer_load_dword v21, v15, s[24:27], 0 offen offset:4 sc1
  v_mfma_f32_16x16x32_bf16 v[32:35], v[116:119], v[112:115], v[32:35]
  ds_read_b128 v[64:67], v9 offset:0
  v_mfma_f32_16x16x32_bf16 v[36:39], v[120:123], v[112:115], v[36:39]
  ds_read_b128 v[68:71], v5 offset:0
  v_mfma_f32_16x16x32_bf16 v[40:43], v[124:127], v[112:115], v[40:43]
  ds_read_b128 v[72:75], v5 offset:1024
  v_mfma_f32_16x16x32_bf16 v[44:47], v[128:131], v[112:115], v[44:47]
  ds_read_b128 v[76:79], v5 offset:2048
  v_mfma_f32_16x16x32_bf16 v[48:51], v[132:135], v[112:115], v[48:51]
  ds_read_b128 v[80:83], v5 offset:3072
  ds_read_b128 v[84:87], v5 offset:4096
  v_mfma_f32_16x16x32_bf16 v[32:35], v[140:143], v[136:139], v[32:35]
  ds_read_b128 v[88:91], v9 offset:1024
  v_mfma_f32_16x16x32_bf16 v[36:39], v[144:147], v[136:139], v[36:39]
  ds_read_b128 v[92:95], v5 offset:5120
  v_mfma_f32_16x16x32_bf16 v[40:43], v[148:151], v[136:139], v[40:43]
  ds_read_b128 v[96:99], v5 offset:6144
  v_mfma_f32_16x16x32_bf16 v[44:47], v[152:155], v[136:139], v[44:47]
  ds_read_b128 v[100:103], v5 offset:7168
  v_mfma_f32_16x16x32_bf16 v[48:51], v[156:159], v[136:139], v[48:51]
  ds_read_b128 v[104:107], v5 offset:8192
  ds_read_b128 v[108:111], v5 offset:9216
  s_lshl_b32 s41, s37, 2
  s_or_b32 s41, s41, s39
  s_cmp_eq_u32 s41, 0
  s_cbranch_scc0 L_parallel_sum__linear_kernel_hedgehog__mixer_channel_mlp__prompt_kernel_k_rf_x
  s_waitcnt vmcnt(6)
  s_lshl_b32 s41, s38, 2
  s_lshr_b32 s42, s36, 2
  s_add_u32 s41, s41, s42
  s_lshl_b32 s41, s41, 7
  s_and_b32 s42, s36, 3
  s_add_u32 s41, s41, s42
  s_add_u32 s41, s41, 21014528
  v_mov_b32 v2, s41
  v_mov_b32 v0, 1
  s_mov_b64 exec, 1
  buffer_store_byte v0, v2, s[24:27], 0 offen sc1
  s_mov_b64 exec, -1
L_parallel_sum__linear_kernel_hedgehog__mixer_channel_mlp__prompt_kernel_k_rf_x:
  s_waitcnt lgkmcnt(6)
  v_mfma_f32_16x16x32_bf16 v[32:35], v[68:71], v[64:67], v[32:35]
  ds_read_b128 v[112:115], v9 offset:2048
  v_mfma_f32_16x16x32_bf16 v[36:39], v[72:75], v[64:67], v[36:39]
  ds_read_b128 v[116:119], v5 offset:10240
  v_mfma_f32_16x16x32_bf16 v[40:43], v[76:79], v[64:67], v[40:43]
  ds_read_b128 v[120:123], v5 offset:11264
  v_mfma_f32_16x16x32_bf16 v[44:47], v[80:83], v[64:67], v[44:47]
  ds_read_b128 v[124:127], v5 offset:12288
  v_mfma_f32_16x16x32_bf16 v[48:51], v[84:87], v[64:67], v[48:51]
  ds_read_b128 v[128:131], v5 offset:13312
  ds_read_b128 v[132:135], v5 offset:14336
  s_waitcnt lgkmcnt(6)
  v_mfma_f32_16x16x32_bf16 v[32:35], v[92:95], v[88:91], v[32:35]
  ds_read_b128 v[136:139], v9 offset:3072
  v_mfma_f32_16x16x32_bf16 v[36:39], v[96:99], v[88:91], v[36:39]
  ds_read_b128 v[140:143], v5 offset:15360
  v_mfma_f32_16x16x32_bf16 v[40:43], v[100:103], v[88:91], v[40:43]
  ds_read_b128 v[144:147], v5 offset:16384
  v_mfma_f32_16x16x32_bf16 v[44:47], v[104:107], v[88:91], v[44:47]
  ds_read_b128 v[148:151], v5 offset:17408
  v_mfma_f32_16x16x32_bf16 v[48:51], v[108:111], v[88:91], v[48:51]
  ds_read_b128 v[152:155], v5 offset:18432
  ds_read_b128 v[156:159], v5 offset:19456
  s_waitcnt lgkmcnt(0)
  s_cmp_eq_u32 s37, 0
  s_cbranch_scc1 L_parallel_sum__linear_kernel_hedgehog__mixer_channel_mlp__prompt_kernel_k_h2w
  s_waitcnt vmcnt(6)
L_parallel_sum__linear_kernel_hedgehog__mixer_channel_mlp__prompt_kernel_k_h2w:
  s_barrier
  s_cmp_eq_u32 s37, 0
  s_cbranch_scc1 L_parallel_sum__linear_kernel_hedgehog__mixer_channel_mlp__prompt_kernel_k_fh2_b
  s_cmp_eq_u32 s39, 0
  s_cbranch_scc0 L_parallel_sum__linear_kernel_hedgehog__mixer_channel_mlp__prompt_kernel_k_fh2
  s_lshl_b32 s41, s36, 1
  s_lshr_b32 s42, s38, 2
  s_add_u32 s41, s41, s42
  s_lshl_b32 s41, s41, 7
  s_and_b32 s42, s38, 3
  s_add_u32 s41, s41, s42
  s_add_u32 s41, s41, 20977664
  v_mov_b32 v2, s41
  v_mov_b32 v0, 1
  s_mov_b64 exec, 1
  buffer_store_byte v0, v2, s[24:27], 0 offen sc1
  s_mov_b64 exec, -1
L_parallel_sum__linear_kernel_hedgehog__mixer_channel_mlp__prompt_kernel_k_fh2:
L_parallel_sum__linear_kernel_hedgehog__mixer_channel_mlp__prompt_kernel_k_fh2_b:
  v_mfma_f32_16x16x32_bf16 v[32:35], v[116:119], v[112:115], v[32:35]
  ds_read_b128 v[64:67], v10 offset:0
  v_mfma_f32_16x16x32_bf16 v[36:39], v[120:123], v[112:115], v[36:39]
  ds_read_b128 v[68:71], v6 offset:0
  v_mfma_f32_16x16x32_bf16 v[40:43], v[124:127], v[112:115], v[40:43]
  ds_read_b128 v[72:75], v6 offset:1024
  v_mfma_f32_16x16x32_bf16 v[44:47], v[128:131], v[112:115], v[44:47]
  ds_read_b128 v[76:79], v6 offset:2048
  v_mfma_f32_16x16x32_bf16 v[48:51], v[132:135], v[112:115], v[48:51]
  ds_read_b128 v[80:83], v6 offset:3072
  ds_read_b128 v[84:87], v6 offset:4096
  v_mfma_f32_16x16x32_bf16 v[32:35], v[140:143], v[136:139], v[32:35]
  ds_read_b128 v[88:91], v10 offset:1024
  v_mfma_f32_16x16x32_bf16 v[36:39], v[144:147], v[136:139], v[36:39]
  ds_read_b128 v[92:95], v6 offset:5120
  v_mfma_f32_16x16x32_bf16 v[40:43], v[148:151], v[136:139], v[40:43]
  ds_read_b128 v[96:99], v6 offset:6144
  v_mfma_f32_16x16x32_bf16 v[44:47], v[152:155], v[136:139], v[44:47]
  ds_read_b128 v[100:103], v6 offset:7168
  v_mfma_f32_16x16x32_bf16 v[48:51], v[156:159], v[136:139], v[48:51]
  ds_read_b128 v[104:107], v6 offset:8192
  ds_read_b128 v[108:111], v6 offset:9216
  ds_read_b64_tr_b16 v[112:113], v28 offset:0
  ds_read_b64_tr_b16 v[114:115], v28 offset:160
  ds_read_b64_tr_b16 v[116:117], v28 offset:320
  ds_read_b64_tr_b16 v[118:119], v28 offset:480
  ds_read_b64_tr_b16 v[120:121], v28 offset:640
  v_mov_b32 v122, 0
  v_mov_b32 v123, 0
  ds_read_b64_tr_b16 v[124:125], v28 offset:8
  ds_read_b64_tr_b16 v[126:127], v28 offset:168
  ds_read_b64_tr_b16 v[128:129], v28 offset:328
  ds_read_b64_tr_b16 v[130:131], v28 offset:488
  ds_read_b64_tr_b16 v[132:133], v28 offset:648
  v_mov_b32 v134, 0
  v_mov_b32 v135, 0
  ds_read_b64_tr_b16 v[136:137], v28 offset:16
  ds_read_b64_tr_b16 v[138:139], v28 offset:176
  ds_read_b64_tr_b16 v[140:141], v28 offset:336
  ds_read_b64_tr_b16 v[142:143], v28 offset:496
  ds_read_b64_tr_b16 v[144:145], v28 offset:656
  v_mov_b32 v146, 0
  v_mov_b32 v147, 0
  ds_read_b64_tr_b16 v[148:149], v28 offset:24
  ds_read_b64_tr_b16 v[150:151], v28 offset:184
  ds_read_b64_tr_b16 v[152:153], v28 offset:344
  ds_read_b64_tr_b16 v[154:155], v28 offset:504
  ds_read_b64_tr_b16 v[156:157], v28 offset:664
  v_mov_b32 v158, 0
  v_mov_b32 v159, 0
  ds_read_b64_tr_b16 v[160:161], v28 offset:32
  ds_read_b64_tr_b16 v[162:163], v28 offset:192
  ds_read_b64_tr_b16 v[164:165], v28 offset:352
  ds_read_b64_tr_b16 v[166:167], v28 offset:512
  ds_read_b64_tr_b16 v[168:169], v28 offset:672
  v_mov_b32 v170, 0
  v_mov_b32 v171, 0
  v_mov_b32 v182, 0
  v_mov_b32 v183, 0
  s_waitcnt vmcnt(0)
  s_waitcnt lgkmcnt(0)
  v_mfma_f32_16x16x32_bf16 v[184:187], v[112:115], v[172:175], 0
  v_mfma_f32_16x16x32_bf16 v[188:191], v[124:127], v[172:175], 0
  v_mfma_f32_16x16x32_bf16 v[192:195], v[136:139], v[172:175], 0
  v_mfma_f32_16x16x32_bf16 v[196:199], v[148:151], v[172:175], 0
  v_mfma_f32_16x16x32_bf16 v[200:203], v[160:163], v[172:175], 0
  v_mfma_f32_16x16x32_bf16 v[184:187], v[116:119], v[176:179], v[184:187]
  v_mfma_f32_16x16x32_bf16 v[188:191], v[128:131], v[176:179], v[188:191]
  v_mfma_f32_16x16x32_bf16 v[192:195], v[140:143], v[176:179], v[192:195]
  v_mfma_f32_16x16x32_bf16 v[196:199], v[152:155], v[176:179], v[196:199]
  v_mfma_f32_16x16x32_bf16 v[200:203], v[164:167], v[176:179], v[200:203]
  v_mfma_f32_16x16x32_bf16 v[184:187], v[120:123], v[180:183], v[184:187]
  v_mfma_f32_16x16x32_bf16 v[188:191], v[132:135], v[180:183], v[188:191]
  v_mfma_f32_16x16x32_bf16 v[192:195], v[144:147], v[180:183], v[192:195]
  v_mfma_f32_16x16x32_bf16 v[196:199], v[156:159], v[180:183], v[196:199]
  v_mfma_f32_16x16x32_bf16 v[200:203], v[168:171], v[180:183], v[200:203]
  s_nop 3
  v_max3_f32 v52, v184, v185, v186
  v_min3_f32 v53, v184, v185, v186
  v_max3_f32 v54, v187, v188, v189
  v_min3_f32 v55, v187, v188, v189
  v_max3_f32 v52, v52, v190, v191
  v_min3_f32 v53, v53, v190, v191
  v_max3_f32 v54, v54, v192, v193
  v_min3_f32 v55, v55, v192, v193
  v_max3_f32 v52, v52, v194, v195
  v_min3_f32 v53, v53, v194, v195
  v_max3_f32 v54, v54, v196, v197
  v_min3_f32 v55, v55, v196, v197
  v_max3_f32 v52, v52, v198, v199
  v_min3_f32 v53, v53, v198, v199
  v_max3_f32 v54, v54, v200, v201
  v_min3_f32 v55, v55, v200, v201
  v_max3_f32 v52, v52, v202, v203
  v_min3_f32 v53, v53, v202, v203
  v_max_f32 v52, v52, v54
  v_min_f32 v53, v53, v55
  v_mul_f32 v54, 0x3fb8aa3b, v21
  v_mov_b32 v55, v54
  v_mul_f32 v2, v52, v54
  v_mul_f32 v0, v53, v54
  v_sub_f32 v52, 0, v2
  v_sub_f32 v53, 0, v2
  v_pk_fma_f32 v[112:113], v[184:185], v[54:55], v[52:53]
  v_pk_fma_f32 v[114:115], v[186:187], v[54:55], v[52:53]
  v_pk_fma_f32 v[116:117], v[188:189], v[54:55], v[52:53]
  v_pk_fma_f32 v[118:119], v[190:191], v[54:55], v[52:53]
  v_pk_fma_f32 v[120:121], v[192:193], v[54:55], v[52:53]
  v_pk_fma_f32 v[122:123], v[194:195], v[54:55], v[52:53]
  v_pk_fma_f32 v[124:125], v[196:197], v[54:55], v[52:53]
  v_pk_fma_f32 v[126:127], v[198:199], v[54:55], v[52:53]
  v_pk_fma_f32 v[128:129], v[200:201], v[54:55], v[52:53]
  v_pk_fma_f32 v[130:131], v[202:203], v[54:55], v[52:53]
  v_mov_b32 v52, v0
  v_mov_b32 v53, v0
  v_pk_fma_f32 v[132:133], v[184:185], v[54:55], v[52:53] neg_lo:[1,0,0] neg_hi:[1,0,0]
  v_pk_fma_f32 v[134:135], v[186:187], v[54:55], v[52:53] neg_lo:[1,0,0] neg_hi:[1,0,0]
  v_pk_fma_f32 v[136:137], v[188:189], v[54:55], v[52:53] neg_lo:[1,0,0] neg_hi:[1,0,0]
  v_pk_fma_f32 v[138:139], v[190:191], v[54:55], v[52:53] neg_lo:[1,0,0] neg_hi:[1,0,0]
  v_pk_fma_f32 v[140:141], v[192:193], v[54:55], v[52:53] neg_lo:[1,0,0] neg_hi:[1,0,0]
  v_pk_fma_f32 v[142:143], v[194:195], v[54:55], v[52:53] neg_lo:[1,0,0] neg_hi:[1,0,0]
  v_pk_fma_f32 v[144:145], v[196:197], v[54:55], v[52:53] neg_lo:[1,0,0] neg_hi:[1,0,0]
  v_pk_fma_f32 v[146:147], v[198:199], v[54:55], v[52:53] neg_lo:[1,0,0] neg_hi:[1,0,0]
  v_pk_fma_f32 v[148:149], v[200:201], v[54:55], v[52:53] neg_lo:[1,0,0] neg_hi:[1,0,0]
  v_pk_fma_f32 v[150:151], v[202:203], v[54:55], v[52:53] neg_lo:[1,0,0] neg_hi:[1,0,0]
  v_exp_f32 v112, v112
  v_exp_f32 v113, v113
  v_exp_f32 v114, v114
  v_exp_f32 v115, v115
  v_exp_f32 v116, v116
  v_exp_f32 v117, v117
  v_exp_f32 v118, v118
  v_exp_f32 v119, v119
  v_exp_f32 v120, v120
  v_exp_f32 v121, v121
  v_exp_f32 v122, v122
  v_exp_f32 v123, v123
  v_exp_f32 v124, v124
  v_exp_f32 v125, v125
  v_exp_f32 v126, v126
  v_exp_f32 v127, v127
  v_exp_f32 v128, v128
  v_exp_f32 v129, v129
  v_exp_f32 v130, v130
  v_exp_f32 v131, v131
  v_exp_f32 v132, v132
  v_exp_f32 v133, v133
  v_exp_f32 v134, v134
  v_exp_f32 v135, v135
  v_exp_f32 v136, v136
  v_exp_f32 v137, v137
  v_exp_f32 v138, v138
  v_exp_f32 v139, v139
  v_exp_f32 v140, v140
  v_exp_f32 v141, v141
  v_exp_f32 v142, v142
  v_exp_f32 v143, v143
  v_exp_f32 v144, v144
  v_exp_f32 v145, v145
  v_exp_f32 v146, v146
  v_exp_f32 v147, v147
  v_exp_f32 v148, v148
  v_exp_f32 v149, v149
  v_exp_f32 v150, v150
  v_exp_f32 v151, v151
  v_pk_add_f32 v[52:53], v[112:113], v[114:115]
  v_pk_add_f32 v[54:55], v[132:133], v[134:135]
  v_pk_add_f32 v[52:53], v[52:53], v[116:117]
  v_pk_add_f32 v[54:55], v[54:55], v[136:137]
  v_pk_add_f32 v[52:53], v[52:53], v[118:119]
  v_pk_add_f32 v[54:55], v[54:55], v[138:139]
  v_pk_add_f32 v[52:53], v[52:53], v[120:121]
  v_pk_add_f32 v[54:55], v[54:55], v[140:141]
  v_pk_add_f32 v[52:53], v[52:53], v[122:123]
  v_pk_add_f32 v[54:55], v[54:55], v[142:143]
  v_pk_add_f32 v[52:53], v[52:53], v[124:125]
  v_pk_add_f32 v[54:55], v[54:55], v[144:145]
  v_pk_add_f32 v[52:53], v[52:53], v[126:127]
  v_pk_add_f32 v[54:55], v[54:55], v[146:147]
  v_pk_add_f32 v[52:53], v[52:53], v[128:129]
  v_pk_add_f32 v[54:55], v[54:55], v[148:149]
  v_pk_add_f32 v[52:53], v[52:53], v[130:131]
  v_pk_add_f32 v[54:55], v[54:55], v[150:151]
  v_add_f32 v52, v52, v53
  v_add_f32 v54, v54, v55
  v_rcp_f32 v52, v52
  v_rcp_f32 v54, v54
  v_mov_b32 v53, v52
  v_mov_b32 v55, v54
  v_pk_mul_f32 v[112:113], v[112:113], v[52:53]
  v_pk_mul_f32 v[132:133], v[132:133], v[54:55]
  v_pk_mul_f32 v[114:115], v[114:115], v[52:53]
  v_pk_mul_f32 v[134:135], v[134:135], v[54:55]
  v_pk_mul_f32 v[116:117], v[116:117], v[52:53]
  v_pk_mul_f32 v[136:137], v[136:137], v[54:55]
  v_pk_mul_f32 v[118:119], v[118:119], v[52:53]
  v_pk_mul_f32 v[138:139], v[138:139], v[54:55]
  v_pk_mul_f32 v[120:121], v[120:121], v[52:53]
  v_pk_mul_f32 v[140:141], v[140:141], v[54:55]
  v_pk_mul_f32 v[122:123], v[122:123], v[52:53]
  v_pk_mul_f32 v[142:143], v[142:143], v[54:55]
  v_pk_mul_f32 v[124:125], v[124:125], v[52:53]
  v_pk_mul_f32 v[144:145], v[144:145], v[54:55]
  v_pk_mul_f32 v[126:127], v[126:127], v[52:53]
  v_pk_mul_f32 v[146:147], v[146:147], v[54:55]
  v_pk_mul_f32 v[128:129], v[128:129], v[52:53]
  v_pk_mul_f32 v[148:149], v[148:149], v[54:55]
  v_pk_mul_f32 v[130:131], v[130:131], v[52:53]
  v_pk_mul_f32 v[150:151], v[150:151], v[54:55]
  v_cvt_pk_bf16_f32 v160, v112, v113
  v_cvt_pk_bf16_f32 v161, v114, v115
  v_cvt_pk_bf16_f32 v162, v116, v117
  v_cvt_pk_bf16_f32 v163, v118, v119
  v_cvt_pk_bf16_f32 v164, v120, v121
  v_cvt_pk_bf16_f32 v165, v122, v123
  v_cvt_pk_bf16_f32 v166, v124, v125
  v_cvt_pk_bf16_f32 v167, v126, v127
  v_cvt_pk_bf16_f32 v168, v128, v129
  v_cvt_pk_bf16_f32 v169, v130, v131
  v_cvt_pk_bf16_f32 v170, v132, v133
  v_cvt_pk_bf16_f32 v171, v134, v135
  v_cvt_pk_bf16_f32 v172, v136, v137
  v_cvt_pk_bf16_f32 v173, v138, v139
  v_cvt_pk_bf16_f32 v174, v140, v141
  v_cvt_pk_bf16_f32 v175, v142, v143
  v_cvt_pk_bf16_f32 v176, v144, v145
  v_cvt_pk_bf16_f32 v177, v146, v147
  v_cvt_pk_bf16_f32 v178, v148, v149
  v_cvt_pk_bf16_f32 v179, v150, v151
  v_mfma_f32_16x16x32_bf16 v[32:35], v[68:71], v[64:67], v[32:35]
  ds_read_b128 v[112:115], v10 offset:2048
  v_mfma_f32_16x16x32_bf16 v[36:39], v[72:75], v[64:67], v[36:39]
  ds_read_b128 v[116:119], v6 offset:10240
  v_mfma_f32_16x16x32_bf16 v[40:43], v[76:79], v[64:67], v[40:43]
  ds_read_b128 v[120:123], v6 offset:11264
  v_mfma_f32_16x16x32_bf16 v[44:47], v[80:83], v[64:67], v[44:47]
  ds_read_b128 v[124:127], v6 offset:12288
  v_mfma_f32_16x16x32_bf16 v[48:51], v[84:87], v[64:67], v[48:51]
  ds_read_b128 v[128:131], v6 offset:13312
  ds_read_b128 v[132:135], v6 offset:14336
  v_mfma_f32_16x16x32_bf16 v[32:35], v[92:95], v[88:91], v[32:35]
  ds_read_b128 v[136:139], v10 offset:3072
  v_mfma_f32_16x16x32_bf16 v[36:39], v[96:99], v[88:91], v[36:39]
  ds_read_b128 v[140:143], v6 offset:15360
  v_mfma_f32_16x16x32_bf16 v[40:43], v[100:103], v[88:91], v[40:43]
  ds_read_b128 v[144:147], v6 offset:16384
  v_mfma_f32_16x16x32_bf16 v[44:47], v[104:107], v[88:91], v[44:47]
  ds_read_b128 v[148:151], v6 offset:17408
  v_mfma_f32_16x16x32_bf16 v[48:51], v[108:111], v[88:91], v[48:51]
  ds_read_b128 v[152:155], v6 offset:18432
  ds_read_b128 v[156:159], v6 offset:19456
  s_waitcnt lgkmcnt(0)
  s_barrier
  v_mfma_f32_16x16x32_bf16 v[32:35], v[116:119], v[112:115], v[32:35]
  ds_read_b128 v[64:67], v11 offset:0
  v_mfma_f32_16x16x32_bf16 v[36:39], v[120:123], v[112:115], v[36:39]
  ds_read_b128 v[68:71], v7 offset:0
  v_mfma_f32_16x16x32_bf16 v[40:43], v[124:127], v[112:115], v[40:43]
  ds_read_b128 v[72:75], v7 offset:1024
  v_mfma_f32_16x16x32_bf16 v[44:47], v[128:131], v[112:115], v[44:47]
  ds_read_b128 v[76:79], v7 offset:2048
  v_mfma_f32_16x16x32_bf16 v[48:51], v[132:135], v[112:115], v[48:51]
  ds_read_b128 v[80:83], v7 offset:3072
  ds_read_b128 v[84:87], v7 offset:4096
  v_mfma_f32_16x16x32_bf16 v[32:35], v[140:143], v[136:139], v[32:35]
  ds_read_b128 v[88:91], v11 offset:1024
  v_mfma_f32_16x16x32_bf16 v[36:39], v[144:147], v[136:139], v[36:39]
  ds_read_b128 v[92:95], v7 offset:5120
  v_mfma_f32_16x16x32_bf16 v[40:43], v[148:151], v[136:139], v[40:43]
  ds_read_b128 v[96:99], v7 offset:6144
  v_mfma_f32_16x16x32_bf16 v[44:47], v[152:155], v[136:139], v[44:47]
  ds_read_b128 v[100:103], v7 offset:7168
  v_mfma_f32_16x16x32_bf16 v[48:51], v[156:159], v[136:139], v[48:51]
  ds_read_b128 v[104:107], v7 offset:8192
  ds_read_b128 v[108:111], v7 offset:9216
  s_waitcnt lgkmcnt(6)
  v_mfma_f32_16x16x32_bf16 v[32:35], v[68:71], v[64:67], v[32:35]
  ds_read_b128 v[112:115], v11 offset:2048
  v_mfma_f32_16x16x32_bf16 v[36:39], v[72:75], v[64:67], v[36:39]
  ds_read_b128 v[116:119], v7 offset:10240
  v_mfma_f32_16x16x32_bf16 v[40:43], v[76:79], v[64:67], v[40:43]
  ds_read_b128 v[120:123], v7 offset:11264
  v_mfma_f32_16x16x32_bf16 v[44:47], v[80:83], v[64:67], v[44:47]
  ds_read_b128 v[124:127], v7 offset:12288
  v_mfma_f32_16x16x32_bf16 v[48:51], v[84:87], v[64:67], v[48:51]
  ds_read_b128 v[128:131], v7 offset:13312
  ds_read_b128 v[132:135], v7 offset:14336
  s_waitcnt lgkmcnt(6)
  v_mfma_f32_16x16x32_bf16 v[32:35], v[92:95], v[88:91], v[32:35]
  ds_read_b128 v[136:139], v11 offset:3072
  v_mfma_f32_16x16x32_bf16 v[36:39], v[96:99], v[88:91], v[36:39]
  ds_read_b128 v[140:143], v7 offset:15360
  v_mfma_f32_16x16x32_bf16 v[40:43], v[100:103], v[88:91], v[40:43]
  ds_read_b128 v[144:147], v7 offset:16384
  v_mfma_f32_16x16x32_bf16 v[44:47], v[104:107], v[88:91], v[44:47]
  ds_read_b128 v[148:151], v7 offset:17408
  v_mfma_f32_16x16x32_bf16 v[48:51], v[108:111], v[88:91], v[48:51]
  ds_read_b128 v[152:155], v7 offset:18432
  ds_read_b128 v[156:159], v7 offset:19456
  s_waitcnt lgkmcnt(0)
  s_barrier
  v_mfma_f32_16x16x32_bf16 v[32:35], v[116:119], v[112:115], v[32:35]
  ds_read_b128 v[64:67], v8 offset:0
  v_mfma_f32_16x16x32_bf16 v[36:39], v[120:123], v[112:115], v[36:39]
  ds_read_b128 v[68:71], v4 offset:0
  v_mfma_f32_16x16x32_bf16 v[40:43], v[124:127], v[112:115], v[40:43]
  ds_read_b128 v[72:75], v4 offset:1024
  v_mfma_f32_16x16x32_bf16 v[44:47], v[128:131], v[112:115], v[44:47]
  ds_read_b128 v[76:79], v4 offset:2048
  v_mfma_f32_16x16x32_bf16 v[48:51], v[132:135], v[112:115], v[48:51]
  ds_read_b128 v[80:83], v4 offset:3072
  ds_read_b128 v[84:87], v4 offset:4096
  v_mfma_f32_16x16x32_bf16 v[32:35], v[140:143], v[136:139], v[32:35]
  ds_read_b128 v[88:91], v8 offset:1024
  v_mfma_f32_16x16x32_bf16 v[36:39], v[144:147], v[136:139], v[36:39]
  ds_read_b128 v[92:95], v4 offset:5120
  v_mfma_f32_16x16x32_bf16 v[40:43], v[148:151], v[136:139], v[40:43]
  ds_read_b128 v[96:99], v4 offset:6144
  v_mfma_f32_16x16x32_bf16 v[44:47], v[152:155], v[136:139], v[44:47]
  ds_read_b128 v[100:103], v4 offset:7168
  v_mfma_f32_16x16x32_bf16 v[48:51], v[156:159], v[136:139], v[48:51]
  ds_read_b128 v[104:107], v4 offset:8192
  ds_read_b128 v[108:111], v4 offset:9216
  s_waitcnt lgkmcnt(6)
  v_mfma_f32_16x16x32_bf16 v[32:35], v[68:71], v[64:67], v[32:35]
  ds_read_b128 v[112:115], v8 offset:2048
  v_mfma_f32_16x16x32_bf16 v[36:39], v[72:75], v[64:67], v[36:39]
  ds_read_b128 v[116:119], v4 offset:10240
  v_mfma_f32_16x16x32_bf16 v[40:43], v[76:79], v[64:67], v[40:43]
  ds_read_b128 v[120:123], v4 offset:11264
  v_mfma_f32_16x16x32_bf16 v[44:47], v[80:83], v[64:67], v[44:47]
  ds_read_b128 v[124:127], v4 offset:12288
  v_mfma_f32_16x16x32_bf16 v[48:51], v[84:87], v[64:67], v[48:51]
  ds_read_b128 v[128:131], v4 offset:13312
  ds_read_b128 v[132:135], v4 offset:14336
  s_waitcnt lgkmcnt(6)
  v_mfma_f32_16x16x32_bf16 v[32:35], v[92:95], v[88:91], v[32:35]
  ds_read_b128 v[136:139], v8 offset:3072
  v_mfma_f32_16x16x32_bf16 v[36:39], v[96:99], v[88:91], v[36:39]
  ds_read_b128 v[140:143], v4 offset:15360
  v_mfma_f32_16x16x32_bf16 v[40:43], v[100:103], v[88:91], v[40:43]
  ds_read_b128 v[144:147], v4 offset:16384
  v_mfma_f32_16x16x32_bf16 v[44:47], v[104:107], v[88:91], v[44:47]
  ds_read_b128 v[148:151], v4 offset:17408
  v_mfma_f32_16x16x32_bf16 v[48:51], v[108:111], v[88:91], v[48:51]
  ds_read_b128 v[152:155], v4 offset:18432
  ds_read_b128 v[156:159], v4 offset:19456
  s_waitcnt lgkmcnt(0)
  s_barrier
  v_mfma_f32_16x16x32_bf16 v[32:35], v[116:119], v[112:115], v[32:35]
  ds_read_b128 v[64:67], v9 offset:0
  v_mfma_f32_16x16x32_bf16 v[36:39], v[120:123], v[112:115], v[36:39]
  ds_read_b128 v[68:71], v5 offset:0
  v_mfma_f32_16x16x32_bf16 v[40:43], v[124:127], v[112:115], v[40:43]
  ds_read_b128 v[72:75], v5 offset:1024
  v_mfma_f32_16x16x32_bf16 v[44:47], v[128:131], v[112:115], v[44:47]
  ds_read_b128 v[76:79], v5 offset:2048
  v_mfma_f32_16x16x32_bf16 v[48:51], v[132:135], v[112:115], v[48:51]
  ds_read_b128 v[80:83], v5 offset:3072
  ds_read_b128 v[84:87], v5 offset:4096
  v_mfma_f32_16x16x32_bf16 v[32:35], v[140:143], v[136:139], v[32:35]
  ds_read_b128 v[88:91], v9 offset:1024
  v_mfma_f32_16x16x32_bf16 v[36:39], v[144:147], v[136:139], v[36:39]
  ds_read_b128 v[92:95], v5 offset:5120
  v_mfma_f32_16x16x32_bf16 v[40:43], v[148:151], v[136:139], v[40:43]
  ds_read_b128 v[96:99], v5 offset:6144
  v_mfma_f32_16x16x32_bf16 v[44:47], v[152:155], v[136:139], v[44:47]
  ds_read_b128 v[100:103], v5 offset:7168
  v_mfma_f32_16x16x32_bf16 v[48:51], v[156:159], v[136:139], v[48:51]
  ds_read_b128 v[104:107], v5 offset:8192
  ds_read_b128 v[108:111], v5 offset:9216
  s_waitcnt lgkmcnt(6)
  v_mfma_f32_16x16x32_bf16 v[32:35], v[68:71], v[64:67], v[32:35]
  ds_read_b128 v[112:115], v9 offset:2048
  v_mfma_f32_16x16x32_bf16 v[36:39], v[72:75], v[64:67], v[36:39]
  ds_read_b128 v[116:119], v5 offset:10240
  v_mfma_f32_16x16x32_bf16 v[40:43], v[76:79], v[64:67], v[40:43]
  ds_read_b128 v[120:123], v5 offset:11264
  v_mfma_f32_16x16x32_bf16 v[44:47], v[80:83], v[64:67], v[44:47]
  ds_read_b128 v[124:127], v5 offset:12288
  v_mfma_f32_16x16x32_bf16 v[48:51], v[84:87], v[64:67], v[48:51]
  ds_read_b128 v[128:131], v5 offset:13312
  ds_read_b128 v[132:135], v5 offset:14336
  s_waitcnt lgkmcnt(6)
  v_mfma_f32_16x16x32_bf16 v[32:35], v[92:95], v[88:91], v[32:35]
  ds_read_b128 v[136:139], v9 offset:3072
  v_mfma_f32_16x16x32_bf16 v[36:39], v[96:99], v[88:91], v[36:39]
  ds_read_b128 v[140:143], v5 offset:15360
  v_mfma_f32_16x16x32_bf16 v[40:43], v[100:103], v[88:91], v[40:43]
  ds_read_b128 v[144:147], v5 offset:16384
  v_mfma_f32_16x16x32_bf16 v[44:47], v[104:107], v[88:91], v[44:47]
  ds_read_b128 v[148:151], v5 offset:17408
  v_mfma_f32_16x16x32_bf16 v[48:51], v[108:111], v[88:91], v[48:51]
  ds_read_b128 v[152:155], v5 offset:18432
  ds_read_b128 v[156:159], v5 offset:19456
  s_waitcnt lgkmcnt(0)
  s_barrier
  v_mfma_f32_16x16x32_bf16 v[32:35], v[116:119], v[112:115], v[32:35]
  ds_read_b128 v[64:67], v10 offset:0
  v_mfma_f32_16x16x32_bf16 v[36:39], v[120:123], v[112:115], v[36:39]
  ds_read_b128 v[68:71], v6 offset:0
  v_mfma_f32_16x16x32_bf16 v[40:43], v[124:127], v[112:115], v[40:43]
  ds_read_b128 v[72:75], v6 offset:1024
  v_mfma_f32_16x16x32_bf16 v[44:47], v[128:131], v[112:115], v[44:47]
  ds_read_b128 v[76:79], v6 offset:2048
  v_mfma_f32_16x16x32_bf16 v[48:51], v[132:135], v[112:115], v[48:51]
  ds_read_b128 v[80:83], v6 offset:3072
  ds_read_b128 v[84:87], v6 offset:4096
  v_mfma_f32_16x16x32_bf16 v[32:35], v[140:143], v[136:139], v[32:35]
  ds_read_b128 v[88:91], v10 offset:1024
  v_mfma_f32_16x16x32_bf16 v[36:39], v[144:147], v[136:139], v[36:39]
  ds_read_b128 v[92:95], v6 offset:5120
  v_mfma_f32_16x16x32_bf16 v[40:43], v[148:151], v[136:139], v[40:43]
  ds_read_b128 v[96:99], v6 offset:6144
  v_mfma_f32_16x16x32_bf16 v[44:47], v[152:155], v[136:139], v[44:47]
  ds_read_b128 v[100:103], v6 offset:7168
  v_mfma_f32_16x16x32_bf16 v[48:51], v[156:159], v[136:139], v[48:51]
  ds_read_b128 v[104:107], v6 offset:8192
  ds_read_b128 v[108:111], v6 offset:9216
  ds_read_b64_tr_b16 v[180:181], v30 offset:0
  ds_read_b64_tr_b16 v[182:183], v30 offset:192
  ds_read_b64_tr_b16 v[200:201], v30 offset:8
  ds_read_b64_tr_b16 v[202:203], v30 offset:200
  ds_read_b64_tr_b16 v[184:185], v30 offset:384
  ds_read_b64_tr_b16 v[186:187], v30 offset:576
  ds_read_b64_tr_b16 v[204:205], v30 offset:392
  ds_read_b64_tr_b16 v[206:207], v30 offset:584
  ds_read_b64_tr_b16 v[188:189], v30 offset:768
  ds_read_b64_tr_b16 v[190:191], v30 offset:960
  ds_read_b64_tr_b16 v[208:209], v30 offset:776
  ds_read_b64_tr_b16 v[210:211], v30 offset:968
  ds_read_b64_tr_b16 v[192:193], v30 offset:1152
  ds_read_b64_tr_b16 v[194:195], v30 offset:1344
  ds_read_b64_tr_b16 v[212:213], v30 offset:1160
  ds_read_b64_tr_b16 v[214:215], v30 offset:1352
  ds_read_b64_tr_b16 v[196:197], v30 offset:1536
  ds_read_b64_tr_b16 v[198:199], v30 offset:1728
  ds_read_b64_tr_b16 v[216:217], v30 offset:1544
  ds_read_b64_tr_b16 v[218:219], v30 offset:1736
  s_waitcnt lgkmcnt(15)
  v_mfma_f32_16x16x32_bf16 v[220:223], v[180:183], v[160:163], 0
  v_mfma_f32_16x16x32_bf16 v[224:227], v[200:203], v[160:163], 0
  ds_read_b64_tr_b16 v[112:113], v30 offset:16
  ds_read_b64_tr_b16 v[114:115], v30 offset:208
  ds_read_b64_tr_b16 v[132:133], v30 offset:24
  ds_read_b64_tr_b16 v[134:135], v30 offset:216
  s_waitcnt lgkmcnt(15)
  v_mfma_f32_16x16x32_bf16 v[220:223], v[184:187], v[164:167], v[220:223]
  v_mfma_f32_16x16x32_bf16 v[224:227], v[204:207], v[164:167], v[224:227]
  ds_read_b64_tr_b16 v[116:117], v30 offset:400
  ds_read_b64_tr_b16 v[118:119], v30 offset:592
  ds_read_b64_tr_b16 v[136:137], v30 offset:408
  ds_read_b64_tr_b16 v[138:139], v30 offset:600
  s_waitcnt lgkmcnt(15)
  v_mfma_f32_16x16x32_bf16 v[220:223], v[188:191], v[168:171], v[220:223]
  v_mfma_f32_16x16x32_bf16 v[224:227], v[208:211], v[168:171], v[224:227]
  ds_read_b64_tr_b16 v[120:121], v30 offset:784
  ds_read_b64_tr_b16 v[122:123], v30 offset:976
  ds_read_b64_tr_b16 v[140:141], v30 offset:792
  ds_read_b64_tr_b16 v[142:143], v30 offset:984
  s_waitcnt lgkmcnt(15)
  v_mfma_f32_16x16x32_bf16 v[220:223], v[192:195], v[172:175], v[220:223]
  v_mfma_f32_16x16x32_bf16 v[224:227], v[212:215], v[172:175], v[224:227]
  ds_read_b64_tr_b16 v[124:125], v30 offset:1168
  ds_read_b64_tr_b16 v[126:127], v30 offset:1360
  ds_read_b64_tr_b16 v[144:145], v30 offset:1176
  ds_read_b64_tr_b16 v[146:147], v30 offset:1368
  s_waitcnt lgkmcnt(15)
  v_mfma_f32_16x16x32_bf16 v[220:223], v[196:199], v[176:179], v[220:223]
  v_mfma_f32_16x16x32_bf16 v[224:227], v[216:219], v[176:179], v[224:227]
  ds_read_b64_tr_b16 v[128:129], v30 offset:1552
  ds_read_b64_tr_b16 v[130:131], v30 offset:1744
  ds_read_b64_tr_b16 v[148:149], v30 offset:1560
  ds_read_b64_tr_b16 v[150:151], v30 offset:1752
  s_waitcnt lgkmcnt(15)
  v_mfma_f32_16x16x32_bf16 v[228:231], v[112:115], v[160:163], 0
  v_mfma_f32_16x16x32_bf16 v[232:235], v[132:135], v[160:163], 0
  ds_read_b64_tr_b16 v[180:181], v30 offset:32
  ds_read_b64_tr_b16 v[182:183], v30 offset:224
  ds_read_b64_tr_b16 v[200:201], v30 offset:40
  ds_read_b64_tr_b16 v[202:203], v30 offset:232
  s_waitcnt lgkmcnt(15)
  v_mfma_f32_16x16x32_bf16 v[228:231], v[116:119], v[164:167], v[228:231]
  v_mfma_f32_16x16x32_bf16 v[232:235], v[136:139], v[164:167], v[232:235]
  ds_read_b64_tr_b16 v[184:185], v30 offset:416
  ds_read_b64_tr_b16 v[186:187], v30 offset:608
  ds_read_b64_tr_b16 v[204:205], v30 offset:424
  ds_read_b64_tr_b16 v[206:207], v30 offset:616
  s_waitcnt lgkmcnt(15)
  v_mfma_f32_16x16x32_bf16 v[228:231], v[120:123], v[168:171], v[228:231]
  v_mfma_f32_16x16x32_bf16 v[232:235], v[140:143], v[168:171], v[232:235]
  ds_read_b64_tr_b16 v[188:189], v30 offset:800
  ds_read_b64_tr_b16 v[190:191], v30 offset:992
  ds_read_b64_tr_b16 v[208:209], v30 offset:808
  ds_read_b64_tr_b16 v[210:211], v30 offset:1000
  s_waitcnt lgkmcnt(15)
  v_mfma_f32_16x16x32_bf16 v[228:231], v[124:127], v[172:175], v[228:231]
  v_mfma_f32_16x16x32_bf16 v[232:235], v[144:147], v[172:175], v[232:235]
  ds_read_b64_tr_b16 v[192:193], v30 offset:1184
  ds_read_b64_tr_b16 v[194:195], v30 offset:1376
  ds_read_b64_tr_b16 v[212:213], v30 offset:1192
  ds_read_b64_tr_b16 v[214:215], v30 offset:1384
  s_waitcnt lgkmcnt(15)
  v_mfma_f32_16x16x32_bf16 v[228:231], v[128:131], v[176:179], v[228:231]
  v_mfma_f32_16x16x32_bf16 v[232:235], v[148:151], v[176:179], v[232:235]
  ds_read_b64_tr_b16 v[196:197], v30 offset:1568
  ds_read_b64_tr_b16 v[198:199], v30 offset:1760
  ds_read_b64_tr_b16 v[216:217], v30 offset:1576
  ds_read_b64_tr_b16 v[218:219], v30 offset:1768
  s_waitcnt lgkmcnt(15)
  v_mfma_f32_16x16x32_bf16 v[236:239], v[180:183], v[160:163], 0
  v_mfma_f32_16x16x32_bf16 v[240:243], v[200:203], v[160:163], 0
  s_waitcnt lgkmcnt(12)
  v_mfma_f32_16x16x32_bf16 v[236:239], v[184:187], v[164:167], v[236:239]
  v_mfma_f32_16x16x32_bf16 v[240:243], v[204:207], v[164:167], v[240:243]
  s_waitcnt lgkmcnt(8)
  v_mfma_f32_16x16x32_bf16 v[236:239], v[188:191], v[168:171], v[236:239]
  v_mfma_f32_16x16x32_bf16 v[240:243], v[208:211], v[168:171], v[240:243]
  s_waitcnt lgkmcnt(4)
  v_mfma_f32_16x16x32_bf16 v[236:239], v[192:195], v[172:175], v[236:239]
  v_mfma_f32_16x16x32_bf16 v[240:243], v[212:215], v[172:175], v[240:243]
  s_waitcnt lgkmcnt(0)
  v_mfma_f32_16x16x32_bf16 v[236:239], v[196:199], v[176:179], v[236:239]
  v_mfma_f32_16x16x32_bf16 v[240:243], v[216:219], v[176:179], v[240:243]
  s_nop 7
  v_add_f32 v52, 0x358637bd, v240
  v_rcp_f32 v52, v52
  s_nop 0
  v_mov_b32 v53, v52
  v_pk_mul_f32 v[220:221], v[220:221], v[52:53]
  v_pk_mul_f32 v[222:223], v[222:223], v[52:53]
  v_pk_mul_f32 v[224:225], v[224:225], v[52:53]
  v_pk_mul_f32 v[226:227], v[226:227], v[52:53]
  v_pk_mul_f32 v[228:229], v[228:229], v[52:53]
  v_pk_mul_f32 v[230:231], v[230:231], v[52:53]
  v_pk_mul_f32 v[232:233], v[232:233], v[52:53]
  v_pk_mul_f32 v[234:235], v[234:235], v[52:53]
  v_pk_mul_f32 v[236:237], v[236:237], v[52:53]
  v_pk_mul_f32 v[238:239], v[238:239], v[52:53]
  v_cvt_pk_bf16_f32 v244, v220, v221
  v_cvt_pk_bf16_f32 v245, v222, v223
  v_cvt_pk_bf16_f32 v246, v224, v225
  v_cvt_pk_bf16_f32 v247, v226, v227
  v_cvt_pk_bf16_f32 v248, v228, v229
  v_cvt_pk_bf16_f32 v249, v230, v231
  v_cvt_pk_bf16_f32 v250, v232, v233
  v_cvt_pk_bf16_f32 v251, v234, v235
  v_cvt_pk_bf16_f32 v252, v236, v237
  v_cvt_pk_bf16_f32 v253, v238, v239
  s_mul_i32 s58, s86, 74
  s_lshr_b32 s59, s69, 1
  s_mul_i32 s59, s59, 5
  s_add_u32 s58, s58, s59
  s_add_u32 s58, s58, 54
  s_lshl_b32 s58, s58, 10
  s_add_u32 s58, s58, 8388608
  s_bitcmp1_b32 s69, 0
  s_cbranch_scc1 L_parallel_sum__linear_kernel_hedgehog__mixer_channel_mlp__prompt_kernel_k_o_odd
  buffer_store_dwordx4 v[244:247], v22, s[24:27], s58 offen sc1
  buffer_store_dwordx4 v[248:251], v22, s[24:27], s58 offen offset:1024 sc1
  buffer_store_dwordx2 v[252:253], v22, s[24:27], s58 offen offset:2048 sc1
  s_branch L_parallel_sum__linear_kernel_hedgehog__mixer_channel_mlp__prompt_kernel_k_o_done
L_parallel_sum__linear_kernel_hedgehog__mixer_channel_mlp__prompt_kernel_k_o_odd:
  buffer_store_dwordx2 v[244:245], v22, s[24:27], s58 offen offset:2056 sc1
  buffer_store_dwordx4 v[246:249], v22, s[24:27], s58 offen offset:3072 sc1
  s_add_u32 s58, s58, 4096
  buffer_store_dwordx4 v[250:253], v22, s[24:27], s58 offen sc1
L_parallel_sum__linear_kernel_hedgehog__mixer_channel_mlp__prompt_kernel_k_o_done:
  v_mfma_f32_16x16x32_bf16 v[32:35], v[68:71], v[64:67], v[32:35]
  ds_read_b128 v[112:115], v10 offset:2048
  v_mfma_f32_16x16x32_bf16 v[36:39], v[72:75], v[64:67], v[36:39]
  ds_read_b128 v[116:119], v6 offset:10240
  v_mfma_f32_16x16x32_bf16 v[40:43], v[76:79], v[64:67], v[40:43]
  ds_read_b128 v[120:123], v6 offset:11264
  v_mfma_f32_16x16x32_bf16 v[44:47], v[80:83], v[64:67], v[44:47]
  ds_read_b128 v[124:127], v6 offset:12288
  v_mfma_f32_16x16x32_bf16 v[48:51], v[84:87], v[64:67], v[48:51]
  ds_read_b128 v[128:131], v6 offset:13312
  ds_read_b128 v[132:135], v6 offset:14336
  v_mfma_f32_16x16x32_bf16 v[32:35], v[92:95], v[88:91], v[32:35]
  ds_read_b128 v[136:139], v10 offset:3072
  v_mfma_f32_16x16x32_bf16 v[36:39], v[96:99], v[88:91], v[36:39]
  ds_read_b128 v[140:143], v6 offset:15360
  v_mfma_f32_16x16x32_bf16 v[40:43], v[100:103], v[88:91], v[40:43]
  ds_read_b128 v[144:147], v6 offset:16384
  v_mfma_f32_16x16x32_bf16 v[44:47], v[104:107], v[88:91], v[44:47]
  ds_read_b128 v[148:151], v6 offset:17408
  v_mfma_f32_16x16x32_bf16 v[48:51], v[108:111], v[88:91], v[48:51]
  ds_read_b128 v[152:155], v6 offset:18432
  ds_read_b128 v[156:159], v6 offset:19456
  s_waitcnt lgkmcnt(0)
  s_barrier
  v_mfma_f32_16x16x32_bf16 v[32:35], v[116:119], v[112:115], v[32:35]
  ds_read_b128 v[64:67], v11 offset:0
  v_mfma_f32_16x16x32_bf16 v[36:39], v[120:123], v[112:115], v[36:39]
  ds_read_b128 v[68:71], v7 offset:0
  v_mfma_f32_16x16x32_bf16 v[40:43], v[124:127], v[112:115], v[40:43]
  ds_read_b128 v[72:75], v7 offset:1024
  v_mfma_f32_16x16x32_bf16 v[44:47], v[128:131], v[112:115], v[44:47]
  ds_read_b128 v[76:79], v7 offset:2048
  v_mfma_f32_16x16x32_bf16 v[48:51], v[132:135], v[112:115], v[48:51]
  ds_read_b128 v[80:83], v7 offset:3072
  ds_read_b128 v[84:87], v7 offset:4096
  v_mfma_f32_16x16x32_bf16 v[32:35], v[140:143], v[136:139], v[32:35]
  ds_read_b128 v[88:91], v11 offset:1024
  v_mfma_f32_16x16x32_bf16 v[36:39], v[144:147], v[136:139], v[36:39]
  ds_read_b128 v[92:95], v7 offset:5120
  v_mfma_f32_16x16x32_bf16 v[40:43], v[148:151], v[136:139], v[40:43]
  ds_read_b128 v[96:99], v7 offset:6144
  v_mfma_f32_16x16x32_bf16 v[44:47], v[152:155], v[136:139], v[44:47]
  ds_read_b128 v[100:103], v7 offset:7168
  v_mfma_f32_16x16x32_bf16 v[48:51], v[156:159], v[136:139], v[48:51]
  ds_read_b128 v[104:107], v7 offset:8192
  ds_read_b128 v[108:111], v7 offset:9216
  s_waitcnt vmcnt(0)
  s_lshl_b32 s41, s86, 1
  s_lshr_b32 s42, s69, 2
  s_add_u32 s41, s41, s42
  s_lshl_b32 s41, s41, 7
  s_and_b32 s42, s69, 3
  s_add_u32 s41, s41, s42
  s_add_u32 s41, s41, 21018624
  v_mov_b32 v2, s41
  v_mov_b32 v0, 1
  s_mov_b64 exec, 1
  buffer_store_byte v0, v2, s[24:27], 0 offen sc1
  s_mov_b64 exec, -1
  s_waitcnt lgkmcnt(6)
  v_mfma_f32_16x16x32_bf16 v[32:35], v[68:71], v[64:67], v[32:35]
  ds_read_b128 v[112:115], v11 offset:2048
  v_mfma_f32_16x16x32_bf16 v[36:39], v[72:75], v[64:67], v[36:39]
  ds_read_b128 v[116:119], v7 offset:10240
  v_mfma_f32_16x16x32_bf16 v[40:43], v[76:79], v[64:67], v[40:43]
  ds_read_b128 v[120:123], v7 offset:11264
  v_mfma_f32_16x16x32_bf16 v[44:47], v[80:83], v[64:67], v[44:47]
  ds_read_b128 v[124:127], v7 offset:12288
  v_mfma_f32_16x16x32_bf16 v[48:51], v[84:87], v[64:67], v[48:51]
  ds_read_b128 v[128:131], v7 offset:13312
  ds_read_b128 v[132:135], v7 offset:14336
  s_waitcnt lgkmcnt(6)
  v_mfma_f32_16x16x32_bf16 v[32:35], v[92:95], v[88:91], v[32:35]
  ds_read_b128 v[136:139], v11 offset:3072
  v_mfma_f32_16x16x32_bf16 v[36:39], v[96:99], v[88:91], v[36:39]
  ds_read_b128 v[140:143], v7 offset:15360
  v_mfma_f32_16x16x32_bf16 v[40:43], v[100:103], v[88:91], v[40:43]
  ds_read_b128 v[144:147], v7 offset:16384
  v_mfma_f32_16x16x32_bf16 v[44:47], v[104:107], v[88:91], v[44:47]
  ds_read_b128 v[148:151], v7 offset:17408
  v_mfma_f32_16x16x32_bf16 v[48:51], v[108:111], v[88:91], v[48:51]
  ds_read_b128 v[152:155], v7 offset:18432
  ds_read_b128 v[156:159], v7 offset:19456
  s_waitcnt lgkmcnt(0)
  s_barrier
  v_mfma_f32_16x16x32_bf16 v[32:35], v[116:119], v[112:115], v[32:35]
  ds_read_b128 v[64:67], v8 offset:0
  v_mfma_f32_16x16x32_bf16 v[36:39], v[120:123], v[112:115], v[36:39]
  ds_read_b128 v[68:71], v4 offset:0
  v_mfma_f32_16x16x32_bf16 v[40:43], v[124:127], v[112:115], v[40:43]
  ds_read_b128 v[72:75], v4 offset:1024
  v_mfma_f32_16x16x32_bf16 v[44:47], v[128:131], v[112:115], v[44:47]
  ds_read_b128 v[76:79], v4 offset:2048
  v_mfma_f32_16x16x32_bf16 v[48:51], v[132:135], v[112:115], v[48:51]
  ds_read_b128 v[80:83], v4 offset:3072
  ds_read_b128 v[84:87], v4 offset:4096
  v_mfma_f32_16x16x32_bf16 v[32:35], v[140:143], v[136:139], v[32:35]
  ds_read_b128 v[88:91], v8 offset:1024
  v_mfma_f32_16x16x32_bf16 v[36:39], v[144:147], v[136:139], v[36:39]
  ds_read_b128 v[92:95], v4 offset:5120
  v_mfma_f32_16x16x32_bf16 v[40:43], v[148:151], v[136:139], v[40:43]
  ds_read_b128 v[96:99], v4 offset:6144
  v_mfma_f32_16x16x32_bf16 v[44:47], v[152:155], v[136:139], v[44:47]
  ds_read_b128 v[100:103], v4 offset:7168
  v_mfma_f32_16x16x32_bf16 v[48:51], v[156:159], v[136:139], v[48:51]
  ds_read_b128 v[104:107], v4 offset:8192
  ds_read_b128 v[108:111], v4 offset:9216
  s_waitcnt lgkmcnt(6)
  v_mfma_f32_16x16x32_bf16 v[32:35], v[68:71], v[64:67], v[32:35]
  ds_read_b128 v[112:115], v8 offset:2048
  v_mfma_f32_16x16x32_bf16 v[36:39], v[72:75], v[64:67], v[36:39]
  ds_read_b128 v[116:119], v4 offset:10240
  v_mfma_f32_16x16x32_bf16 v[40:43], v[76:79], v[64:67], v[40:43]
  ds_read_b128 v[120:123], v4 offset:11264
  v_mfma_f32_16x16x32_bf16 v[44:47], v[80:83], v[64:67], v[44:47]
  ds_read_b128 v[124:127], v4 offset:12288
  v_mfma_f32_16x16x32_bf16 v[48:51], v[84:87], v[64:67], v[48:51]
  ds_read_b128 v[128:131], v4 offset:13312
  ds_read_b128 v[132:135], v4 offset:14336
  s_waitcnt lgkmcnt(6)
  v_mfma_f32_16x16x32_bf16 v[32:35], v[92:95], v[88:91], v[32:35]
  ds_read_b128 v[136:139], v8 offset:3072
  v_mfma_f32_16x16x32_bf16 v[36:39], v[96:99], v[88:91], v[36:39]
  ds_read_b128 v[140:143], v4 offset:15360
  v_mfma_f32_16x16x32_bf16 v[40:43], v[100:103], v[88:91], v[40:43]
  ds_read_b128 v[144:147], v4 offset:16384
  v_mfma_f32_16x16x32_bf16 v[44:47], v[104:107], v[88:91], v[44:47]
  ds_read_b128 v[148:151], v4 offset:17408
  v_mfma_f32_16x16x32_bf16 v[48:51], v[108:111], v[88:91], v[48:51]
  ds_read_b128 v[152:155], v4 offset:18432
  ds_read_b128 v[156:159], v4 offset:19456
  s_waitcnt lgkmcnt(0)
  s_barrier
  v_mfma_f32_16x16x32_bf16 v[32:35], v[116:119], v[112:115], v[32:35]
  ds_read_b128 v[64:67], v9 offset:0
  v_mfma_f32_16x16x32_bf16 v[36:39], v[120:123], v[112:115], v[36:39]
  ds_read_b128 v[68:71], v5 offset:0
  v_mfma_f32_16x16x32_bf16 v[40:43], v[124:127], v[112:115], v[40:43]
  ds_read_b128 v[72:75], v5 offset:1024
  v_mfma_f32_16x16x32_bf16 v[44:47], v[128:131], v[112:115], v[44:47]
  ds_read_b128 v[76:79], v5 offset:2048
  v_mfma_f32_16x16x32_bf16 v[48:51], v[132:135], v[112:115], v[48:51]
  ds_read_b128 v[80:83], v5 offset:3072
  ds_read_b128 v[84:87], v5 offset:4096
  v_mfma_f32_16x16x32_bf16 v[32:35], v[140:143], v[136:139], v[32:35]
  ds_read_b128 v[88:91], v9 offset:1024
  v_mfma_f32_16x16x32_bf16 v[36:39], v[144:147], v[136:139], v[36:39]
  ds_read_b128 v[92:95], v5 offset:5120
  v_mfma_f32_16x16x32_bf16 v[40:43], v[148:151], v[136:139], v[40:43]
  ds_read_b128 v[96:99], v5 offset:6144
  v_mfma_f32_16x16x32_bf16 v[44:47], v[152:155], v[136:139], v[44:47]
  ds_read_b128 v[100:103], v5 offset:7168
  v_mfma_f32_16x16x32_bf16 v[48:51], v[156:159], v[136:139], v[48:51]
  ds_read_b128 v[104:107], v5 offset:8192
  ds_read_b128 v[108:111], v5 offset:9216
  s_waitcnt lgkmcnt(6)
  v_mfma_f32_16x16x32_bf16 v[32:35], v[68:71], v[64:67], v[32:35]
  ds_read_b128 v[112:115], v9 offset:2048
  v_mfma_f32_16x16x32_bf16 v[36:39], v[72:75], v[64:67], v[36:39]
  ds_read_b128 v[116:119], v5 offset:10240
  v_mfma_f32_16x16x32_bf16 v[40:43], v[76:79], v[64:67], v[40:43]
  ds_read_b128 v[120:123], v5 offset:11264
  v_mfma_f32_16x16x32_bf16 v[44:47], v[80:83], v[64:67], v[44:47]
  ds_read_b128 v[124:127], v5 offset:12288
  v_mfma_f32_16x16x32_bf16 v[48:51], v[84:87], v[64:67], v[48:51]
  ds_read_b128 v[128:131], v5 offset:13312
  ds_read_b128 v[132:135], v5 offset:14336
  s_waitcnt lgkmcnt(6)
  v_mfma_f32_16x16x32_bf16 v[32:35], v[92:95], v[88:91], v[32:35]
  ds_read_b128 v[136:139], v9 offset:3072
  v_mfma_f32_16x16x32_bf16 v[36:39], v[96:99], v[88:91], v[36:39]
  ds_read_b128 v[140:143], v5 offset:15360
  v_mfma_f32_16x16x32_bf16 v[40:43], v[100:103], v[88:91], v[40:43]
  ds_read_b128 v[144:147], v5 offset:16384
  v_mfma_f32_16x16x32_bf16 v[44:47], v[104:107], v[88:91], v[44:47]
  ds_read_b128 v[148:151], v5 offset:17408
  v_mfma_f32_16x16x32_bf16 v[48:51], v[108:111], v[88:91], v[48:51]
  ds_read_b128 v[152:155], v5 offset:18432
  ds_read_b128 v[156:159], v5 offset:19456
  s_waitcnt lgkmcnt(0)
  s_barrier
  v_mfma_f32_16x16x32_bf16 v[32:35], v[116:119], v[112:115], v[32:35]
  ds_read_b128 v[64:67], v10 offset:0
  v_mfma_f32_16x16x32_bf16 v[36:39], v[120:123], v[112:115], v[36:39]
  ds_read_b128 v[68:71], v6 offset:0
  v_mfma_f32_16x16x32_bf16 v[40:43], v[124:127], v[112:115], v[40:43]
  ds_read_b128 v[72:75], v6 offset:1024
  v_mfma_f32_16x16x32_bf16 v[44:47], v[128:131], v[112:115], v[44:47]
  ds_read_b128 v[76:79], v6 offset:2048
  v_mfma_f32_16x16x32_bf16 v[48:51], v[132:135], v[112:115], v[48:51]
  ds_read_b128 v[80:83], v6 offset:3072
  ds_read_b128 v[84:87], v6 offset:4096
  v_mfma_f32_16x16x32_bf16 v[32:35], v[140:143], v[136:139], v[32:35]
  ds_read_b128 v[88:91], v10 offset:1024
  v_mfma_f32_16x16x32_bf16 v[36:39], v[144:147], v[136:139], v[36:39]
  ds_read_b128 v[92:95], v6 offset:5120
  v_mfma_f32_16x16x32_bf16 v[40:43], v[148:151], v[136:139], v[40:43]
  ds_read_b128 v[96:99], v6 offset:6144
  v_mfma_f32_16x16x32_bf16 v[44:47], v[152:155], v[136:139], v[44:47]
  ds_read_b128 v[100:103], v6 offset:7168
  v_mfma_f32_16x16x32_bf16 v[48:51], v[156:159], v[136:139], v[48:51]
  ds_read_b128 v[104:107], v6 offset:8192
  ds_read_b128 v[108:111], v6 offset:9216
  s_waitcnt lgkmcnt(6)
  v_mfma_f32_16x16x32_bf16 v[32:35], v[68:71], v[64:67], v[32:35]
  ds_read_b128 v[112:115], v10 offset:2048
  v_mfma_f32_16x16x32_bf16 v[36:39], v[72:75], v[64:67], v[36:39]
  ds_read_b128 v[116:119], v6 offset:10240
  v_mfma_f32_16x16x32_bf16 v[40:43], v[76:79], v[64:67], v[40:43]
  ds_read_b128 v[120:123], v6 offset:11264
  v_mfma_f32_16x16x32_bf16 v[44:47], v[80:83], v[64:67], v[44:47]
  ds_read_b128 v[124:127], v6 offset:12288
  v_mfma_f32_16x16x32_bf16 v[48:51], v[84:87], v[64:67], v[48:51]
  ds_read_b128 v[128:131], v6 offset:13312
  ds_read_b128 v[132:135], v6 offset:14336
  s_waitcnt lgkmcnt(6)
  v_mfma_f32_16x16x32_bf16 v[32:35], v[92:95], v[88:91], v[32:35]
  ds_read_b128 v[136:139], v10 offset:3072
  v_mfma_f32_16x16x32_bf16 v[36:39], v[96:99], v[88:91], v[36:39]
  ds_read_b128 v[140:143], v6 offset:15360
  v_mfma_f32_16x16x32_bf16 v[40:43], v[100:103], v[88:91], v[40:43]
  ds_read_b128 v[144:147], v6 offset:16384
  v_mfma_f32_16x16x32_bf16 v[44:47], v[104:107], v[88:91], v[44:47]
  ds_read_b128 v[148:151], v6 offset:17408
  v_mfma_f32_16x16x32_bf16 v[48:51], v[108:111], v[88:91], v[48:51]
  ds_read_b128 v[152:155], v6 offset:18432
  ds_read_b128 v[156:159], v6 offset:19456
  s_waitcnt lgkmcnt(0)
  s_barrier
  v_mfma_f32_16x16x32_bf16 v[32:35], v[116:119], v[112:115], v[32:35]
  ds_read_b128 v[64:67], v11 offset:0
  v_mfma_f32_16x16x32_bf16 v[36:39], v[120:123], v[112:115], v[36:39]
  ds_read_b128 v[68:71], v7 offset:0
  v_mfma_f32_16x16x32_bf16 v[40:43], v[124:127], v[112:115], v[40:43]
  ds_read_b128 v[72:75], v7 offset:1024
  v_mfma_f32_16x16x32_bf16 v[44:47], v[128:131], v[112:115], v[44:47]
  ds_read_b128 v[76:79], v7 offset:2048
  v_mfma_f32_16x16x32_bf16 v[48:51], v[132:135], v[112:115], v[48:51]
  ds_read_b128 v[80:83], v7 offset:3072
  ds_read_b128 v[84:87], v7 offset:4096
  v_mfma_f32_16x16x32_bf16 v[32:35], v[140:143], v[136:139], v[32:35]
  ds_read_b128 v[88:91], v11 offset:1024
  v_mfma_f32_16x16x32_bf16 v[36:39], v[144:147], v[136:139], v[36:39]
  ds_read_b128 v[92:95], v7 offset:5120
  v_mfma_f32_16x16x32_bf16 v[40:43], v[148:151], v[136:139], v[40:43]
  ds_read_b128 v[96:99], v7 offset:6144
  v_mfma_f32_16x16x32_bf16 v[44:47], v[152:155], v[136:139], v[44:47]
  ds_read_b128 v[100:103], v7 offset:7168
  v_mfma_f32_16x16x32_bf16 v[48:51], v[156:159], v[136:139], v[48:51]
  ds_read_b128 v[104:107], v7 offset:8192
  ds_read_b128 v[108:111], v7 offset:9216
  s_waitcnt lgkmcnt(6)
  v_mfma_f32_16x16x32_bf16 v[32:35], v[68:71], v[64:67], v[32:35]
  ds_read_b128 v[112:115], v11 offset:2048
  v_mfma_f32_16x16x32_bf16 v[36:39], v[72:75], v[64:67], v[36:39]
  ds_read_b128 v[116:119], v7 offset:10240
  v_mfma_f32_16x16x32_bf16 v[40:43], v[76:79], v[64:67], v[40:43]
  ds_read_b128 v[120:123], v7 offset:11264
  v_mfma_f32_16x16x32_bf16 v[44:47], v[80:83], v[64:67], v[44:47]
  ds_read_b128 v[124:127], v7 offset:12288
  v_mfma_f32_16x16x32_bf16 v[48:51], v[84:87], v[64:67], v[48:51]
  ds_read_b128 v[128:131], v7 offset:13312
  ds_read_b128 v[132:135], v7 offset:14336
  s_waitcnt lgkmcnt(6)
  v_mfma_f32_16x16x32_bf16 v[32:35], v[92:95], v[88:91], v[32:35]
  ds_read_b128 v[136:139], v11 offset:3072
  v_mfma_f32_16x16x32_bf16 v[36:39], v[96:99], v[88:91], v[36:39]
  ds_read_b128 v[140:143], v7 offset:15360
  v_mfma_f32_16x16x32_bf16 v[40:43], v[100:103], v[88:91], v[40:43]
  ds_read_b128 v[144:147], v7 offset:16384
  v_mfma_f32_16x16x32_bf16 v[44:47], v[104:107], v[88:91], v[44:47]
  ds_read_b128 v[148:151], v7 offset:17408
  v_mfma_f32_16x16x32_bf16 v[48:51], v[108:111], v[88:91], v[48:51]
  ds_read_b128 v[152:155], v7 offset:18432
  ds_read_b128 v[156:159], v7 offset:19456
  s_waitcnt lgkmcnt(0)
  s_barrier
  v_mfma_f32_16x16x32_bf16 v[32:35], v[116:119], v[112:115], v[32:35]
  ds_read_b128 v[64:67], v8 offset:0
  v_mfma_f32_16x16x32_bf16 v[36:39], v[120:123], v[112:115], v[36:39]
  ds_read_b128 v[68:71], v4 offset:0
  v_mfma_f32_16x16x32_bf16 v[40:43], v[124:127], v[112:115], v[40:43]
  ds_read_b128 v[72:75], v4 offset:1024
  v_mfma_f32_16x16x32_bf16 v[44:47], v[128:131], v[112:115], v[44:47]
  ds_read_b128 v[76:79], v4 offset:2048
  v_mfma_f32_16x16x32_bf16 v[48:51], v[132:135], v[112:115], v[48:51]
  ds_read_b128 v[80:83], v4 offset:3072
  ds_read_b128 v[84:87], v4 offset:4096
  v_mfma_f32_16x16x32_bf16 v[32:35], v[140:143], v[136:139], v[32:35]
  ds_read_b128 v[88:91], v8 offset:1024
  v_mfma_f32_16x16x32_bf16 v[36:39], v[144:147], v[136:139], v[36:39]
  ds_read_b128 v[92:95], v4 offset:5120
  v_mfma_f32_16x16x32_bf16 v[40:43], v[148:151], v[136:139], v[40:43]
  ds_read_b128 v[96:99], v4 offset:6144
  v_mfma_f32_16x16x32_bf16 v[44:47], v[152:155], v[136:139], v[44:47]
  ds_read_b128 v[100:103], v4 offset:7168
  v_mfma_f32_16x16x32_bf16 v[48:51], v[156:159], v[136:139], v[48:51]
  ds_read_b128 v[104:107], v4 offset:8192
  ds_read_b128 v[108:111], v4 offset:9216
  s_waitcnt lgkmcnt(6)
  v_mfma_f32_16x16x32_bf16 v[32:35], v[68:71], v[64:67], v[32:35]
  ds_read_b128 v[112:115], v8 offset:2048
  v_mfma_f32_16x16x32_bf16 v[36:39], v[72:75], v[64:67], v[36:39]
  ds_read_b128 v[116:119], v4 offset:10240
  v_mfma_f32_16x16x32_bf16 v[40:43], v[76:79], v[64:67], v[40:43]
  ds_read_b128 v[120:123], v4 offset:11264
  v_mfma_f32_16x16x32_bf16 v[44:47], v[80:83], v[64:67], v[44:47]
  ds_read_b128 v[124:127], v4 offset:12288
  v_mfma_f32_16x16x32_bf16 v[48:51], v[84:87], v[64:67], v[48:51]
  ds_read_b128 v[128:131], v4 offset:13312
  ds_read_b128 v[132:135], v4 offset:14336
  s_waitcnt lgkmcnt(6)
  v_mfma_f32_16x16x32_bf16 v[32:35], v[92:95], v[88:91], v[32:35]
  ds_read_b128 v[136:139], v8 offset:3072
  v_mfma_f32_16x16x32_bf16 v[36:39], v[96:99], v[88:91], v[36:39]
  ds_read_b128 v[140:143], v4 offset:15360
  v_mfma_f32_16x16x32_bf16 v[40:43], v[100:103], v[88:91], v[40:43]
  ds_read_b128 v[144:147], v4 offset:16384
  v_mfma_f32_16x16x32_bf16 v[44:47], v[104:107], v[88:91], v[44:47]
  ds_read_b128 v[148:151], v4 offset:17408
  v_mfma_f32_16x16x32_bf16 v[48:51], v[108:111], v[88:91], v[48:51]
  ds_read_b128 v[152:155], v4 offset:18432
  ds_read_b128 v[156:159], v4 offset:19456
  s_waitcnt lgkmcnt(0)
  s_barrier
  v_mfma_f32_16x16x32_bf16 v[32:35], v[116:119], v[112:115], v[32:35]
  ds_read_b128 v[64:67], v9 offset:0
  v_mfma_f32_16x16x32_bf16 v[36:39], v[120:123], v[112:115], v[36:39]
  ds_read_b128 v[68:71], v5 offset:0
  v_mfma_f32_16x16x32_bf16 v[40:43], v[124:127], v[112:115], v[40:43]
  ds_read_b128 v[72:75], v5 offset:1024
  v_mfma_f32_16x16x32_bf16 v[44:47], v[128:131], v[112:115], v[44:47]
  ds_read_b128 v[76:79], v5 offset:2048
  v_mfma_f32_16x16x32_bf16 v[48:51], v[132:135], v[112:115], v[48:51]
  ds_read_b128 v[80:83], v5 offset:3072
  ds_read_b128 v[84:87], v5 offset:4096
  v_mfma_f32_16x16x32_bf16 v[32:35], v[140:143], v[136:139], v[32:35]
  ds_read_b128 v[88:91], v9 offset:1024
  v_mfma_f32_16x16x32_bf16 v[36:39], v[144:147], v[136:139], v[36:39]
  ds_read_b128 v[92:95], v5 offset:5120
  v_mfma_f32_16x16x32_bf16 v[40:43], v[148:151], v[136:139], v[40:43]
  ds_read_b128 v[96:99], v5 offset:6144
  v_mfma_f32_16x16x32_bf16 v[44:47], v[152:155], v[136:139], v[44:47]
  ds_read_b128 v[100:103], v5 offset:7168
  v_mfma_f32_16x16x32_bf16 v[48:51], v[156:159], v[136:139], v[48:51]
  ds_read_b128 v[104:107], v5 offset:8192
  ds_read_b128 v[108:111], v5 offset:9216
  s_waitcnt lgkmcnt(6)
  v_mfma_f32_16x16x32_bf16 v[32:35], v[68:71], v[64:67], v[32:35]
  ds_read_b128 v[112:115], v9 offset:2048
  v_mfma_f32_16x16x32_bf16 v[36:39], v[72:75], v[64:67], v[36:39]
  ds_read_b128 v[116:119], v5 offset:10240
  v_mfma_f32_16x16x32_bf16 v[40:43], v[76:79], v[64:67], v[40:43]
  ds_read_b128 v[120:123], v5 offset:11264
  v_mfma_f32_16x16x32_bf16 v[44:47], v[80:83], v[64:67], v[44:47]
  ds_read_b128 v[124:127], v5 offset:12288
  v_mfma_f32_16x16x32_bf16 v[48:51], v[84:87], v[64:67], v[48:51]
  ds_read_b128 v[128:131], v5 offset:13312
  ds_read_b128 v[132:135], v5 offset:14336
  s_waitcnt lgkmcnt(6)
  v_mfma_f32_16x16x32_bf16 v[32:35], v[92:95], v[88:91], v[32:35]
  ds_read_b128 v[136:139], v9 offset:3072
  v_mfma_f32_16x16x32_bf16 v[36:39], v[96:99], v[88:91], v[36:39]
  ds_read_b128 v[140:143], v5 offset:15360
  v_mfma_f32_16x16x32_bf16 v[40:43], v[100:103], v[88:91], v[40:43]
  ds_read_b128 v[144:147], v5 offset:16384
  v_mfma_f32_16x16x32_bf16 v[44:47], v[104:107], v[88:91], v[44:47]
  ds_read_b128 v[148:151], v5 offset:17408
  v_mfma_f32_16x16x32_bf16 v[48:51], v[108:111], v[88:91], v[48:51]
  ds_read_b128 v[152:155], v5 offset:18432
  ds_read_b128 v[156:159], v5 offset:19456
  s_waitcnt lgkmcnt(0)
  s_barrier
  v_mfma_f32_16x16x32_bf16 v[32:35], v[116:119], v[112:115], v[32:35]
  ds_read_b128 v[64:67], v10 offset:0
  v_mfma_f32_16x16x32_bf16 v[36:39], v[120:123], v[112:115], v[36:39]
  ds_read_b128 v[68:71], v6 offset:0
  v_mfma_f32_16x16x32_bf16 v[40:43], v[124:127], v[112:115], v[40:43]
  ds_read_b128 v[72:75], v6 offset:1024
  v_mfma_f32_16x16x32_bf16 v[44:47], v[128:131], v[112:115], v[44:47]
  ds_read_b128 v[76:79], v6 offset:2048
  v_mfma_f32_16x16x32_bf16 v[48:51], v[132:135], v[112:115], v[48:51]
  ds_read_b128 v[80:83], v6 offset:3072
  ds_read_b128 v[84:87], v6 offset:4096
  v_mfma_f32_16x16x32_bf16 v[32:35], v[140:143], v[136:139], v[32:35]
  ds_read_b128 v[88:91], v10 offset:1024
  v_mfma_f32_16x16x32_bf16 v[36:39], v[144:147], v[136:139], v[36:39]
  ds_read_b128 v[92:95], v6 offset:5120
  v_mfma_f32_16x16x32_bf16 v[40:43], v[148:151], v[136:139], v[40:43]
  ds_read_b128 v[96:99], v6 offset:6144
  v_mfma_f32_16x16x32_bf16 v[44:47], v[152:155], v[136:139], v[44:47]
  ds_read_b128 v[100:103], v6 offset:7168
  v_mfma_f32_16x16x32_bf16 v[48:51], v[156:159], v[136:139], v[48:51]
  ds_read_b128 v[104:107], v6 offset:8192
  ds_read_b128 v[108:111], v6 offset:9216
  s_waitcnt lgkmcnt(6)
  v_mfma_f32_16x16x32_bf16 v[32:35], v[68:71], v[64:67], v[32:35]
  ds_read_b128 v[112:115], v10 offset:2048
  v_mfma_f32_16x16x32_bf16 v[36:39], v[72:75], v[64:67], v[36:39]
  ds_read_b128 v[116:119], v6 offset:10240
  v_mfma_f32_16x16x32_bf16 v[40:43], v[76:79], v[64:67], v[40:43]
  ds_read_b128 v[120:123], v6 offset:11264
  v_mfma_f32_16x16x32_bf16 v[44:47], v[80:83], v[64:67], v[44:47]
  ds_read_b128 v[124:127], v6 offset:12288
  v_mfma_f32_16x16x32_bf16 v[48:51], v[84:87], v[64:67], v[48:51]
  ds_read_b128 v[128:131], v6 offset:13312
  ds_read_b128 v[132:135], v6 offset:14336
  s_waitcnt lgkmcnt(6)
  v_mfma_f32_16x16x32_bf16 v[32:35], v[92:95], v[88:91], v[32:35]
  ds_read_b128 v[136:139], v10 offset:3072
  v_mfma_f32_16x16x32_bf16 v[36:39], v[96:99], v[88:91], v[36:39]
  ds_read_b128 v[140:143], v6 offset:15360
  v_mfma_f32_16x16x32_bf16 v[40:43], v[100:103], v[88:91], v[40:43]
  ds_read_b128 v[144:147], v6 offset:16384
  v_mfma_f32_16x16x32_bf16 v[44:47], v[104:107], v[88:91], v[44:47]
  ds_read_b128 v[148:151], v6 offset:17408
  v_mfma_f32_16x16x32_bf16 v[48:51], v[108:111], v[88:91], v[48:51]
  ds_read_b128 v[152:155], v6 offset:18432
  ds_read_b128 v[156:159], v6 offset:19456
  s_waitcnt lgkmcnt(0)
  s_barrier
  v_mfma_f32_16x16x32_bf16 v[32:35], v[116:119], v[112:115], v[32:35]
  ds_read_b128 v[64:67], v11 offset:0
  v_mfma_f32_16x16x32_bf16 v[36:39], v[120:123], v[112:115], v[36:39]
  ds_read_b128 v[68:71], v7 offset:0
  v_mfma_f32_16x16x32_bf16 v[40:43], v[124:127], v[112:115], v[40:43]
  ds_read_b128 v[72:75], v7 offset:1024
  v_mfma_f32_16x16x32_bf16 v[44:47], v[128:131], v[112:115], v[44:47]
  ds_read_b128 v[76:79], v7 offset:2048
  v_mfma_f32_16x16x32_bf16 v[48:51], v[132:135], v[112:115], v[48:51]
  ds_read_b128 v[80:83], v7 offset:3072
  ds_read_b128 v[84:87], v7 offset:4096
  v_mfma_f32_16x16x32_bf16 v[32:35], v[140:143], v[136:139], v[32:35]
  ds_read_b128 v[88:91], v11 offset:1024
  v_mfma_f32_16x16x32_bf16 v[36:39], v[144:147], v[136:139], v[36:39]
  ds_read_b128 v[92:95], v7 offset:5120
  v_mfma_f32_16x16x32_bf16 v[40:43], v[148:151], v[136:139], v[40:43]
  ds_read_b128 v[96:99], v7 offset:6144
  v_mfma_f32_16x16x32_bf16 v[44:47], v[152:155], v[136:139], v[44:47]
  ds_read_b128 v[100:103], v7 offset:7168
  v_mfma_f32_16x16x32_bf16 v[48:51], v[156:159], v[136:139], v[48:51]
  ds_read_b128 v[104:107], v7 offset:8192
  ds_read_b128 v[108:111], v7 offset:9216
  s_waitcnt lgkmcnt(6)
  v_mfma_f32_16x16x32_bf16 v[32:35], v[68:71], v[64:67], v[32:35]
  ds_read_b128 v[112:115], v11 offset:2048
  v_mfma_f32_16x16x32_bf16 v[36:39], v[72:75], v[64:67], v[36:39]
  ds_read_b128 v[116:119], v7 offset:10240
  v_mfma_f32_16x16x32_bf16 v[40:43], v[76:79], v[64:67], v[40:43]
  ds_read_b128 v[120:123], v7 offset:11264
  v_mfma_f32_16x16x32_bf16 v[44:47], v[80:83], v[64:67], v[44:47]
  ds_read_b128 v[124:127], v7 offset:12288
  v_mfma_f32_16x16x32_bf16 v[48:51], v[84:87], v[64:67], v[48:51]
  ds_read_b128 v[128:131], v7 offset:13312
  ds_read_b128 v[132:135], v7 offset:14336
  s_waitcnt lgkmcnt(6)
  v_mfma_f32_16x16x32_bf16 v[32:35], v[92:95], v[88:91], v[32:35]
  ds_read_b128 v[136:139], v11 offset:3072
  v_mfma_f32_16x16x32_bf16 v[36:39], v[96:99], v[88:91], v[36:39]
  ds_read_b128 v[140:143], v7 offset:15360
  v_mfma_f32_16x16x32_bf16 v[40:43], v[100:103], v[88:91], v[40:43]
  ds_read_b128 v[144:147], v7 offset:16384
  v_mfma_f32_16x16x32_bf16 v[44:47], v[104:107], v[88:91], v[44:47]
  ds_read_b128 v[148:151], v7 offset:17408
  v_mfma_f32_16x16x32_bf16 v[48:51], v[108:111], v[88:91], v[48:51]
  ds_read_b128 v[152:155], v7 offset:18432
  ds_read_b128 v[156:159], v7 offset:19456
  s_waitcnt lgkmcnt(0)
  s_barrier
  v_mfma_f32_16x16x32_bf16 v[32:35], v[116:119], v[112:115], v[32:35]
  ds_read_b128 v[64:67], v8 offset:0
  v_mfma_f32_16x16x32_bf16 v[36:39], v[120:123], v[112:115], v[36:39]
  ds_read_b128 v[68:71], v4 offset:0
  v_mfma_f32_16x16x32_bf16 v[40:43], v[124:127], v[112:115], v[40:43]
  ds_read_b128 v[72:75], v4 offset:1024
  v_mfma_f32_16x16x32_bf16 v[44:47], v[128:131], v[112:115], v[44:47]
  ds_read_b128 v[76:79], v4 offset:2048
  v_mfma_f32_16x16x32_bf16 v[48:51], v[132:135], v[112:115], v[48:51]
  ds_read_b128 v[80:83], v4 offset:3072
  ds_read_b128 v[84:87], v4 offset:4096
  v_mfma_f32_16x16x32_bf16 v[32:35], v[140:143], v[136:139], v[32:35]
  ds_read_b128 v[88:91], v8 offset:1024
  v_mfma_f32_16x16x32_bf16 v[36:39], v[144:147], v[136:139], v[36:39]
  ds_read_b128 v[92:95], v4 offset:5120
  v_mfma_f32_16x16x32_bf16 v[40:43], v[148:151], v[136:139], v[40:43]
  ds_read_b128 v[96:99], v4 offset:6144
  v_mfma_f32_16x16x32_bf16 v[44:47], v[152:155], v[136:139], v[44:47]
  ds_read_b128 v[100:103], v4 offset:7168
  v_mfma_f32_16x16x32_bf16 v[48:51], v[156:159], v[136:139], v[48:51]
  ds_read_b128 v[104:107], v4 offset:8192
  ds_read_b128 v[108:111], v4 offset:9216
  s_waitcnt lgkmcnt(6)
  v_mfma_f32_16x16x32_bf16 v[32:35], v[68:71], v[64:67], v[32:35]
  ds_read_b128 v[112:115], v8 offset:2048
  v_mfma_f32_16x16x32_bf16 v[36:39], v[72:75], v[64:67], v[36:39]
  ds_read_b128 v[116:119], v4 offset:10240
  v_mfma_f32_16x16x32_bf16 v[40:43], v[76:79], v[64:67], v[40:43]
  ds_read_b128 v[120:123], v4 offset:11264
  v_mfma_f32_16x16x32_bf16 v[44:47], v[80:83], v[64:67], v[44:47]
  ds_read_b128 v[124:127], v4 offset:12288
  v_mfma_f32_16x16x32_bf16 v[48:51], v[84:87], v[64:67], v[48:51]
  ds_read_b128 v[128:131], v4 offset:13312
  ds_read_b128 v[132:135], v4 offset:14336
  s_waitcnt lgkmcnt(6)
  v_mfma_f32_16x16x32_bf16 v[32:35], v[92:95], v[88:91], v[32:35]
  ds_read_b128 v[136:139], v8 offset:3072
  v_mfma_f32_16x16x32_bf16 v[36:39], v[96:99], v[88:91], v[36:39]
  ds_read_b128 v[140:143], v4 offset:15360
  v_mfma_f32_16x16x32_bf16 v[40:43], v[100:103], v[88:91], v[40:43]
  ds_read_b128 v[144:147], v4 offset:16384
  v_mfma_f32_16x16x32_bf16 v[44:47], v[104:107], v[88:91], v[44:47]
  ds_read_b128 v[148:151], v4 offset:17408
  v_mfma_f32_16x16x32_bf16 v[48:51], v[108:111], v[88:91], v[48:51]
  ds_read_b128 v[152:155], v4 offset:18432
  ds_read_b128 v[156:159], v4 offset:19456
  s_waitcnt lgkmcnt(0)
  s_barrier
  v_mfma_f32_16x16x32_bf16 v[32:35], v[116:119], v[112:115], v[32:35]
  ds_read_b128 v[64:67], v9 offset:0
  v_mfma_f32_16x16x32_bf16 v[36:39], v[120:123], v[112:115], v[36:39]
  ds_read_b128 v[68:71], v5 offset:0
  v_mfma_f32_16x16x32_bf16 v[40:43], v[124:127], v[112:115], v[40:43]
  ds_read_b128 v[72:75], v5 offset:1024
  v_mfma_f32_16x16x32_bf16 v[44:47], v[128:131], v[112:115], v[44:47]
  ds_read_b128 v[76:79], v5 offset:2048
  v_mfma_f32_16x16x32_bf16 v[48:51], v[132:135], v[112:115], v[48:51]
  ds_read_b128 v[80:83], v5 offset:3072
  ds_read_b128 v[84:87], v5 offset:4096
  v_mfma_f32_16x16x32_bf16 v[32:35], v[140:143], v[136:139], v[32:35]
  ds_read_b128 v[88:91], v9 offset:1024
  v_mfma_f32_16x16x32_bf16 v[36:39], v[144:147], v[136:139], v[36:39]
  ds_read_b128 v[92:95], v5 offset:5120
  v_mfma_f32_16x16x32_bf16 v[40:43], v[148:151], v[136:139], v[40:43]
  ds_read_b128 v[96:99], v5 offset:6144
  v_mfma_f32_16x16x32_bf16 v[44:47], v[152:155], v[136:139], v[44:47]
  ds_read_b128 v[100:103], v5 offset:7168
  v_mfma_f32_16x16x32_bf16 v[48:51], v[156:159], v[136:139], v[48:51]
  ds_read_b128 v[104:107], v5 offset:8192
  ds_read_b128 v[108:111], v5 offset:9216
  s_waitcnt lgkmcnt(6)
  v_mfma_f32_16x16x32_bf16 v[32:35], v[68:71], v[64:67], v[32:35]
  ds_read_b128 v[112:115], v9 offset:2048
  v_mfma_f32_16x16x32_bf16 v[36:39], v[72:75], v[64:67], v[36:39]
  ds_read_b128 v[116:119], v5 offset:10240
  v_mfma_f32_16x16x32_bf16 v[40:43], v[76:79], v[64:67], v[40:43]
  ds_read_b128 v[120:123], v5 offset:11264
  v_mfma_f32_16x16x32_bf16 v[44:47], v[80:83], v[64:67], v[44:47]
  ds_read_b128 v[124:127], v5 offset:12288
  v_mfma_f32_16x16x32_bf16 v[48:51], v[84:87], v[64:67], v[48:51]
  ds_read_b128 v[128:131], v5 offset:13312
  ds_read_b128 v[132:135], v5 offset:14336
  s_waitcnt lgkmcnt(6)
  v_mfma_f32_16x16x32_bf16 v[32:35], v[92:95], v[88:91], v[32:35]
  ds_read_b128 v[136:139], v9 offset:3072
  v_mfma_f32_16x16x32_bf16 v[36:39], v[96:99], v[88:91], v[36:39]
  ds_read_b128 v[140:143], v5 offset:15360
  v_mfma_f32_16x16x32_bf16 v[40:43], v[100:103], v[88:91], v[40:43]
  ds_read_b128 v[144:147], v5 offset:16384
  v_mfma_f32_16x16x32_bf16 v[44:47], v[104:107], v[88:91], v[44:47]
  ds_read_b128 v[148:151], v5 offset:17408
  v_mfma_f32_16x16x32_bf16 v[48:51], v[108:111], v[88:91], v[48:51]
  ds_read_b128 v[152:155], v5 offset:18432
  ds_read_b128 v[156:159], v5 offset:19456
  s_waitcnt lgkmcnt(0)
  s_barrier
  v_mfma_f32_16x16x32_bf16 v[32:35], v[116:119], v[112:115], v[32:35]
  ds_read_b128 v[64:67], v10 offset:0
  v_mfma_f32_16x16x32_bf16 v[36:39], v[120:123], v[112:115], v[36:39]
  ds_read_b128 v[68:71], v6 offset:0
  v_mfma_f32_16x16x32_bf16 v[40:43], v[124:127], v[112:115], v[40:43]
  ds_read_b128 v[72:75], v6 offset:1024
  v_mfma_f32_16x16x32_bf16 v[44:47], v[128:131], v[112:115], v[44:47]
  ds_read_b128 v[76:79], v6 offset:2048
  v_mfma_f32_16x16x32_bf16 v[48:51], v[132:135], v[112:115], v[48:51]
  ds_read_b128 v[80:83], v6 offset:3072
  ds_read_b128 v[84:87], v6 offset:4096
  v_mfma_f32_16x16x32_bf16 v[32:35], v[140:143], v[136:139], v[32:35]
  ds_read_b128 v[88:91], v10 offset:1024
  v_mfma_f32_16x16x32_bf16 v[36:39], v[144:147], v[136:139], v[36:39]
  ds_read_b128 v[92:95], v6 offset:5120
  v_mfma_f32_16x16x32_bf16 v[40:43], v[148:151], v[136:139], v[40:43]
  ds_read_b128 v[96:99], v6 offset:6144
  v_mfma_f32_16x16x32_bf16 v[44:47], v[152:155], v[136:139], v[44:47]
  ds_read_b128 v[100:103], v6 offset:7168
  v_mfma_f32_16x16x32_bf16 v[48:51], v[156:159], v[136:139], v[48:51]
  ds_read_b128 v[104:107], v6 offset:8192
  ds_read_b128 v[108:111], v6 offset:9216
  s_waitcnt lgkmcnt(0)
  v_mfma_f32_16x16x32_bf16 v[32:35], v[68:71], v[64:67], v[32:35]
  v_mfma_f32_16x16x32_bf16 v[36:39], v[72:75], v[64:67], v[36:39]
  v_mfma_f32_16x16x32_bf16 v[40:43], v[76:79], v[64:67], v[40:43]
  v_mfma_f32_16x16x32_bf16 v[44:47], v[80:83], v[64:67], v[44:47]
  v_mfma_f32_16x16x32_bf16 v[48:51], v[84:87], v[64:67], v[48:51]
  v_mfma_f32_16x16x32_bf16 v[32:35], v[92:95], v[88:91], v[32:35]
  v_mfma_f32_16x16x32_bf16 v[36:39], v[96:99], v[88:91], v[36:39]
  v_mfma_f32_16x16x32_bf16 v[40:43], v[100:103], v[88:91], v[40:43]
  v_mfma_f32_16x16x32_bf16 v[44:47], v[104:107], v[88:91], v[44:47]
  v_mfma_f32_16x16x32_bf16 v[48:51], v[108:111], v[88:91], v[48:51]
  s_lshl_b32 s44, s39, 4
  v_add_u32 v52, s44, v16
  v_mul_u32_u24 v52, 160, v52
  v_lshl_add_u32 v52, v17, 3, v52
  v_add_u32 v52, 83968, v52
  v_lshlrev_b32 v53, 3, v17
  v_add_u32 v53, 161280, v53
  ds_read_b64 v[64:65], v52 offset:0
  ds_read_b64 v[76:77], v53 offset:0
  ds_read_b64 v[66:67], v52 offset:32
  ds_read_b64 v[78:79], v53 offset:32
  ds_read_b64 v[68:69], v52 offset:64
  ds_read_b64 v[80:81], v53 offset:64
  ds_read_b64 v[70:71], v52 offset:96
  ds_read_b64 v[82:83], v53 offset:96
  ds_read_b64 v[72:73], v52 offset:128
  ds_read_b64 v[84:85], v53 offset:128
  v_add_u32 v88, 0, v1
  v_mul_u32_u24 v91, 6554, v88
  v_lshrrev_b32 v91, 16, v91
  v_mul_u32_u24 v92, 10, v91
  v_sub_u32 v92, v88, v92
  s_lshl_b32 s44, s39, 4
  v_add_u32 v93, s44, v91
  v_mul_u32_u24 v94, 160, v93
  v_lshl_add_u32 v94, v92, 4, v94
  v_add_u32 v94, 83968, v94
  s_lshl_b32 s44, s86, 4
  v_add_u32 v91, s44, v91
  v_mul_u32_u24 v91, 1280, v91
  v_lshl_add_u32 v91, v92, 4, v91
  s_mul_i32 s44, s69, 160
  v_add_u32 v97, s44, v91
  v_add_u32 v89, 64, v1
  v_mul_u32_u24 v91, 6554, v89
  v_lshrrev_b32 v91, 16, v91
  v_mul_u32_u24 v92, 10, v91
  v_sub_u32 v92, v89, v92
  s_lshl_b32 s44, s39, 4
  v_add_u32 v93, s44, v91
  v_mul_u32_u24 v95, 160, v93
  v_lshl_add_u32 v95, v92, 4, v95
  v_add_u32 v95, 83968, v95
  s_lshl_b32 s44, s86, 4
  v_add_u32 v91, s44, v91
  v_mul_u32_u24 v91, 1280, v91
  v_lshl_add_u32 v91, v92, 4, v91
  s_mul_i32 s44, s69, 160
  v_add_u32 v98, s44, v91
  v_add_u32 v90, 128, v1
  v_mul_u32_u24 v91, 6554, v90
  v_lshrrev_b32 v91, 16, v91
  v_mul_u32_u24 v92, 10, v91
  v_sub_u32 v92, v90, v92
  s_lshl_b32 s44, s39, 4
  v_add_u32 v93, s44, v91
  v_mul_u32_u24 v96, 160, v93
  v_lshl_add_u32 v96, v92, 4, v96
  v_add_u32 v96, 83968, v96
  s_lshl_b32 s44, s86, 4
  v_add_u32 v91, s44, v91
  v_mul_u32_u24 v91, 1280, v91
  v_lshl_add_u32 v91, v92, 4, v91
  s_mul_i32 s44, s69, 160
  v_add_u32 v99, s44, v91
  v_mov_b32 v91, 0x7fff0000
  v_cmp_gt_u32 vcc, 160, v90
  s_nop 1
  v_cndmask_b32 v99, v91, v99, vcc
  v_mov_b32 v91, 83968
  v_cndmask_b32 v96, v91, v96, vcc
  s_waitcnt lgkmcnt(0)
  v_lshlrev_b32 v54, 16, v64
  v_and_b32 v55, 0xffff0000, v64
  v_lshlrev_b32 v56, 16, v65
  v_and_b32 v57, 0xffff0000, v65
  v_lshlrev_b32 v58, 16, v76
  v_and_b32 v59, 0xffff0000, v76
  v_lshlrev_b32 v60, 16, v77
  v_and_b32 v61, 0xffff0000, v77
  v_pk_add_f32 v[54:55], v[54:55], v[58:59]
  v_pk_add_f32 v[56:57], v[56:57], v[60:61]
  v_pk_add_f32 v[32:33], v[32:33], v[54:55]
  v_pk_add_f32 v[34:35], v[34:35], v[56:57]
  v_cvt_pk_bf16_f32 v62, v32, v33
  v_cvt_pk_bf16_f32 v63, v34, v35
  ds_write_b64 v52, v[62:63] offset:0
  v_lshlrev_b32 v54, 16, v66
  v_and_b32 v55, 0xffff0000, v66
  v_lshlrev_b32 v56, 16, v67
  v_and_b32 v57, 0xffff0000, v67
  v_lshlrev_b32 v58, 16, v78
  v_and_b32 v59, 0xffff0000, v78
  v_lshlrev_b32 v60, 16, v79
  v_and_b32 v61, 0xffff0000, v79
  v_pk_add_f32 v[54:55], v[54:55], v[58:59]
  v_pk_add_f32 v[56:57], v[56:57], v[60:61]
  v_pk_add_f32 v[36:37], v[36:37], v[54:55]
  v_pk_add_f32 v[38:39], v[38:39], v[56:57]
  v_cvt_pk_bf16_f32 v62, v36, v37
  v_cvt_pk_bf16_f32 v63, v38, v39
  ds_write_b64 v52, v[62:63] offset:32
  v_lshlrev_b32 v54, 16, v68
  v_and_b32 v55, 0xffff0000, v68
  v_lshlrev_b32 v56, 16, v69
  v_and_b32 v57, 0xffff0000, v69
  v_lshlrev_b32 v58, 16, v80
  v_and_b32 v59, 0xffff0000, v80
  v_lshlrev_b32 v60, 16, v81
  v_and_b32 v61, 0xffff0000, v81
  v_pk_add_f32 v[54:55], v[54:55], v[58:59]
  v_pk_add_f32 v[56:57], v[56:57], v[60:61]
  v_pk_add_f32 v[40:41], v[40:41], v[54:55]
  v_pk_add_f32 v[42:43], v[42:43], v[56:57]
  v_cvt_pk_bf16_f32 v62, v40, v41
  v_cvt_pk_bf16_f32 v63, v42, v43
  ds_write_b64 v52, v[62:63] offset:64
  v_lshlrev_b32 v54, 16, v70
  v_and_b32 v55, 0xffff0000, v70
  v_lshlrev_b32 v56, 16, v71
  v_and_b32 v57, 0xffff0000, v71
  v_lshlrev_b32 v58, 16, v82
  v_and_b32 v59, 0xffff0000, v82
  v_lshlrev_b32 v60, 16, v83
  v_and_b32 v61, 0xffff0000, v83
  v_pk_add_f32 v[54:55], v[54:55], v[58:59]
  v_pk_add_f32 v[56:57], v[56:57], v[60:61]
  v_pk_add_f32 v[44:45], v[44:45], v[54:55]
  v_pk_add_f32 v[46:47], v[46:47], v[56:57]
  v_cvt_pk_bf16_f32 v62, v44, v45
  v_cvt_pk_bf16_f32 v63, v46, v47
  ds_write_b64 v52, v[62:63] offset:96
  v_lshlrev_b32 v54, 16, v72
  v_and_b32 v55, 0xffff0000, v72
  v_lshlrev_b32 v56, 16, v73
  v_and_b32 v57, 0xffff0000, v73
  v_lshlrev_b32 v58, 16, v84
  v_and_b32 v59, 0xffff0000, v84
  v_lshlrev_b32 v60, 16, v85
  v_and_b32 v61, 0xffff0000, v85
  v_pk_add_f32 v[54:55], v[54:55], v[58:59]
  v_pk_add_f32 v[56:57], v[56:57], v[60:61]
  v_pk_add_f32 v[48:49], v[48:49], v[54:55]
  v_pk_add_f32 v[50:51], v[50:51], v[56:57]
  v_cvt_pk_bf16_f32 v62, v48, v49
  v_cvt_pk_bf16_f32 v63, v50, v51
  ds_write_b64 v52, v[62:63] offset:128
  s_waitcnt lgkmcnt(0)
  ds_read_b128 v[100:103], v94
  ds_read_b128 v[104:107], v95
  ds_read_b128 v[108:111], v96
  s_waitcnt lgkmcnt(2)
  buffer_store_dwordx4 v[100:103], v97, s[60:63], 0 offen sc1
  s_waitcnt lgkmcnt(1)
  buffer_store_dwordx4 v[104:107], v98, s[60:63], 0 offen sc1
  s_waitcnt lgkmcnt(0)
  buffer_store_dwordx4 v[108:111], v99, s[60:63], 0 offen sc1
  s_endpgm
L_parallel_sum__linear_kernel_hedgehog__mixer_channel_mlp__prompt_kernel_loader:
  s_waitcnt vmcnt(17)
  s_barrier
  s_add_u32 m0, s48, 0
  s_nop 0
  buffer_load_dwordx4 v12, s[20:23], s100 offen lds
  s_add_u32 s100, s100, s49
  s_add_u32 m0, s48, 1024
  s_nop 0
  buffer_load_dwordx4 v12, s[20:23], s100 offen lds
  s_add_u32 s100, s100, s49
  s_add_u32 m0, s48, 2048
  s_nop 0
  buffer_load_dwordx4 v12, s[20:23], s100 offen lds
  s_add_u32 s100, s100, s49
  s_add_u32 m0, s48, 3072
  s_nop 0
  buffer_load_dwordx4 v12, s[20:23], s100 offen lds
  s_add_u32 s100, s100, s49
  s_waitcnt vmcnt(12)
  s_barrier
  s_add_u32 m0, s48, 16384
  s_nop 0
  buffer_load_dwordx4 v12, s[20:23], s100 offen lds
  s_add_u32 s100, s100, s49
  s_add_u32 m0, s48, 17408
  s_nop 0
  buffer_load_dwordx4 v12, s[20:23], s100 offen lds
  s_add_u32 s100, s100, s49
  s_add_u32 m0, s48, 18432
  s_nop 0
  buffer_load_dwordx4 v12, s[20:23], s100 offen lds
  s_add_u32 s100, s100, s49
  s_add_u32 m0, s48, 19456
  s_nop 0
  buffer_load_dwordx4 v12, s[20:23], s100 offen lds
  s_add_u32 s100, s100, s49
  s_add_u32 m0, s47, 0
  s_add_u32 s87, s101, 384
  buffer_load_dwordx4 v10, s[16:19], s87 offen lds
  s_add_u32 m0, s47, 1024
  s_add_u32 s87, s101, 10624
  buffer_load_dwordx4 v11, s[16:19], s87 offen lds
  s_add_u32 m0, s47, 2048
  s_add_u32 s87, s101, 20864
  buffer_load_dwordx4 v10, s[16:19], s87 offen lds
  s_add_u32 m0, s47, 3072
  s_add_u32 s87, s101, 31104
  buffer_load_dwordx4 v11, s[16:19], s87 offen lds
  s_waitcnt vmcnt(16)
  s_barrier
  s_add_u32 m0, s48, 32768
  s_nop 0
  buffer_load_dwordx4 v12, s[20:23], s100 offen lds
  s_add_u32 s100, s100, s49
  s_add_u32 m0, s48, 33792
  s_nop 0
  buffer_load_dwordx4 v12, s[20:23], s100 offen lds
  s_add_u32 s100, s100, s49
  s_add_u32 m0, s48, 34816
  s_nop 0
  buffer_load_dwordx4 v12, s[20:23], s100 offen lds
  s_add_u32 s100, s100, s49
  s_add_u32 m0, s48, 35840
  s_nop 0
  buffer_load_dwordx4 v12, s[20:23], s100 offen lds
  s_add_u32 s100, s100, s49
  s_waitcnt vmcnt(12)
  s_barrier
  s_add_u32 m0, s48, 49152
  s_nop 0
  buffer_load_dwordx4 v12, s[20:23], s100 offen lds
  s_add_u32 s100, s100, s49
  s_add_u32 m0, s48, 50176
  s_nop 0
  buffer_load_dwordx4 v12, s[20:23], s100 offen lds
  s_add_u32 s100, s100, s49
  s_add_u32 m0, s48, 51200
  s_nop 0
  buffer_load_dwordx4 v12, s[20:23], s100 offen lds
  s_add_u32 s100, s100, s49
  s_add_u32 m0, s48, 52224
  s_nop 0
  buffer_load_dwordx4 v12, s[20:23], s100 offen lds
  s_add_u32 s100, s100, s49
  s_add_u32 m0, s47, 16384
  s_add_u32 s87, s101, 512
  buffer_load_dwordx4 v10, s[16:19], s87 offen lds
  s_add_u32 m0, s47, 17408
  s_add_u32 s87, s101, 10752
  buffer_load_dwordx4 v11, s[16:19], s87 offen lds
  s_add_u32 m0, s47, 18432
  s_add_u32 s87, s101, 20992
  buffer_load_dwordx4 v10, s[16:19], s87 offen lds
  s_add_u32 m0, s47, 19456
  s_add_u32 s87, s101, 31232
  buffer_load_dwordx4 v11, s[16:19], s87 offen lds
  s_waitcnt vmcnt(16)
  s_barrier
  s_add_u32 m0, s48, 0
  s_nop 0
  buffer_load_dwordx4 v12, s[20:23], s100 offen lds
  s_add_u32 s100, s100, s49
  s_add_u32 m0, s48, 1024
  s_nop 0
  buffer_load_dwordx4 v12, s[20:23], s100 offen lds
  s_add_u32 s100, s100, s49
  s_add_u32 m0, s48, 2048
  s_nop 0
  buffer_load_dwordx4 v12, s[20:23], s100 offen lds
  s_add_u32 s100, s100, s49
  s_add_u32 m0, s48, 3072
  s_nop 0
  buffer_load_dwordx4 v12, s[20:23], s100 offen lds
  s_add_u32 s100, s100, s49
  s_waitcnt vmcnt(12)
  s_barrier
  s_add_u32 m0, s48, 16384
  s_nop 0
  buffer_load_dwordx4 v12, s[20:23], s100 offen lds
  s_add_u32 s100, s100, s49
  s_add_u32 m0, s48, 17408
  s_nop 0
  buffer_load_dwordx4 v12, s[20:23], s100 offen lds
  s_add_u32 s100, s100, s49
  s_add_u32 m0, s48, 18432
  s_nop 0
  buffer_load_dwordx4 v12, s[20:23], s100 offen lds
  s_add_u32 s100, s100, s49
  s_add_u32 m0, s48, 19456
  s_nop 0
  buffer_load_dwordx4 v12, s[20:23], s100 offen lds
  s_add_u32 s100, s100, s49
  s_add_u32 m0, s47, 32768
  s_add_u32 s87, s101, 640
  buffer_load_dwordx4 v10, s[16:19], s87 offen lds
  s_add_u32 m0, s47, 33792
  s_add_u32 s87, s101, 10880
  buffer_load_dwordx4 v11, s[16:19], s87 offen lds
  s_add_u32 m0, s47, 34816
  s_add_u32 s87, s101, 21120
  buffer_load_dwordx4 v10, s[16:19], s87 offen lds
  s_add_u32 m0, s47, 35840
  s_add_u32 s87, s101, 31360
  buffer_load_dwordx4 v11, s[16:19], s87 offen lds
  s_waitcnt vmcnt(16)
  s_barrier
  s_add_u32 m0, s48, 32768
  s_nop 0
  buffer_load_dwordx4 v12, s[20:23], s100 offen lds
  s_add_u32 s100, s100, s49
  s_add_u32 m0, s48, 33792
  s_nop 0
  buffer_load_dwordx4 v12, s[20:23], s100 offen lds
  s_add_u32 s100, s100, s49
  s_add_u32 m0, s48, 34816
  s_nop 0
  buffer_load_dwordx4 v12, s[20:23], s100 offen lds
  s_add_u32 s100, s100, s49
  s_add_u32 m0, s48, 35840
  s_nop 0
  buffer_load_dwordx4 v12, s[20:23], s100 offen lds
  s_add_u32 s100, s100, s49
  s_waitcnt vmcnt(12)
  s_barrier
  s_add_u32 m0, s48, 49152
  s_nop 0
  buffer_load_dwordx4 v12, s[20:23], s100 offen lds
  s_add_u32 s100, s100, s49
  s_add_u32 m0, s48, 50176
  s_nop 0
  buffer_load_dwordx4 v12, s[20:23], s100 offen lds
  s_add_u32 s100, s100, s49
  s_add_u32 m0, s48, 51200
  s_nop 0
  buffer_load_dwordx4 v12, s[20:23], s100 offen lds
  s_add_u32 s100, s100, s49
  s_add_u32 m0, s48, 52224
  s_nop 0
  buffer_load_dwordx4 v12, s[20:23], s100 offen lds
  s_add_u32 s100, s100, s49
  s_add_u32 m0, s47, 0
  s_add_u32 s87, s101, 768
  buffer_load_dwordx4 v10, s[16:19], s87 offen lds
  s_add_u32 m0, s47, 1024
  s_add_u32 s87, s101, 11008
  buffer_load_dwordx4 v11, s[16:19], s87 offen lds
  s_add_u32 m0, s47, 2048
  s_add_u32 s87, s101, 21248
  buffer_load_dwordx4 v10, s[16:19], s87 offen lds
  s_add_u32 m0, s47, 3072
  s_add_u32 s87, s101, 31488
  buffer_load_dwordx4 v11, s[16:19], s87 offen lds
  s_waitcnt vmcnt(16)
  s_barrier
  s_add_u32 m0, s48, 0
  s_nop 0
  buffer_load_dwordx4 v12, s[20:23], s100 offen lds
  s_add_u32 s100, s100, s49
  s_add_u32 m0, s48, 1024
  s_nop 0
  buffer_load_dwordx4 v12, s[20:23], s100 offen lds
  s_add_u32 s100, s100, s49
  s_add_u32 m0, s48, 2048
  s_nop 0
  buffer_load_dwordx4 v12, s[20:23], s100 offen lds
  s_add_u32 s100, s100, s49
  s_add_u32 m0, s48, 3072
  s_nop 0
  buffer_load_dwordx4 v12, s[20:23], s100 offen lds
  s_add_u32 s100, s100, s49
  s_waitcnt vmcnt(12)
  s_barrier
  s_add_u32 m0, s48, 16384
  s_nop 0
  buffer_load_dwordx4 v12, s[20:23], s100 offen lds
  s_add_u32 s100, s100, s49
  s_add_u32 m0, s48, 17408
  s_nop 0
  buffer_load_dwordx4 v12, s[20:23], s100 offen lds
  s_add_u32 s100, s100, s49
  s_add_u32 m0, s48, 18432
  s_nop 0
  buffer_load_dwordx4 v12, s[20:23], s100 offen lds
  s_add_u32 s100, s100, s49
  s_add_u32 m0, s48, 19456
  s_nop 0
  buffer_load_dwordx4 v12, s[20:23], s100 offen lds
  s_add_u32 s100, s100, s49
  s_add_u32 m0, s47, 16384
  s_add_u32 s87, s101, 896
  buffer_load_dwordx4 v10, s[16:19], s87 offen lds
  s_add_u32 m0, s47, 17408
  s_add_u32 s87, s101, 11136
  buffer_load_dwordx4 v11, s[16:19], s87 offen lds
  s_add_u32 m0, s47, 18432
  s_add_u32 s87, s101, 21376
  buffer_load_dwordx4 v10, s[16:19], s87 offen lds
  s_add_u32 m0, s47, 19456
  s_add_u32 s87, s101, 31616
  buffer_load_dwordx4 v11, s[16:19], s87 offen lds
  s_waitcnt vmcnt(16)
  s_barrier
  s_add_u32 m0, s48, 32768
  s_nop 0
  buffer_load_dwordx4 v12, s[20:23], s100 offen lds
  s_add_u32 s100, s100, s49
  s_add_u32 m0, s48, 33792
  s_nop 0
  buffer_load_dwordx4 v12, s[20:23], s100 offen lds
  s_add_u32 s100, s100, s49
  s_add_u32 m0, s48, 34816
  s_nop 0
  buffer_load_dwordx4 v12, s[20:23], s100 offen lds
  s_add_u32 s100, s100, s49
  s_add_u32 m0, s48, 35840
  s_nop 0
  buffer_load_dwordx4 v12, s[20:23], s100 offen lds
  s_add_u32 s100, s100, s49
  s_waitcnt vmcnt(12)
  s_barrier
  s_add_u32 m0, s48, 49152
  s_nop 0
  buffer_load_dwordx4 v12, s[20:23], s100 offen lds
  s_add_u32 s100, s100, s49
  s_add_u32 m0, s48, 50176
  s_nop 0
  buffer_load_dwordx4 v12, s[20:23], s100 offen lds
  s_add_u32 s100, s100, s49
  s_add_u32 m0, s48, 51200
  s_nop 0
  buffer_load_dwordx4 v12, s[20:23], s100 offen lds
  s_add_u32 s100, s100, s49
  s_add_u32 m0, s48, 52224
  s_nop 0
  buffer_load_dwordx4 v12, s[20:23], s100 offen lds
  s_add_u32 s100, s100, s49
  s_add_u32 m0, s47, 32768
  s_add_u32 s87, s101, 1024
  buffer_load_dwordx4 v10, s[16:19], s87 offen lds
  s_add_u32 m0, s47, 33792
  s_add_u32 s87, s101, 11264
  buffer_load_dwordx4 v11, s[16:19], s87 offen lds
  s_add_u32 m0, s47, 34816
  s_add_u32 s87, s101, 21504
  buffer_load_dwordx4 v10, s[16:19], s87 offen lds
  s_add_u32 m0, s47, 35840
  s_add_u32 s87, s101, 31744
  buffer_load_dwordx4 v11, s[16:19], s87 offen lds
  s_waitcnt vmcnt(16)
  s_barrier
  s_add_u32 m0, s48, 0
  s_nop 0
  buffer_load_dwordx4 v12, s[20:23], s100 offen lds
  s_add_u32 s100, s100, s49
  s_cmp_eq_u32 s39, 3
  s_cbranch_scc0 L_parallel_sum__linear_kernel_hedgehog__mixer_channel_mlp__prompt_kernel_nopf2nd
  s_getpc_b64 s[58:59]
L_parallel_sum__linear_kernel_hedgehog__mixer_channel_mlp__prompt_kernel_pc2:
  s_sub_u32 s58, s58, L_parallel_sum__linear_kernel_hedgehog__mixer_channel_mlp__prompt_kernel_pc2-parallel_sum__linear_kernel_hedgehog__mixer_channel_mlp__prompt_kernel
  s_subb_u32 s59, s59, 0
  s_lshr_b32 s41, s2, 3
  s_and_b32 s41, s41, 7
  s_lshl_b32 s41, s41, 13
  v_lshl_add_u32 v50, v1, 7, s41
  v_min_u32 v50, L_parallel_sum__linear_kernel_hedgehog__mixer_channel_mlp__prompt_kernel_codeend-parallel_sum__linear_kernel_hedgehog__mixer_channel_mlp__prompt_kernel-4, v50
  global_load_dword v51, v50, s[58:59]
L_parallel_sum__linear_kernel_hedgehog__mixer_channel_mlp__prompt_kernel_nopf2nd:
  s_add_u32 m0, s48, 1024
  s_nop 0
  buffer_load_dwordx4 v12, s[20:23], s100 offen lds
  s_add_u32 s100, s100, s49
  s_add_u32 m0, s48, 2048
  s_nop 0
  buffer_load_dwordx4 v12, s[20:23], s100 offen lds
  s_add_u32 s100, s100, s49
  s_add_u32 m0, s48, 3072
  s_nop 0
  buffer_load_dwordx4 v12, s[20:23], s100 offen lds
  s_add_u32 s100, s100, s49
  s_waitcnt vmcnt(12)
  s_barrier
  s_add_u32 m0, s48, 16384
  s_nop 0
  buffer_load_dwordx4 v12, s[20:23], s100 offen lds
  s_add_u32 s100, s100, s49
  s_add_u32 m0, s48, 17408
  s_nop 0
  buffer_load_dwordx4 v12, s[20:23], s100 offen lds
  s_add_u32 s100, s100, s49
  s_add_u32 m0, s48, 18432
  s_nop 0
  buffer_load_dwordx4 v12, s[20:23], s100 offen lds
  s_add_u32 s100, s100, s49
  s_add_u32 m0, s48, 19456
  s_nop 0
  buffer_load_dwordx4 v12, s[20:23], s100 offen lds
  s_add_u32 s100, s100, s49
  s_add_u32 m0, s47, 0
  s_add_u32 s87, s101, 1152
  buffer_load_dwordx4 v10, s[16:19], s87 offen lds
  s_add_u32 m0, s47, 1024
  s_add_u32 s87, s101, 11392
  buffer_load_dwordx4 v11, s[16:19], s87 offen lds
  s_add_u32 m0, s47, 2048
  s_add_u32 s87, s101, 21632
  buffer_load_dwordx4 v10, s[16:19], s87 offen lds
  s_add_u32 m0, s47, 3072
  s_add_u32 s87, s101, 31872
  buffer_load_dwordx4 v11, s[16:19], s87 offen lds
  s_waitcnt vmcnt(16)
  s_barrier
  s_add_u32 m0, s48, 32768
  s_nop 0
  buffer_load_dwordx4 v12, s[20:23], s100 offen lds
  s_add_u32 s100, s100, s49
  v_lshrrev_b32 v53, 2, v1
  v_lshlrev_b32 v53, 7, v53
  v_and_b32 v54, 3, v1
  v_lshl_add_u32 v53, v54, 2, v53
  v_add_u32 v53, 20971520, v53
  s_cmp_eq_u32 s39, 0
  s_cselect_b32 s41, 0, 0x7fff0000
  v_or_b32 v53, s41, v53
  buffer_load_dword v52, v53, s[24:27], 0 offen sc1
  s_add_u32 m0, s48, 33792
  s_nop 0
  buffer_load_dwordx4 v12, s[20:23], s100 offen lds
  s_add_u32 s100, s100, s49
  s_add_u32 m0, s48, 34816
  s_nop 0
  buffer_load_dwordx4 v12, s[20:23], s100 offen lds
  s_add_u32 s100, s100, s49
  s_add_u32 m0, s48, 35840
  s_nop 0
  buffer_load_dwordx4 v12, s[20:23], s100 offen lds
  s_add_u32 s100, s100, s49
  s_waitcnt vmcnt(13)
  s_barrier
  s_add_u32 m0, s48, 49152
  s_nop 0
  buffer_load_dwordx4 v12, s[20:23], s100 offen lds
  s_add_u32 s100, s100, s49
  s_add_u32 m0, s48, 50176
  s_nop 0
  buffer_load_dwordx4 v12, s[20:23], s100 offen lds
  s_add_u32 s100, s100, s49
  s_add_u32 m0, s48, 51200
  s_nop 0
  buffer_load_dwordx4 v12, s[20:23], s100 offen lds
  s_add_u32 s100, s100, s49
  s_add_u32 m0, s48, 52224
  s_nop 0
  buffer_load_dwordx4 v12, s[20:23], s100 offen lds
  s_add_u32 s100, s100, s49
  s_waitcnt vmcnt(13)
  s_waitcnt vmcnt(7)
  s_cmp_eq_u32 s39, 0
  s_cbranch_scc0 L_parallel_sum__linear_kernel_hedgehog__mixer_channel_mlp__prompt_kernel_f2_ok
  v_cmp_ne_u32 vcc, 0x01010101, v52
  s_nop 0
  s_cmp_eq_u64 vcc, 0
  s_cbranch_scc1 L_parallel_sum__linear_kernel_hedgehog__mixer_channel_mlp__prompt_kernel_f2_ok
L_parallel_sum__linear_kernel_hedgehog__mixer_channel_mlp__prompt_kernel_f2_sp:

  s_sleep 1
  buffer_load_dword v52, v53, s[24:27], 0 offen sc1
  s_waitcnt vmcnt(0)
  v_cmp_ne_u32 vcc, 0x01010101, v52
  s_nop 0
  s_cmp_eq_u64 vcc, 0
  s_cbranch_scc0 L_parallel_sum__linear_kernel_hedgehog__mixer_channel_mlp__prompt_kernel_f2_sp
L_parallel_sum__linear_kernel_hedgehog__mixer_channel_mlp__prompt_kernel_f2_ok:
  s_barrier
  v_lshlrev_b32 v21, 2, v20
  v_subrev_u32 v22, 1920, v20
  v_lshlrev_b32 v22, 1, v22
  s_lshl_b32 s58, s36, 7
  s_lshl_b32 s59, s39, 6
  s_add_u32 s58, s58, s59
  v_add_u32 v23, s58, v1
  v_lshlrev_b32 v23, 4, v23
  s_cmp_lt_u32 s39, 2
  s_cselect_b32 s59, 0, 0x7fff0000
  v_add_u32 v23, s59, v23
  s_mov_b32 s58, 65536
  buffer_load_dword v24, v21, s[24:27], s58 offen sc1
  s_mov_b32 s58, 80128
  buffer_load_dword v25, v21, s[24:27], s58 offen sc1
  s_mov_b32 s58, 94720
  buffer_load_dword v26, v21, s[24:27], s58 offen sc1
  s_mov_b32 s58, 109312
  buffer_load_dword v27, v21, s[24:27], s58 offen sc1
  s_mov_b32 s58, 123904
  buffer_load_dword v28, v21, s[24:27], s58 offen sc1
  s_mov_b32 s58, 138496
  buffer_load_dword v29, v21, s[24:27], s58 offen sc1
  s_mov_b32 s58, 153088
  buffer_load_dword v30, v21, s[24:27], s58 offen sc1
  s_mov_b32 s58, 167680
  buffer_load_dword v31, v21, s[24:27], s58 offen sc1
  s_mov_b32 s58, 182272
  buffer_load_dword v32, v21, s[24:27], s58 offen sc1
  s_mov_b32 s58, 196864
  buffer_load_dword v33, v21, s[24:27], s58 offen sc1
  buffer_load_ushort v34, v22, s[28:31], 0 offen
  buffer_load_dwordx4 v[36:39], v23, s[24:27], 0 offen sc1
  s_lshr_b32 s40, s2, 3
  s_and_b32 s68, s2, 3
  s_lshl_b32 s68, s68, 3
  s_lshr_b32 s41, s40, 2
  s_add_u32 s68, s68, s41
  s_lshr_b32 s69, s2, 2
  s_and_b32 s69, s69, 1
  s_lshl_b32 s69, s69, 2
  s_and_b32 s41, s40, 3
  s_add_u32 s69, s69, s41
  s_lshl_b32 s86, s68, 2
  s_add_u32 s86, s86, s39
  v_lshlrev_b32 v4, 4, v1
  s_mul_i32 s44, s69, 378880
  s_mul_i32 s45, s39, 5120
  s_add_u32 s44, s44, s45
  s_add_u32 s44, s44, 4194304
  s_mul_i32 s46, s86, 75776
  s_add_u32 s46, s46, 8388608
  s_waitcnt vmcnt(16)
  s_barrier
  s_waitcnt vmcnt(12)
  s_barrier
  s_waitcnt vmcnt(0)
  v_add_f32 v24, v24, v25
  v_add_f32 v24, v24, v26
  v_add_f32 v24, v24, v27
  v_add_f32 v24, v24, v28
  v_add_f32 v24, v24, v29
  v_add_f32 v24, v24, v30
  v_add_f32 v24, v24, v31
  v_add_f32 v24, v24, v32
  v_add_f32 v24, v24, v33
  v_cvt_pk_bf16_f32 v25, v24, v24
  v_and_b32 v26, 0xffff0000, v25
  v_sub_f32 v26, v24, v26
  v_cvt_pk_bf16_f32 v28, v24, v26
  v_and_b32 v29, 0xffff, v25
  v_lshl_or_b32 v29, v34, 16, v29
  v_mov_b32 v30, v34
  v_mov_b32 v31, 0
  v_lshlrev_b32 v27, 4, v1
  s_lshl_b32 s58, s39, 10
  s_add_u32 s58, s58, 147456
  v_add_u32 v27, s58, v27
  ds_write_b128 v27, v[28:31]
  v_mov_b32 v44, 0
  v_mov_b32 v45, 0
  v_mov_b32 v46, 0
  v_mov_b32 v47, 0
  v_add_u32 v27, 10240, v27
  s_cmp_lt_u32 s39, 2
  s_cbranch_scc0 L_parallel_sum__linear_kernel_hedgehog__mixer_channel_mlp__prompt_kernel_ld_nost
  ds_write_b128 v27, v[44:47]
  v_add_u32 v27, 4294961152, v27
  ds_write_b128 v27, v[36:39]
L_parallel_sum__linear_kernel_hedgehog__mixer_channel_mlp__prompt_kernel_ld_nost:
  s_waitcnt lgkmcnt(0)
  s_barrier
  s_cmp_eq_u32 s37, 0
  s_cbranch_scc1 L_parallel_sum__linear_kernel_hedgehog__mixer_channel_mlp__prompt_kernel_lb_kv
  s_setprio 2
  s_mul_i32 s47, s39, 5120
  s_lshl_b32 s48, s39, 12
  s_add_u32 s48, s48, 20480
  v_add_u32 v5, s47, v4
  v_add_u32 v6, 36864, v5
  v_add_u32 v7, 73728, v5
  v_add_u32 v8, 110592, v5
  s_add_u32 m0, s47, 0
  s_add_u32 s87, s44, 0
  buffer_load_dwordx4 v4, s[24:27], s87 offen sc1 lds
  s_add_u32 m0, s47, 1024
  s_add_u32 s87, s44, 1024
  buffer_load_dwordx4 v4, s[24:27], s87 offen sc1 lds
  s_add_u32 m0, s47, 2048
  s_add_u32 s87, s44, 2048
  buffer_load_dwordx4 v4, s[24:27], s87 offen sc1 lds
  s_add_u32 m0, s47, 3072
  s_add_u32 s87, s44, 3072
  buffer_load_dwordx4 v4, s[24:27], s87 offen sc1 lds
  s_add_u32 m0, s47, 4096
  s_add_u32 s87, s44, 4096
  buffer_load_dwordx4 v4, s[24:27], s87 offen sc1 lds
  s_add_u32 m0, s47, 36864
  s_add_u32 s87, s44, 20480
  buffer_load_dwordx4 v4, s[24:27], s87 offen sc1 lds
  s_add_u32 m0, s47, 37888
  s_add_u32 s87, s44, 21504
  buffer_load_dwordx4 v4, s[24:27], s87 offen sc1 lds
  s_add_u32 m0, s47, 38912
  s_add_u32 s87, s44, 22528
  buffer_load_dwordx4 v4, s[24:27], s87 offen sc1 lds
  s_add_u32 m0, s47, 39936
  s_add_u32 s87, s44, 23552
  buffer_load_dwordx4 v4, s[24:27], s87 offen sc1 lds
  s_add_u32 m0, s47, 40960
  s_add_u32 s87, s44, 24576
  buffer_load_dwordx4 v4, s[24:27], s87 offen sc1 lds
  s_add_u32 m0, s47, 73728
  s_add_u32 s87, s44, 40960
  buffer_load_dwordx4 v4, s[24:27], s87 offen sc1 lds
  s_add_u32 m0, s47, 74752
  s_add_u32 s87, s44, 41984
  buffer_load_dwordx4 v4, s[24:27], s87 offen sc1 lds
  s_add_u32 m0, s47, 75776
  s_add_u32 s87, s44, 43008
  buffer_load_dwordx4 v4, s[24:27], s87 offen sc1 lds
  s_add_u32 m0, s47, 76800
  s_add_u32 s87, s44, 44032
  buffer_load_dwordx4 v4, s[24:27], s87 offen sc1 lds
  s_add_u32 m0, s47, 77824
  s_add_u32 s87, s44, 45056
  buffer_load_dwordx4 v4, s[24:27], s87 offen sc1 lds
  s_add_u32 m0, s47, 110592
  s_add_u32 s87, s44, 61440
  buffer_load_dwordx4 v4, s[24:27], s87 offen sc1 lds
  s_add_u32 m0, s47, 111616
  s_add_u32 s87, s44, 62464
  buffer_load_dwordx4 v4, s[24:27], s87 offen sc1 lds
  s_add_u32 m0, s47, 112640
  s_add_u32 s87, s44, 63488
  buffer_load_dwordx4 v4, s[24:27], s87 offen sc1 lds
  s_add_u32 m0, s47, 113664
  s_add_u32 s87, s44, 64512
  buffer_load_dwordx4 v4, s[24:27], s87 offen sc1 lds
  s_add_u32 m0, s47, 114688
  s_add_u32 s87, s44, 65536
  buffer_load_dwordx4 v4, s[24:27], s87 offen sc1 lds
  s_barrier
  s_lshl_b32 s58, s69, 2
  s_add_u32 s58, s58, s39
  s_mul_i32 s58, s58, 800
  s_add_u32 s32, s8, s58
  s_addc_u32 s33, s9, 0
  s_and_b32 s33, s33, 0xffff
  s_mov_b32 s34, 800
  s_mov_b32 s35, 0x20000
  v_lshlrev_b32 v40, 4, v1
  s_lshl_b32 s58, s39, 10
  s_add_u32 m0, s58, 147456
  s_nop 0
  buffer_load_dwordx4 v40, s[32:35], 0 offen lds
  s_mov_b32 s34, 0
  s_and_b32 s58, s39, 1
  s_lshl_b32 s58, s58, 10
  s_add_u32 m0, s58, 159232
  s_nop 0
  buffer_load_dwordx4 v40, s[32:35], 0 offen lds
  s_lshr_b32 s41, s68, 1
  s_lshl_b32 s41, s41, 8
  s_add_u32 s41, s41, 20973568
  v_min_u32 v51, 1, v1
  v_lshlrev_b32 v51, 7, v51
  v_add_u32 v51, s41, v51
  buffer_load_dword v50, v51, s[24:27], 0 offen sc1
  s_waitcnt vmcnt(0)
  v_cmp_ne_u32 vcc, 0x01010101, v50
  s_nop 0
  s_cmp_eq_u64 vcc, 0
  s_cbranch_scc1 L_parallel_sum__linear_kernel_hedgehog__mixer_channel_mlp__prompt_kernel_g_ph1_ok
L_parallel_sum__linear_kernel_hedgehog__mixer_channel_mlp__prompt_kernel_g_ph1_sp:

  s_sleep 2
  buffer_load_dword v50, v51, s[24:27], 0 offen sc1
  s_waitcnt vmcnt(0)
  v_cmp_ne_u32 vcc, 0x01010101, v50
  s_nop 0
  s_cmp_eq_u64 vcc, 0
  s_cbranch_scc0 L_parallel_sum__linear_kernel_hedgehog__mixer_channel_mlp__prompt_kernel_g_ph1_sp
L_parallel_sum__linear_kernel_hedgehog__mixer_channel_mlp__prompt_kernel_g_ph1_ok:
  s_add_u32 m0, s48, 0
  s_add_u32 s87, s46, 0
  buffer_load_dwordx4 v4, s[24:27], s87 offen sc1 lds
  s_add_u32 m0, s48, 1024
  s_add_u32 s87, s46, 1024
  buffer_load_dwordx4 v4, s[24:27], s87 offen sc1 lds
  s_add_u32 m0, s48, 2048
  s_add_u32 s87, s46, 2048
  buffer_load_dwordx4 v4, s[24:27], s87 offen sc1 lds
  s_add_u32 m0, s48, 3072
  s_add_u32 s87, s46, 3072
  buffer_load_dwordx4 v4, s[24:27], s87 offen sc1 lds
  s_add_u32 m0, s48, 36864
  s_add_u32 s87, s46, 4096
  buffer_load_dwordx4 v4, s[24:27], s87 offen sc1 lds
  s_add_u32 m0, s48, 37888
  s_add_u32 s87, s46, 5120
  buffer_load_dwordx4 v4, s[24:27], s87 offen sc1 lds
  s_add_u32 m0, s48, 38912
  s_add_u32 s87, s46, 6144
  buffer_load_dwordx4 v4, s[24:27], s87 offen sc1 lds
  s_add_u32 m0, s48, 39936
  s_add_u32 s87, s46, 7168
  buffer_load_dwordx4 v4, s[24:27], s87 offen sc1 lds
  s_add_u32 m0, s48, 73728
  s_add_u32 s87, s46, 8192
  buffer_load_dwordx4 v4, s[24:27], s87 offen sc1 lds
  s_add_u32 m0, s48, 74752
  s_add_u32 s87, s46, 9216
  buffer_load_dwordx4 v4, s[24:27], s87 offen sc1 lds
  s_add_u32 m0, s48, 75776
  s_add_u32 s87, s46, 10240
  buffer_load_dwordx4 v4, s[24:27], s87 offen sc1 lds
  s_add_u32 m0, s48, 76800
  s_add_u32 s87, s46, 11264
  buffer_load_dwordx4 v4, s[24:27], s87 offen sc1 lds
  s_add_u32 m0, s48, 110592
  s_add_u32 s87, s46, 12288
  buffer_load_dwordx4 v4, s[24:27], s87 offen sc1 lds
  s_add_u32 m0, s48, 111616
  s_add_u32 s87, s46, 13312
  buffer_load_dwordx4 v4, s[24:27], s87 offen sc1 lds
  s_add_u32 m0, s48, 112640
  s_add_u32 s87, s46, 14336
  buffer_load_dwordx4 v4, s[24:27], s87 offen sc1 lds
  s_add_u32 m0, s48, 113664
  s_add_u32 s87, s46, 15360
  buffer_load_dwordx4 v4, s[24:27], s87 offen sc1 lds
  s_barrier
  s_waitcnt vmcnt(12)
  s_barrier
  s_lshl_b32 s41, s68, 9
  s_add_u32 s41, s41, 20981760
  v_min_u32 v51, 3, v1
  v_lshlrev_b32 v51, 7, v51
  v_add_u32 v51, s41, v51
  s_cmp_eq_u32 s39, 0
  s_cselect_b32 s41, 0, 0x7fff0000
  v_or_b32 v51, s41, v51
  buffer_load_dword v50, v51, s[24:27], 0 offen sc1
  s_waitcnt vmcnt(9)
  s_waitcnt vmcnt(0)
  s_cmp_eq_u32 s39, 0
  s_cbranch_scc0 L_parallel_sum__linear_kernel_hedgehog__mixer_channel_mlp__prompt_kernel_g_pq_ok
  v_cmp_ne_u32 vcc, 0x01010101, v50
  s_nop 0
  s_cmp_eq_u64 vcc, 0
  s_cbranch_scc1 L_parallel_sum__linear_kernel_hedgehog__mixer_channel_mlp__prompt_kernel_g_pq_ok
L_parallel_sum__linear_kernel_hedgehog__mixer_channel_mlp__prompt_kernel_g_pq_sp:

  s_sleep 1
  buffer_load_dword v50, v51, s[24:27], 0 offen sc1
  s_waitcnt vmcnt(0)
  v_cmp_ne_u32 vcc, 0x01010101, v50
  s_nop 0
  s_cmp_eq_u64 vcc, 0
  s_cbranch_scc0 L_parallel_sum__linear_kernel_hedgehog__mixer_channel_mlp__prompt_kernel_g_pq_sp
L_parallel_sum__linear_kernel_hedgehog__mixer_channel_mlp__prompt_kernel_g_pq_ok:
  s_waitcnt lgkmcnt(0)
  s_barrier
  s_add_u32 m0, s47, 0
  s_add_u32 s87, s44, 81920
  buffer_load_dwordx4 v4, s[24:27], s87 offen sc1 lds
  s_add_u32 m0, s47, 1024
  s_add_u32 s87, s44, 82944
  buffer_load_dwordx4 v4, s[24:27], s87 offen sc1 lds
  s_add_u32 m0, s47, 2048
  s_add_u32 s87, s44, 83968
  buffer_load_dwordx4 v4, s[24:27], s87 offen sc1 lds
  s_add_u32 m0, s47, 3072
  s_add_u32 s87, s44, 84992
  buffer_load_dwordx4 v4, s[24:27], s87 offen sc1 lds
  s_add_u32 m0, s47, 4096
  s_add_u32 s87, s44, 86016
  buffer_load_dwordx4 v4, s[24:27], s87 offen sc1 lds
  s_add_u32 m0, s48, 0
  s_add_u32 s87, s46, 16384
  buffer_load_dwordx4 v4, s[24:27], s87 offen sc1 lds
  s_add_u32 m0, s48, 1024
  s_add_u32 s87, s46, 17408
  buffer_load_dwordx4 v4, s[24:27], s87 offen sc1 lds
  s_add_u32 m0, s48, 2048
  s_add_u32 s87, s46, 18432
  buffer_load_dwordx4 v4, s[24:27], s87 offen sc1 lds
  s_add_u32 m0, s48, 3072
  s_add_u32 s87, s46, 19456
  buffer_load_dwordx4 v4, s[24:27], s87 offen sc1 lds
  s_waitcnt lgkmcnt(0)
  s_barrier
  s_add_u32 m0, s47, 36864
  s_add_u32 s87, s44, 102400
  buffer_load_dwordx4 v4, s[24:27], s87 offen sc1 lds
  s_add_u32 m0, s47, 37888
  s_add_u32 s87, s44, 103424
  buffer_load_dwordx4 v4, s[24:27], s87 offen sc1 lds
  s_add_u32 m0, s47, 38912
  s_add_u32 s87, s44, 104448
  buffer_load_dwordx4 v4, s[24:27], s87 offen sc1 lds
  s_add_u32 m0, s47, 39936
  s_add_u32 s87, s44, 105472
  buffer_load_dwordx4 v4, s[24:27], s87 offen sc1 lds
  s_add_u32 m0, s47, 40960
  s_add_u32 s87, s44, 106496
  buffer_load_dwordx4 v4, s[24:27], s87 offen sc1 lds
  s_add_u32 m0, s48, 36864
  s_add_u32 s87, s46, 20480
  buffer_load_dwordx4 v4, s[24:27], s87 offen sc1 lds
  s_add_u32 m0, s48, 37888
  s_add_u32 s87, s46, 21504
  buffer_load_dwordx4 v4, s[24:27], s87 offen sc1 lds
  s_add_u32 m0, s48, 38912
  s_add_u32 s87, s46, 22528
  buffer_load_dwordx4 v4, s[24:27], s87 offen sc1 lds
  s_add_u32 m0, s48, 39936
  s_add_u32 s87, s46, 23552
  buffer_load_dwordx4 v4, s[24:27], s87 offen sc1 lds
  s_waitcnt lgkmcnt(0)
  s_barrier
  s_add_u32 m0, s47, 73728
  s_add_u32 s87, s44, 122880
  buffer_load_dwordx4 v4, s[24:27], s87 offen sc1 lds
  s_lshr_b32 s41, s68, 1
  s_lshl_b32 s41, s41, 8
  s_add_u32 s41, s41, 20977664
  v_min_u32 v51, 1, v1
  v_lshlrev_b32 v51, 7, v51
  v_add_u32 v51, s41, v51
  s_cmp_eq_u32 s39, 0
  s_cselect_b32 s41, 0, 0x7fff0000
  v_or_b32 v51, s41, v51
  buffer_load_dword v50, v51, s[24:27], 0 offen sc1
  s_add_u32 m0, s47, 74752
  s_add_u32 s87, s44, 123904
  buffer_load_dwordx4 v4, s[24:27], s87 offen sc1 lds
  s_add_u32 m0, s47, 75776
  s_add_u32 s87, s44, 124928
  buffer_load_dwordx4 v4, s[24:27], s87 offen sc1 lds
  s_add_u32 m0, s47, 76800
  s_add_u32 s87, s44, 125952
  buffer_load_dwordx4 v4, s[24:27], s87 offen sc1 lds
  s_add_u32 m0, s47, 77824
  s_add_u32 s87, s44, 126976
  buffer_load_dwordx4 v4, s[24:27], s87 offen sc1 lds
  s_add_u32 m0, s48, 73728
  s_add_u32 s87, s46, 24576
  buffer_load_dwordx4 v4, s[24:27], s87 offen sc1 lds
  s_add_u32 m0, s48, 74752
  s_add_u32 s87, s46, 25600
  buffer_load_dwordx4 v4, s[24:27], s87 offen sc1 lds
  s_add_u32 m0, s48, 75776
  s_add_u32 s87, s46, 26624
  buffer_load_dwordx4 v4, s[24:27], s87 offen sc1 lds
  s_add_u32 m0, s48, 76800
  s_add_u32 s87, s46, 27648
  buffer_load_dwordx4 v4, s[24:27], s87 offen sc1 lds
  s_waitcnt vmcnt(19)
  s_waitcnt vmcnt(8)
  s_cmp_eq_u32 s39, 0
  s_cbranch_scc0 L_parallel_sum__linear_kernel_hedgehog__mixer_channel_mlp__prompt_kernel_g_ph2_ok
  v_cmp_ne_u32 vcc, 0x01010101, v50
  s_nop 0
  s_cmp_eq_u64 vcc, 0
  s_cbranch_scc1 L_parallel_sum__linear_kernel_hedgehog__mixer_channel_mlp__prompt_kernel_g_ph2_ok
L_parallel_sum__linear_kernel_hedgehog__mixer_channel_mlp__prompt_kernel_g_ph2_sp:

  s_sleep 1
  buffer_load_dword v50, v51, s[24:27], 0 offen sc1
  s_waitcnt vmcnt(0)
  v_cmp_ne_u32 vcc, 0x01010101, v50
  s_nop 0
  s_cmp_eq_u64 vcc, 0
  s_cbranch_scc0 L_parallel_sum__linear_kernel_hedgehog__mixer_channel_mlp__prompt_kernel_g_ph2_sp
L_parallel_sum__linear_kernel_hedgehog__mixer_channel_mlp__prompt_kernel_g_ph2_ok:
  s_waitcnt lgkmcnt(0)
  s_barrier
  s_add_u32 m0, s47, 110592
  s_add_u32 s87, s44, 143360
  buffer_load_dwordx4 v4, s[24:27], s87 offen sc1 lds
  s_add_u32 m0, s47, 111616
  s_add_u32 s87, s44, 144384
  buffer_load_dwordx4 v4, s[24:27], s87 offen sc1 lds
  s_add_u32 m0, s47, 112640
  s_add_u32 s87, s44, 145408
  buffer_load_dwordx4 v4, s[24:27], s87 offen sc1 lds
  s_add_u32 m0, s47, 113664
  s_add_u32 s87, s44, 146432
  buffer_load_dwordx4 v4, s[24:27], s87 offen sc1 lds
  s_add_u32 m0, s47, 114688
  s_add_u32 s87, s44, 147456
  buffer_load_dwordx4 v4, s[24:27], s87 offen sc1 lds
  s_add_u32 m0, s48, 110592
  s_add_u32 s87, s46, 28672
  buffer_load_dwordx4 v4, s[24:27], s87 offen sc1 lds
  s_add_u32 m0, s48, 111616
  s_add_u32 s87, s46, 29696
  buffer_load_dwordx4 v4, s[24:27], s87 offen sc1 lds
  s_add_u32 m0, s48, 112640
  s_add_u32 s87, s46, 30720
  buffer_load_dwordx4 v4, s[24:27], s87 offen sc1 lds
  s_add_u32 m0, s48, 113664
  s_add_u32 s87, s46, 31744
  buffer_load_dwordx4 v4, s[24:27], s87 offen sc1 lds
  s_waitcnt lgkmcnt(0)
  s_barrier
  s_add_u32 m0, s47, 0
  s_add_u32 s87, s44, 163840
  buffer_load_dwordx4 v4, s[24:27], s87 offen sc1 lds
  s_lshl_b32 s41, s69, 9
  s_add_u32 s41, s41, 21014528
  v_min_u32 v57, 3, v1
  v_lshlrev_b32 v57, 7, v57
  v_add_u32 v57, s41, v57
  s_cmp_eq_u32 s39, 0
  s_cselect_b32 s41, 0, 0x7fff0000
  v_or_b32 v57, s41, v57
  buffer_load_dword v56, v57, s[24:27], 0 offen sc1
  s_add_u32 m0, s47, 1024
  s_add_u32 s87, s44, 164864
  buffer_load_dwordx4 v4, s[24:27], s87 offen sc1 lds
  s_add_u32 m0, s47, 2048
  s_add_u32 s87, s44, 165888
  buffer_load_dwordx4 v4, s[24:27], s87 offen sc1 lds
  s_add_u32 m0, s47, 3072
  s_add_u32 s87, s44, 166912
  buffer_load_dwordx4 v4, s[24:27], s87 offen sc1 lds
  s_add_u32 m0, s47, 4096
  s_add_u32 s87, s44, 167936
  buffer_load_dwordx4 v4, s[24:27], s87 offen sc1 lds
  s_add_u32 m0, s48, 0
  s_add_u32 s87, s46, 32768
  buffer_load_dwordx4 v4, s[24:27], s87 offen sc1 lds
  s_add_u32 m0, s48, 1024
  s_add_u32 s87, s46, 33792
  buffer_load_dwordx4 v4, s[24:27], s87 offen sc1 lds
  s_add_u32 m0, s48, 2048
  s_add_u32 s87, s46, 34816
  buffer_load_dwordx4 v4, s[24:27], s87 offen sc1 lds
  s_add_u32 m0, s48, 3072
  s_add_u32 s87, s46, 35840
  buffer_load_dwordx4 v4, s[24:27], s87 offen sc1 lds
  s_waitcnt vmcnt(19)
  s_waitcnt vmcnt(8)
  s_cmp_eq_u32 s39, 0
  s_cbranch_scc0 L_parallel_sum__linear_kernel_hedgehog__mixer_channel_mlp__prompt_kernel_g_pkv_ok
  v_cmp_ne_u32 vcc, 0x01010101, v56
  s_nop 0
  s_cmp_eq_u64 vcc, 0
  s_cbranch_scc1 L_parallel_sum__linear_kernel_hedgehog__mixer_channel_mlp__prompt_kernel_g_pkv_ok
L_parallel_sum__linear_kernel_hedgehog__mixer_channel_mlp__prompt_kernel_g_pkv_sp:

  s_sleep 1
  buffer_load_dword v56, v57, s[24:27], 0 offen sc1
  s_waitcnt vmcnt(0)
  v_cmp_ne_u32 vcc, 0x01010101, v56
  s_nop 0
  s_cmp_eq_u64 vcc, 0
  s_cbranch_scc0 L_parallel_sum__linear_kernel_hedgehog__mixer_channel_mlp__prompt_kernel_g_pkv_sp
L_parallel_sum__linear_kernel_hedgehog__mixer_channel_mlp__prompt_kernel_g_pkv_ok:
  s_waitcnt lgkmcnt(0)
  s_barrier
  s_lshl_b32 s58, s39, 1
  s_add_u32 s58, s58, 0
  s_lshl_b32 s59, s58, 10
  v_add_u32 v60, s59, v4
  v_mov_b32 v61, 0x7fff0000
  v_cmp_gt_u32 vcc, 7680, v60
  s_nop 1
  v_cndmask_b32 v60, v61, v60, vcc
  s_add_u32 m0, s59, 151552
  s_mul_i32 s58, s69, 7680
  s_add_u32 s58, s58, 262144
  buffer_load_dwordx4 v60, s[24:27], s58 offen sc1 lds
  s_lshl_b32 s58, s39, 1
  s_add_u32 s58, s58, 1
  s_lshl_b32 s59, s58, 10
  v_add_u32 v60, s59, v4
  v_mov_b32 v61, 0x7fff0000
  v_cmp_gt_u32 vcc, 7680, v60
  s_nop 1
  v_cndmask_b32 v60, v61, v60, vcc
  s_add_u32 m0, s59, 151552
  s_mul_i32 s58, s69, 7680
  s_add_u32 s58, s58, 262144
  buffer_load_dwordx4 v60, s[24:27], s58 offen sc1 lds
  s_add_u32 m0, s47, 36864
  s_add_u32 s87, s44, 184320
  buffer_load_dwordx4 v4, s[24:27], s87 offen sc1 lds
  s_add_u32 m0, s47, 37888
  s_add_u32 s87, s44, 185344
  buffer_load_dwordx4 v4, s[24:27], s87 offen sc1 lds
  s_add_u32 m0, s47, 38912
  s_add_u32 s87, s44, 186368
  buffer_load_dwordx4 v4, s[24:27], s87 offen sc1 lds
  s_add_u32 m0, s47, 39936
  s_add_u32 s87, s44, 187392
  buffer_load_dwordx4 v4, s[24:27], s87 offen sc1 lds
  s_add_u32 m0, s47, 40960
  s_add_u32 s87, s44, 188416
  buffer_load_dwordx4 v4, s[24:27], s87 offen sc1 lds
  s_add_u32 m0, s48, 36864
  s_add_u32 s87, s46, 36864
  buffer_load_dwordx4 v4, s[24:27], s87 offen sc1 lds
  s_add_u32 m0, s48, 37888
  s_add_u32 s87, s46, 37888
  buffer_load_dwordx4 v4, s[24:27], s87 offen sc1 lds
  s_add_u32 m0, s48, 38912
  s_add_u32 s87, s46, 38912
  buffer_load_dwordx4 v4, s[24:27], s87 offen sc1 lds
  s_add_u32 m0, s48, 39936
  s_add_u32 s87, s46, 39936
  buffer_load_dwordx4 v4, s[24:27], s87 offen sc1 lds
  s_waitcnt vmcnt(9)
  s_waitcnt lgkmcnt(0)
  s_barrier
  s_add_u32 m0, s47, 73728
  s_add_u32 s87, s44, 204800
  buffer_load_dwordx4 v4, s[24:27], s87 offen sc1 lds
  s_add_u32 m0, s47, 74752
  s_add_u32 s87, s44, 205824
  buffer_load_dwordx4 v4, s[24:27], s87 offen sc1 lds
  s_add_u32 m0, s47, 75776
  s_add_u32 s87, s44, 206848
  buffer_load_dwordx4 v4, s[24:27], s87 offen sc1 lds
  s_add_u32 m0, s47, 76800
  s_add_u32 s87, s44, 207872
  buffer_load_dwordx4 v4, s[24:27], s87 offen sc1 lds
  s_add_u32 m0, s47, 77824
  s_add_u32 s87, s44, 208896
  buffer_load_dwordx4 v4, s[24:27], s87 offen sc1 lds
  s_add_u32 m0, s48, 73728
  s_add_u32 s87, s46, 40960
  buffer_load_dwordx4 v4, s[24:27], s87 offen sc1 lds
  s_add_u32 m0, s48, 74752
  s_add_u32 s87, s46, 41984
  buffer_load_dwordx4 v4, s[24:27], s87 offen sc1 lds
  s_add_u32 m0, s48, 75776
  s_add_u32 s87, s46, 43008
  buffer_load_dwordx4 v4, s[24:27], s87 offen sc1 lds
  s_add_u32 m0, s48, 76800
  s_add_u32 s87, s46, 44032
  buffer_load_dwordx4 v4, s[24:27], s87 offen sc1 lds
  s_waitcnt lgkmcnt(0)
  s_barrier
  s_add_u32 m0, s47, 110592
  s_add_u32 s87, s44, 225280
  buffer_load_dwordx4 v4, s[24:27], s87 offen sc1 lds
  s_add_u32 m0, s47, 111616
  s_add_u32 s87, s44, 226304
  buffer_load_dwordx4 v4, s[24:27], s87 offen sc1 lds
  s_add_u32 m0, s47, 112640
  s_add_u32 s87, s44, 227328
  buffer_load_dwordx4 v4, s[24:27], s87 offen sc1 lds
  s_add_u32 m0, s47, 113664
  s_add_u32 s87, s44, 228352
  buffer_load_dwordx4 v4, s[24:27], s87 offen sc1 lds
  s_add_u32 m0, s47, 114688
  s_add_u32 s87, s44, 229376
  buffer_load_dwordx4 v4, s[24:27], s87 offen sc1 lds
  s_add_u32 m0, s48, 110592
  s_add_u32 s87, s46, 45056
  buffer_load_dwordx4 v4, s[24:27], s87 offen sc1 lds
  s_add_u32 m0, s48, 111616
  s_add_u32 s87, s46, 46080
  buffer_load_dwordx4 v4, s[24:27], s87 offen sc1 lds
  s_add_u32 m0, s48, 112640
  s_add_u32 s87, s46, 47104
  buffer_load_dwordx4 v4, s[24:27], s87 offen sc1 lds
  s_add_u32 m0, s48, 113664
  s_add_u32 s87, s46, 48128
  buffer_load_dwordx4 v4, s[24:27], s87 offen sc1 lds
  s_waitcnt vmcnt(18)
  s_waitcnt lgkmcnt(0)
  s_barrier
  s_add_u32 m0, s47, 0
  s_add_u32 s87, s44, 245760
  buffer_load_dwordx4 v4, s[24:27], s87 offen sc1 lds
  s_add_u32 m0, s47, 1024
  s_add_u32 s87, s44, 246784
  buffer_load_dwordx4 v4, s[24:27], s87 offen sc1 lds
  s_add_u32 m0, s47, 2048
  s_add_u32 s87, s44, 247808
  buffer_load_dwordx4 v4, s[24:27], s87 offen sc1 lds
  s_add_u32 m0, s47, 3072
  s_add_u32 s87, s44, 248832
  buffer_load_dwordx4 v4, s[24:27], s87 offen sc1 lds
  s_add_u32 m0, s47, 4096
  s_add_u32 s87, s44, 249856
  buffer_load_dwordx4 v4, s[24:27], s87 offen sc1 lds
  s_add_u32 m0, s48, 0
  s_add_u32 s87, s46, 49152
  buffer_load_dwordx4 v4, s[24:27], s87 offen sc1 lds
  s_add_u32 m0, s48, 1024
  s_add_u32 s87, s46, 50176
  buffer_load_dwordx4 v4, s[24:27], s87 offen sc1 lds
  s_add_u32 m0, s48, 2048
  s_add_u32 s87, s46, 51200
  buffer_load_dwordx4 v4, s[24:27], s87 offen sc1 lds
  s_add_u32 m0, s48, 3072
  s_add_u32 s87, s46, 52224
  buffer_load_dwordx4 v4, s[24:27], s87 offen sc1 lds
  s_waitcnt vmcnt(18)
  s_waitcnt lgkmcnt(0)
  s_barrier
  s_add_u32 m0, s47, 36864
  s_add_u32 s87, s44, 266240
  buffer_load_dwordx4 v4, s[24:27], s87 offen sc1 lds
  s_add_u32 m0, s47, 37888
  s_add_u32 s87, s44, 267264
  buffer_load_dwordx4 v4, s[24:27], s87 offen sc1 lds
  s_add_u32 m0, s47, 38912
  s_add_u32 s87, s44, 268288
  buffer_load_dwordx4 v4, s[24:27], s87 offen sc1 lds
  s_add_u32 m0, s47, 39936
  s_add_u32 s87, s44, 269312
  buffer_load_dwordx4 v4, s[24:27], s87 offen sc1 lds
  s_add_u32 m0, s47, 40960
  s_add_u32 s87, s44, 270336
  buffer_load_dwordx4 v4, s[24:27], s87 offen sc1 lds
  s_waitcnt vmcnt(14)
  s_waitcnt lgkmcnt(0)
  s_barrier
  s_add_u32 m0, s47, 73728
  s_add_u32 s87, s44, 286720
  buffer_load_dwordx4 v4, s[24:27], s87 offen sc1 lds
  s_add_u32 m0, s47, 74752
  s_add_u32 s87, s44, 287744
  buffer_load_dwordx4 v4, s[24:27], s87 offen sc1 lds
  s_add_u32 m0, s47, 75776
  s_add_u32 s87, s44, 288768
  buffer_load_dwordx4 v4, s[24:27], s87 offen sc1 lds
  s_add_u32 m0, s47, 76800
  s_add_u32 s87, s44, 289792
  buffer_load_dwordx4 v4, s[24:27], s87 offen sc1 lds
  s_add_u32 m0, s47, 77824
  s_add_u32 s87, s44, 290816
  buffer_load_dwordx4 v4, s[24:27], s87 offen sc1 lds
  s_waitcnt vmcnt(10)
  s_waitcnt lgkmcnt(0)
  s_barrier
  s_add_u32 m0, s47, 110592
  s_add_u32 s87, s44, 307200
  buffer_load_dwordx4 v4, s[24:27], s87 offen sc1 lds
  s_add_u32 m0, s47, 111616
  s_add_u32 s87, s44, 308224
  buffer_load_dwordx4 v4, s[24:27], s87 offen sc1 lds
  s_add_u32 m0, s47, 112640
  s_add_u32 s87, s44, 309248
  buffer_load_dwordx4 v4, s[24:27], s87 offen sc1 lds
  s_add_u32 m0, s47, 113664
  s_add_u32 s87, s44, 310272
  buffer_load_dwordx4 v4, s[24:27], s87 offen sc1 lds
  s_add_u32 m0, s47, 114688
  s_add_u32 s87, s44, 311296
  buffer_load_dwordx4 v4, s[24:27], s87 offen sc1 lds
  s_lshl_b32 s41, s86, 8
  s_add_u32 s41, s41, 21018624
  v_min_u32 v51, 1, v1
  v_lshlrev_b32 v51, 7, v51
  v_add_u32 v51, s41, v51
  buffer_load_dword v50, v51, s[24:27], 0 offen sc1
  s_waitcnt vmcnt(0)
  v_cmp_ne_u32 vcc, 0x01010101, v50
  s_nop 0
  s_cmp_eq_u64 vcc, 0
  s_cbranch_scc1 L_parallel_sum__linear_kernel_hedgehog__mixer_channel_mlp__prompt_kernel_g_po_ok
L_parallel_sum__linear_kernel_hedgehog__mixer_channel_mlp__prompt_kernel_g_po_sp:

  s_sleep 1
  buffer_load_dword v50, v51, s[24:27], 0 offen sc1
  s_waitcnt vmcnt(0)
  v_cmp_ne_u32 vcc, 0x01010101, v50
  s_nop 0
  s_cmp_eq_u64 vcc, 0
  s_cbranch_scc0 L_parallel_sum__linear_kernel_hedgehog__mixer_channel_mlp__prompt_kernel_g_po_sp
L_parallel_sum__linear_kernel_hedgehog__mixer_channel_mlp__prompt_kernel_g_po_ok:
  s_add_u32 m0, s48, 36864
  s_add_u32 s87, s46, 53248
  buffer_load_dwordx4 v4, s[24:27], s87 offen sc1 lds
  s_add_u32 m0, s48, 37888
  s_add_u32 s87, s46, 54272
  buffer_load_dwordx4 v4, s[24:27], s87 offen sc1 lds
  s_add_u32 m0, s48, 38912
  s_add_u32 s87, s46, 55296
  buffer_load_dwordx4 v4, s[24:27], s87 offen sc1 lds
  s_add_u32 m0, s48, 39936
  s_add_u32 s87, s46, 56320
  buffer_load_dwordx4 v4, s[24:27], s87 offen sc1 lds
  s_add_u32 m0, s48, 73728
  s_add_u32 s87, s46, 57344
  buffer_load_dwordx4 v4, s[24:27], s87 offen sc1 lds
  s_add_u32 m0, s48, 74752
  s_add_u32 s87, s46, 58368
  buffer_load_dwordx4 v4, s[24:27], s87 offen sc1 lds
  s_add_u32 m0, s48, 75776
  s_add_u32 s87, s46, 59392
  buffer_load_dwordx4 v4, s[24:27], s87 offen sc1 lds
  s_add_u32 m0, s48, 76800
  s_add_u32 s87, s46, 60416
  buffer_load_dwordx4 v4, s[24:27], s87 offen sc1 lds
  s_add_u32 m0, s48, 110592
  s_add_u32 s87, s46, 61440
  buffer_load_dwordx4 v4, s[24:27], s87 offen sc1 lds
  s_add_u32 m0, s48, 111616
  s_add_u32 s87, s46, 62464
  buffer_load_dwordx4 v4, s[24:27], s87 offen sc1 lds
  s_add_u32 m0, s48, 112640
  s_add_u32 s87, s46, 63488
  buffer_load_dwordx4 v4, s[24:27], s87 offen sc1 lds
  s_add_u32 m0, s48, 113664
  s_add_u32 s87, s46, 64512
  buffer_load_dwordx4 v4, s[24:27], s87 offen sc1 lds
  s_waitcnt vmcnt(8)
  s_waitcnt lgkmcnt(0)
  s_barrier
  s_add_u32 m0, s47, 0
  s_add_u32 s87, s44, 327680
  buffer_load_dwordx4 v4, s[24:27], s87 offen sc1 lds
  s_add_u32 m0, s47, 1024
  s_add_u32 s87, s44, 328704
  buffer_load_dwordx4 v4, s[24:27], s87 offen sc1 lds
  s_add_u32 m0, s47, 2048
  s_add_u32 s87, s44, 329728
  buffer_load_dwordx4 v4, s[24:27], s87 offen sc1 lds
  s_add_u32 m0, s47, 3072
  s_add_u32 s87, s44, 330752
  buffer_load_dwordx4 v4, s[24:27], s87 offen sc1 lds
  s_add_u32 m0, s47, 4096
  s_add_u32 s87, s44, 331776
  buffer_load_dwordx4 v4, s[24:27], s87 offen sc1 lds
  s_add_u32 m0, s48, 0
  s_add_u32 s87, s46, 65536
  buffer_load_dwordx4 v4, s[24:27], s87 offen sc1 lds
  s_add_u32 m0, s48, 1024
  s_add_u32 s87, s46, 66560
  buffer_load_dwordx4 v4, s[24:27], s87 offen sc1 lds
  s_add_u32 m0, s48, 2048
  s_add_u32 s87, s46, 67584
  buffer_load_dwordx4 v4, s[24:27], s87 offen sc1 lds
  s_add_u32 m0, s48, 3072
  s_add_u32 s87, s46, 68608
  buffer_load_dwordx4 v4, s[24:27], s87 offen sc1 lds
  s_waitcnt vmcnt(13)
  s_waitcnt lgkmcnt(0)
  s_barrier
  s_add_u32 m0, s47, 36864
  s_add_u32 s87, s44, 348160
  buffer_load_dwordx4 v4, s[24:27], s87 offen sc1 lds
  s_add_u32 m0, s47, 37888
  s_add_u32 s87, s44, 349184
  buffer_load_dwordx4 v4, s[24:27], s87 offen sc1 lds
  s_add_u32 m0, s47, 38912
  s_add_u32 s87, s44, 350208
  buffer_load_dwordx4 v4, s[24:27], s87 offen sc1 lds
  s_add_u32 m0, s47, 39936
  s_add_u32 s87, s44, 351232
  buffer_load_dwordx4 v4, s[24:27], s87 offen sc1 lds
  s_add_u32 m0, s47, 40960
  s_add_u32 s87, s44, 352256
  buffer_load_dwordx4 v4, s[24:27], s87 offen sc1 lds
  s_add_u32 m0, s48, 36864
  s_add_u32 s87, s46, 69632
  buffer_load_dwordx4 v4, s[24:27], s87 offen sc1 lds
  s_add_u32 m0, s48, 37888
  s_add_u32 s87, s46, 70656
  buffer_load_dwordx4 v4, s[24:27], s87 offen sc1 lds
  s_add_u32 m0, s48, 38912
  s_add_u32 s87, s46, 71680
  buffer_load_dwordx4 v4, s[24:27], s87 offen sc1 lds
  s_add_u32 m0, s48, 39936
  s_add_u32 s87, s46, 72704
  buffer_load_dwordx4 v4, s[24:27], s87 offen sc1 lds
  s_waitcnt vmcnt(18)
  s_waitcnt lgkmcnt(0)
  s_barrier
  s_add_u32 s87, s47, 73728
  s_cmp_lt_u32 s39, 2
  s_cselect_b32 m0, s87, 159232
  s_cselect_b32 s26, 21073920, 0
  s_add_u32 s87, s44, 368640
  buffer_load_dwordx4 v4, s[24:27], s87 offen sc1 lds
  s_mov_b32 s26, 21073920
  s_add_u32 s58, s39, 0
  s_lshl_b32 s59, s58, 6
  v_add_u32 v60, s59, v1
  v_mul_u32_u24 v61, 6554, v60
  v_lshrrev_b32 v61, 16, v61
  v_mul_u32_u24 v62, 10, v61
  v_sub_u32 v62, v60, v62
  s_lshl_b32 s59, s68, 6
  v_add_u32 v61, s59, v61
  v_mul_u32_u24 v61, 1280, v61
  v_lshl_add_u32 v61, v62, 4, v61
  s_mul_i32 s59, s69, 160
  v_add_u32 v61, s59, v61
  s_lshl_b32 s59, s58, 10
  s_add_u32 s59, s59, 83968
  s_cmp_lt_u32 s58, 10
  s_cselect_b32 s59, s59, 159232
  s_cselect_b32 s58, 0, 0x7fff0000
  v_or_b32 v61, s58, v61
  s_mov_b32 m0, s59
  s_nop 0
  buffer_load_dwordx4 v61, s[16:19], 0 offen lds
  s_add_u32 s87, s47, 74752
  s_cmp_lt_u32 s39, 2
  s_cselect_b32 m0, s87, 159232
  s_cselect_b32 s26, 21073920, 0
  s_add_u32 s87, s44, 369664
  buffer_load_dwordx4 v4, s[24:27], s87 offen sc1 lds
  s_mov_b32 s26, 21073920
  s_add_u32 s58, s39, 4
  s_lshl_b32 s59, s58, 6
  v_add_u32 v60, s59, v1
  v_mul_u32_u24 v61, 6554, v60
  v_lshrrev_b32 v61, 16, v61
  v_mul_u32_u24 v62, 10, v61
  v_sub_u32 v62, v60, v62
  s_lshl_b32 s59, s68, 6
  v_add_u32 v61, s59, v61
  v_mul_u32_u24 v61, 1280, v61
  v_lshl_add_u32 v61, v62, 4, v61
  s_mul_i32 s59, s69, 160
  v_add_u32 v61, s59, v61
  s_lshl_b32 s59, s58, 10
  s_add_u32 s59, s59, 83968
  s_cmp_lt_u32 s58, 10
  s_cselect_b32 s59, s59, 159232
  s_cselect_b32 s58, 0, 0x7fff0000
  v_or_b32 v61, s58, v61
  s_mov_b32 m0, s59
  s_nop 0
  buffer_load_dwordx4 v61, s[16:19], 0 offen lds
  s_add_u32 s87, s47, 75776
  s_cmp_lt_u32 s39, 2
  s_cselect_b32 m0, s87, 159232
  s_cselect_b32 s26, 21073920, 0
  s_add_u32 s87, s44, 370688
  buffer_load_dwordx4 v4, s[24:27], s87 offen sc1 lds
  s_mov_b32 s26, 21073920
  s_add_u32 s58, s39, 8
  s_lshl_b32 s59, s58, 6
  v_add_u32 v60, s59, v1
  v_mul_u32_u24 v61, 6554, v60
  v_lshrrev_b32 v61, 16, v61
  v_mul_u32_u24 v62, 10, v61
  v_sub_u32 v62, v60, v62
  s_lshl_b32 s59, s68, 6
  v_add_u32 v61, s59, v61
  v_mul_u32_u24 v61, 1280, v61
  v_lshl_add_u32 v61, v62, 4, v61
  s_mul_i32 s59, s69, 160
  v_add_u32 v61, s59, v61
  s_lshl_b32 s59, s58, 10
  s_add_u32 s59, s59, 83968
  s_cmp_lt_u32 s58, 10
  s_cselect_b32 s59, s59, 159232
  s_cselect_b32 s58, 0, 0x7fff0000
  v_or_b32 v61, s58, v61
  s_mov_b32 m0, s59
  s_nop 0
  buffer_load_dwordx4 v61, s[16:19], 0 offen lds
  s_add_u32 s87, s47, 76800
  s_cmp_lt_u32 s39, 2
  s_cselect_b32 m0, s87, 159232
  s_cselect_b32 s26, 21073920, 0
  s_add_u32 s87, s44, 371712
  buffer_load_dwordx4 v4, s[24:27], s87 offen sc1 lds
  s_mov_b32 s26, 21073920
  s_mul_i32 s58, s69, 160
  s_add_u32 s32, s80, s58
  s_addc_u32 s33, s81, 0
  s_and_b32 s33, s33, 0xffff
  s_mov_b32 s34, 160
  s_mov_b32 s35, 0x20000
  s_mov_b32 m0, 161280
  s_nop 0
  buffer_load_dwordx4 v4, s[32:35], 0 offen lds
  s_add_u32 s87, s47, 77824
  s_cmp_lt_u32 s39, 2
  s_cselect_b32 m0, s87, 159232
  s_cselect_b32 s26, 21073920, 0
  s_add_u32 s87, s44, 372736
  buffer_load_dwordx4 v4, s[24:27], s87 offen sc1 lds
  s_mov_b32 s26, 21073920
  s_add_u32 m0, s48, 73728
  s_add_u32 s87, s46, 73728
  buffer_load_dwordx4 v4, s[24:27], s87 offen sc1 lds
  s_add_u32 m0, s48, 74752
  s_add_u32 s87, s46, 74752
  buffer_load_dwordx4 v4, s[24:27], s87 offen sc1 lds
  s_waitcnt vmcnt(20)
  s_waitcnt lgkmcnt(0)
  s_barrier
  s_waitcnt vmcnt(11)
  s_waitcnt lgkmcnt(0)
  s_barrier
  s_waitcnt vmcnt(0)
  s_waitcnt lgkmcnt(0)
  s_barrier
  s_endpgm
L_parallel_sum__linear_kernel_hedgehog__mixer_channel_mlp__prompt_kernel_lb_kv:
  s_setprio 2
  s_mul_i32 s47, s39, 5120
  s_lshl_b32 s48, s39, 12
  s_add_u32 s48, s48, 20480
  v_add_u32 v5, s47, v4
  v_add_u32 v6, 36864, v5
  v_add_u32 v7, 73728, v5
  v_add_u32 v8, 110592, v5
  s_add_u32 m0, s47, 0
  s_add_u32 s87, s44, 0
  buffer_load_dwordx4 v4, s[24:27], s87 offen sc1 lds
  s_add_u32 m0, s47, 1024
  s_add_u32 s87, s44, 1024
  buffer_load_dwordx4 v4, s[24:27], s87 offen sc1 lds
  s_add_u32 m0, s47, 2048
  s_add_u32 s87, s44, 2048
  buffer_load_dwordx4 v4, s[24:27], s87 offen sc1 lds
  s_add_u32 m0, s47, 3072
  s_add_u32 s87, s44, 3072
  buffer_load_dwordx4 v4, s[24:27], s87 offen sc1 lds
  s_add_u32 m0, s47, 4096
  s_add_u32 s87, s44, 4096
  buffer_load_dwordx4 v4, s[24:27], s87 offen sc1 lds
  s_add_u32 m0, s47, 36864
  s_add_u32 s87, s44, 20480
  buffer_load_dwordx4 v4, s[24:27], s87 offen sc1 lds
  s_add_u32 m0, s47, 37888
  s_add_u32 s87, s44, 21504
  buffer_load_dwordx4 v4, s[24:27], s87 offen sc1 lds
  s_add_u32 m0, s47, 38912
  s_add_u32 s87, s44, 22528
  buffer_load_dwordx4 v4, s[24:27], s87 offen sc1 lds
  s_add_u32 m0, s47, 39936
  s_add_u32 s87, s44, 23552
  buffer_load_dwordx4 v4, s[24:27], s87 offen sc1 lds
  s_add_u32 m0, s47, 40960
  s_add_u32 s87, s44, 24576
  buffer_load_dwordx4 v4, s[24:27], s87 offen sc1 lds
  s_barrier
  s_lshl_b32 s58, s69, 2
  s_add_u32 s58, s58, s39
  s_mul_i32 s58, s58, 800
  s_add_u32 s32, s8, s58
  s_addc_u32 s33, s9, 0
  s_and_b32 s33, s33, 0xffff
  s_mov_b32 s34, 800
  s_mov_b32 s35, 0x20000
  v_lshlrev_b32 v40, 4, v1
  s_lshl_b32 s58, s39, 10
  s_add_u32 m0, s58, 147456
  s_nop 0
  buffer_load_dwordx4 v40, s[32:35], 0 offen lds
  s_mov_b32 s34, 0
  s_and_b32 s58, s39, 1
  s_lshl_b32 s58, s58, 10
  s_add_u32 m0, s58, 159232
  s_nop 0
  buffer_load_dwordx4 v40, s[32:35], 0 offen lds
  s_waitcnt vmcnt(0)
  s_barrier
  s_lshr_b32 s41, s68, 1
  s_lshl_b32 s41, s41, 8
  s_add_u32 s41, s41, 20973568
  v_min_u32 v51, 1, v1
  v_lshlrev_b32 v51, 7, v51
  v_add_u32 v51, s41, v51
  buffer_load_dword v50, v51, s[24:27], 0 offen sc1
  s_waitcnt vmcnt(0)
  v_cmp_ne_u32 vcc, 0x01010101, v50
  s_nop 0
  s_cmp_eq_u64 vcc, 0
  s_cbranch_scc1 L_parallel_sum__linear_kernel_hedgehog__mixer_channel_mlp__prompt_kernel_k_ph1_ok
L_parallel_sum__linear_kernel_hedgehog__mixer_channel_mlp__prompt_kernel_k_ph1_sp:

  s_sleep 2
  buffer_load_dword v50, v51, s[24:27], 0 offen sc1
  s_waitcnt vmcnt(0)
  v_cmp_ne_u32 vcc, 0x01010101, v50
  s_nop 0
  s_cmp_eq_u64 vcc, 0
  s_cbranch_scc0 L_parallel_sum__linear_kernel_hedgehog__mixer_channel_mlp__prompt_kernel_k_ph1_sp
L_parallel_sum__linear_kernel_hedgehog__mixer_channel_mlp__prompt_kernel_k_ph1_ok:
  s_add_u32 m0, s48, 0
  s_add_u32 s87, s46, 0
  buffer_load_dwordx4 v4, s[24:27], s87 offen sc1 lds
  s_add_u32 m0, s48, 1024
  s_add_u32 s87, s46, 1024
  buffer_load_dwordx4 v4, s[24:27], s87 offen sc1 lds
  s_add_u32 m0, s48, 2048
  s_add_u32 s87, s46, 2048
  buffer_load_dwordx4 v4, s[24:27], s87 offen sc1 lds
  s_add_u32 m0, s48, 3072
  s_add_u32 s87, s46, 3072
  buffer_load_dwordx4 v4, s[24:27], s87 offen sc1 lds
  s_add_u32 m0, s48, 36864
  s_add_u32 s87, s46, 4096
  buffer_load_dwordx4 v4, s[24:27], s87 offen sc1 lds
  s_add_u32 m0, s48, 37888
  s_add_u32 s87, s46, 5120
  buffer_load_dwordx4 v4, s[24:27], s87 offen sc1 lds
  s_add_u32 m0, s48, 38912
  s_add_u32 s87, s46, 6144
  buffer_load_dwordx4 v4, s[24:27], s87 offen sc1 lds
  s_add_u32 m0, s48, 39936
  s_add_u32 s87, s46, 7168
  buffer_load_dwordx4 v4, s[24:27], s87 offen sc1 lds
  s_waitcnt vmcnt(4)
  s_barrier
  s_lshl_b32 s41, s68, 9
  s_add_u32 s41, s41, 20981760
  v_min_u32 v51, 3, v1
  v_lshlrev_b32 v51, 7, v51
  v_add_u32 v51, s41, v51
  s_cmp_eq_u32 s39, 0
  s_cselect_b32 s41, 0, 0x7fff0000
  v_or_b32 v51, s41, v51
  buffer_load_dword v50, v51, s[24:27], 0 offen sc1
  s_add_u32 m0, s48, 73728
  s_add_u32 s87, s46, 8192
  buffer_load_dwordx4 v4, s[24:27], s87 offen sc1 lds
  s_add_u32 m0, s48, 74752
  s_add_u32 s87, s46, 9216
  buffer_load_dwordx4 v4, s[24:27], s87 offen sc1 lds
  s_add_u32 m0, s48, 75776
  s_add_u32 s87, s46, 10240
  buffer_load_dwordx4 v4, s[24:27], s87 offen sc1 lds
  s_add_u32 m0, s48, 76800
  s_add_u32 s87, s46, 11264
  buffer_load_dwordx4 v4, s[24:27], s87 offen sc1 lds
  s_add_u32 m0, s47, 73728
  s_add_u32 s87, s44, 40960
  buffer_load_dwordx4 v4, s[24:27], s87 offen sc1 lds
  s_add_u32 m0, s47, 74752
  s_add_u32 s87, s44, 41984
  buffer_load_dwordx4 v4, s[24:27], s87 offen sc1 lds
  s_add_u32 m0, s47, 75776
  s_add_u32 s87, s44, 43008
  buffer_load_dwordx4 v4, s[24:27], s87 offen sc1 lds
  s_add_u32 m0, s47, 76800
  s_add_u32 s87, s44, 44032
  buffer_load_dwordx4 v4, s[24:27], s87 offen sc1 lds
  s_add_u32 m0, s47, 77824
  s_add_u32 s87, s44, 45056
  buffer_load_dwordx4 v4, s[24:27], s87 offen sc1 lds
  s_waitcnt vmcnt(10)
  s_waitcnt vmcnt(9)
  s_cmp_eq_u32 s39, 0
  s_cbranch_scc0 L_parallel_sum__linear_kernel_hedgehog__mixer_channel_mlp__prompt_kernel_k_pq_ok
  v_cmp_ne_u32 vcc, 0x01010101, v50
  s_nop 0
  s_cmp_eq_u64 vcc, 0
  s_cbranch_scc1 L_parallel_sum__linear_kernel_hedgehog__mixer_channel_mlp__prompt_kernel_k_pq_ok
L_parallel_sum__linear_kernel_hedgehog__mixer_channel_mlp__prompt_kernel_k_pq_sp:

  s_sleep 1
  buffer_load_dword v50, v51, s[24:27], 0 offen sc1
  s_waitcnt vmcnt(0)
  v_cmp_ne_u32 vcc, 0x01010101, v50
  s_nop 0
  s_cmp_eq_u64 vcc, 0
  s_cbranch_scc0 L_parallel_sum__linear_kernel_hedgehog__mixer_channel_mlp__prompt_kernel_k_pq_sp
L_parallel_sum__linear_kernel_hedgehog__mixer_channel_mlp__prompt_kernel_k_pq_ok:
  s_waitcnt lgkmcnt(0)
  s_barrier
  s_add_u32 m0, s47, 110592
  s_add_u32 s87, s44, 61440
  buffer_load_dwordx4 v4, s[24:27], s87 offen sc1 lds
  s_add_u32 m0, s47, 111616
  s_add_u32 s87, s44, 62464
  buffer_load_dwordx4 v4, s[24:27], s87 offen sc1 lds
  s_add_u32 m0, s47, 112640
  s_add_u32 s87, s44, 63488
  buffer_load_dwordx4 v4, s[24:27], s87 offen sc1 lds
  s_add_u32 m0, s47, 113664
  s_add_u32 s87, s44, 64512
  buffer_load_dwordx4 v4, s[24:27], s87 offen sc1 lds
  s_add_u32 m0, s47, 114688
  s_add_u32 s87, s44, 65536
  buffer_load_dwordx4 v4, s[24:27], s87 offen sc1 lds
  s_add_u32 m0, s48, 110592
  s_add_u32 s87, s46, 12288
  buffer_load_dwordx4 v4, s[24:27], s87 offen sc1 lds
  s_add_u32 m0, s48, 111616
  s_add_u32 s87, s46, 13312
  buffer_load_dwordx4 v4, s[24:27], s87 offen sc1 lds
  s_add_u32 m0, s48, 112640
  s_add_u32 s87, s46, 14336
  buffer_load_dwordx4 v4, s[24:27], s87 offen sc1 lds
  s_add_u32 m0, s48, 113664
  s_add_u32 s87, s46, 15360
  buffer_load_dwordx4 v4, s[24:27], s87 offen sc1 lds
  s_add_u32 m0, s47, 0
  s_add_u32 s87, s44, 81920
  buffer_load_dwordx4 v4, s[24:27], s87 offen sc1 lds
  s_add_u32 m0, s47, 1024
  s_add_u32 s87, s44, 82944
  buffer_load_dwordx4 v4, s[24:27], s87 offen sc1 lds
  s_add_u32 m0, s47, 2048
  s_add_u32 s87, s44, 83968
  buffer_load_dwordx4 v4, s[24:27], s87 offen sc1 lds
  s_add_u32 m0, s47, 3072
  s_add_u32 s87, s44, 84992
  buffer_load_dwordx4 v4, s[24:27], s87 offen sc1 lds
  s_add_u32 m0, s47, 4096
  s_add_u32 s87, s44, 86016
  buffer_load_dwordx4 v4, s[24:27], s87 offen sc1 lds
  s_add_u32 m0, s48, 0
  s_add_u32 s87, s46, 16384
  buffer_load_dwordx4 v4, s[24:27], s87 offen sc1 lds
  s_add_u32 m0, s48, 1024
  s_add_u32 s87, s46, 17408
  buffer_load_dwordx4 v4, s[24:27], s87 offen sc1 lds
  s_add_u32 m0, s48, 2048
  s_add_u32 s87, s46, 18432
  buffer_load_dwordx4 v4, s[24:27], s87 offen sc1 lds
  s_add_u32 m0, s48, 3072
  s_add_u32 s87, s46, 19456
  buffer_load_dwordx4 v4, s[24:27], s87 offen sc1 lds
  s_waitcnt vmcnt(18)
  s_waitcnt lgkmcnt(0)
  s_barrier
  s_add_u32 m0, s47, 36864
  s_add_u32 s87, s44, 102400
  buffer_load_dwordx4 v4, s[24:27], s87 offen sc1 lds
  s_add_u32 m0, s47, 37888
  s_add_u32 s87, s44, 103424
  buffer_load_dwordx4 v4, s[24:27], s87 offen sc1 lds
  s_add_u32 m0, s47, 38912
  s_add_u32 s87, s44, 104448
  buffer_load_dwordx4 v4, s[24:27], s87 offen sc1 lds
  s_add_u32 m0, s47, 39936
  s_add_u32 s87, s44, 105472
  buffer_load_dwordx4 v4, s[24:27], s87 offen sc1 lds
  s_add_u32 m0, s47, 40960
  s_add_u32 s87, s44, 106496
  buffer_load_dwordx4 v4, s[24:27], s87 offen sc1 lds
  s_add_u32 m0, s48, 36864
  s_add_u32 s87, s46, 20480
  buffer_load_dwordx4 v4, s[24:27], s87 offen sc1 lds
  s_add_u32 m0, s48, 37888
  s_add_u32 s87, s46, 21504
  buffer_load_dwordx4 v4, s[24:27], s87 offen sc1 lds
  s_add_u32 m0, s48, 38912
  s_add_u32 s87, s46, 22528
  buffer_load_dwordx4 v4, s[24:27], s87 offen sc1 lds
  s_add_u32 m0, s48, 39936
  s_add_u32 s87, s46, 23552
  buffer_load_dwordx4 v4, s[24:27], s87 offen sc1 lds
  s_waitcnt vmcnt(18)
  s_waitcnt lgkmcnt(0)
  s_barrier
  s_add_u32 m0, s47, 73728
  s_add_u32 s87, s44, 122880
  buffer_load_dwordx4 v4, s[24:27], s87 offen sc1 lds
  s_lshr_b32 s41, s68, 1
  s_lshl_b32 s41, s41, 8
  s_add_u32 s41, s41, 20977664
  v_min_u32 v51, 1, v1
  v_lshlrev_b32 v51, 7, v51
  v_add_u32 v51, s41, v51
  s_cmp_eq_u32 s39, 0
  s_cselect_b32 s41, 0, 0x7fff0000
  v_or_b32 v51, s41, v51
  buffer_load_dword v50, v51, s[24:27], 0 offen sc1
  s_add_u32 m0, s47, 74752
  s_add_u32 s87, s44, 123904
  buffer_load_dwordx4 v4, s[24:27], s87 offen sc1 lds
  s_add_u32 m0, s47, 75776
  s_add_u32 s87, s44, 124928
  buffer_load_dwordx4 v4, s[24:27], s87 offen sc1 lds
  s_add_u32 m0, s47, 76800
  s_add_u32 s87, s44, 125952
  buffer_load_dwordx4 v4, s[24:27], s87 offen sc1 lds
  s_add_u32 m0, s47, 77824
  s_add_u32 s87, s44, 126976
  buffer_load_dwordx4 v4, s[24:27], s87 offen sc1 lds
  s_add_u32 m0, s48, 73728
  s_add_u32 s87, s46, 24576
  buffer_load_dwordx4 v4, s[24:27], s87 offen sc1 lds
  s_add_u32 m0, s48, 74752
  s_add_u32 s87, s46, 25600
  buffer_load_dwordx4 v4, s[24:27], s87 offen sc1 lds
  s_add_u32 m0, s48, 75776
  s_add_u32 s87, s46, 26624
  buffer_load_dwordx4 v4, s[24:27], s87 offen sc1 lds
  s_add_u32 m0, s48, 76800
  s_add_u32 s87, s46, 27648
  buffer_load_dwordx4 v4, s[24:27], s87 offen sc1 lds
  s_waitcnt vmcnt(19)
  s_waitcnt vmcnt(8)
  s_cmp_eq_u32 s39, 0
  s_cbranch_scc0 L_parallel_sum__linear_kernel_hedgehog__mixer_channel_mlp__prompt_kernel_k_ph2_ok
  v_cmp_ne_u32 vcc, 0x01010101, v50
  s_nop 0
  s_cmp_eq_u64 vcc, 0
  s_cbranch_scc1 L_parallel_sum__linear_kernel_hedgehog__mixer_channel_mlp__prompt_kernel_k_ph2_ok
L_parallel_sum__linear_kernel_hedgehog__mixer_channel_mlp__prompt_kernel_k_ph2_sp:

  s_sleep 1
  buffer_load_dword v50, v51, s[24:27], 0 offen sc1
  s_waitcnt vmcnt(0)
  v_cmp_ne_u32 vcc, 0x01010101, v50
  s_nop 0
  s_cmp_eq_u64 vcc, 0
  s_cbranch_scc0 L_parallel_sum__linear_kernel_hedgehog__mixer_channel_mlp__prompt_kernel_k_ph2_sp
L_parallel_sum__linear_kernel_hedgehog__mixer_channel_mlp__prompt_kernel_k_ph2_ok:
  s_waitcnt lgkmcnt(0)
  s_barrier
  s_add_u32 m0, s47, 110592
  s_add_u32 s87, s44, 143360
  buffer_load_dwordx4 v4, s[24:27], s87 offen sc1 lds
  s_lshl_b32 s41, s69, 9
  s_add_u32 s41, s41, 21014528
  v_min_u32 v57, 3, v1
  v_lshlrev_b32 v57, 7, v57
  v_add_u32 v57, s41, v57
  s_cmp_eq_u32 s39, 0
  s_cselect_b32 s41, 0, 0x7fff0000
  v_or_b32 v57, s41, v57
  buffer_load_dword v56, v57, s[24:27], 0 offen sc1
  s_add_u32 m0, s47, 111616
  s_add_u32 s87, s44, 144384
  buffer_load_dwordx4 v4, s[24:27], s87 offen sc1 lds
  s_add_u32 m0, s47, 112640
  s_add_u32 s87, s44, 145408
  buffer_load_dwordx4 v4, s[24:27], s87 offen sc1 lds
  s_add_u32 m0, s47, 113664
  s_add_u32 s87, s44, 146432
  buffer_load_dwordx4 v4, s[24:27], s87 offen sc1 lds
  s_add_u32 m0, s47, 114688
  s_add_u32 s87, s44, 147456
  buffer_load_dwordx4 v4, s[24:27], s87 offen sc1 lds
  s_add_u32 m0, s48, 110592
  s_add_u32 s87, s46, 28672
  buffer_load_dwordx4 v4, s[24:27], s87 offen sc1 lds
  s_add_u32 m0, s48, 111616
  s_add_u32 s87, s46, 29696
  buffer_load_dwordx4 v4, s[24:27], s87 offen sc1 lds
  s_add_u32 m0, s48, 112640
  s_add_u32 s87, s46, 30720
  buffer_load_dwordx4 v4, s[24:27], s87 offen sc1 lds
  s_add_u32 m0, s48, 113664
  s_add_u32 s87, s46, 31744
  buffer_load_dwordx4 v4, s[24:27], s87 offen sc1 lds
  s_waitcnt vmcnt(8)
  s_cmp_eq_u32 s39, 0
  s_cbranch_scc0 L_parallel_sum__linear_kernel_hedgehog__mixer_channel_mlp__prompt_kernel_k_pkv_ok
  v_cmp_ne_u32 vcc, 0x01010101, v56
  s_nop 0
  s_cmp_eq_u64 vcc, 0
  s_cbranch_scc1 L_parallel_sum__linear_kernel_hedgehog__mixer_channel_mlp__prompt_kernel_k_pkv_ok
L_parallel_sum__linear_kernel_hedgehog__mixer_channel_mlp__prompt_kernel_k_pkv_sp:

  s_sleep 1
  buffer_load_dword v56, v57, s[24:27], 0 offen sc1
  s_waitcnt vmcnt(0)
  v_cmp_ne_u32 vcc, 0x01010101, v56
  s_nop 0
  s_cmp_eq_u64 vcc, 0
  s_cbranch_scc0 L_parallel_sum__linear_kernel_hedgehog__mixer_channel_mlp__prompt_kernel_k_pkv_sp
L_parallel_sum__linear_kernel_hedgehog__mixer_channel_mlp__prompt_kernel_k_pkv_ok:
  s_waitcnt lgkmcnt(0)
  s_barrier
  s_lshl_b32 s58, s39, 1
  s_add_u32 s58, s58, 0
  s_lshl_b32 s59, s58, 10
  v_add_u32 v60, s59, v4
  v_mov_b32 v61, 0x7fff0000
  v_cmp_gt_u32 vcc, 7680, v60
  s_nop 1
  v_cndmask_b32 v60, v61, v60, vcc
  s_add_u32 m0, s59, 151552
  s_mul_i32 s58, s69, 7680
  s_add_u32 s58, s58, 262144
  buffer_load_dwordx4 v60, s[24:27], s58 offen sc1 lds
  s_lshl_b32 s58, s39, 1
  s_add_u32 s58, s58, 1
  s_lshl_b32 s59, s58, 10
  v_add_u32 v60, s59, v4
  v_mov_b32 v61, 0x7fff0000
  v_cmp_gt_u32 vcc, 7680, v60
  s_nop 1
  v_cndmask_b32 v60, v61, v60, vcc
  s_add_u32 m0, s59, 151552
  s_mul_i32 s58, s69, 7680
  s_add_u32 s58, s58, 262144
  buffer_load_dwordx4 v60, s[24:27], s58 offen sc1 lds
  s_add_u32 m0, s47, 0
  s_add_u32 s87, s44, 163840
  buffer_load_dwordx4 v4, s[24:27], s87 offen sc1 lds
  s_add_u32 m0, s47, 1024
  s_add_u32 s87, s44, 164864
  buffer_load_dwordx4 v4, s[24:27], s87 offen sc1 lds
  s_add_u32 m0, s47, 2048
  s_add_u32 s87, s44, 165888
  buffer_load_dwordx4 v4, s[24:27], s87 offen sc1 lds
  s_add_u32 m0, s47, 3072
  s_add_u32 s87, s44, 166912
  buffer_load_dwordx4 v4, s[24:27], s87 offen sc1 lds
  s_add_u32 m0, s47, 4096
  s_add_u32 s87, s44, 167936
  buffer_load_dwordx4 v4, s[24:27], s87 offen sc1 lds
  s_add_u32 m0, s48, 0
  s_add_u32 s87, s46, 32768
  buffer_load_dwordx4 v4, s[24:27], s87 offen sc1 lds
  s_add_u32 m0, s48, 1024
  s_add_u32 s87, s46, 33792
  buffer_load_dwordx4 v4, s[24:27], s87 offen sc1 lds
  s_add_u32 m0, s48, 2048
  s_add_u32 s87, s46, 34816
  buffer_load_dwordx4 v4, s[24:27], s87 offen sc1 lds
  s_add_u32 m0, s48, 3072
  s_add_u32 s87, s46, 35840
  buffer_load_dwordx4 v4, s[24:27], s87 offen sc1 lds
  s_waitcnt vmcnt(9)
  s_waitcnt lgkmcnt(0)
  s_barrier
  s_add_u32 m0, s47, 36864
  s_add_u32 s87, s44, 184320
  buffer_load_dwordx4 v4, s[24:27], s87 offen sc1 lds
  s_add_u32 m0, s47, 37888
  s_add_u32 s87, s44, 185344
  buffer_load_dwordx4 v4, s[24:27], s87 offen sc1 lds
  s_add_u32 m0, s47, 38912
  s_add_u32 s87, s44, 186368
  buffer_load_dwordx4 v4, s[24:27], s87 offen sc1 lds
  s_add_u32 m0, s47, 39936
  s_add_u32 s87, s44, 187392
  buffer_load_dwordx4 v4, s[24:27], s87 offen sc1 lds
  s_add_u32 m0, s47, 40960
  s_add_u32 s87, s44, 188416
  buffer_load_dwordx4 v4, s[24:27], s87 offen sc1 lds
  s_add_u32 m0, s48, 36864
  s_add_u32 s87, s46, 36864
  buffer_load_dwordx4 v4, s[24:27], s87 offen sc1 lds
  s_add_u32 m0, s48, 37888
  s_add_u32 s87, s46, 37888
  buffer_load_dwordx4 v4, s[24:27], s87 offen sc1 lds
  s_add_u32 m0, s48, 38912
  s_add_u32 s87, s46, 38912
  buffer_load_dwordx4 v4, s[24:27], s87 offen sc1 lds
  s_add_u32 m0, s48, 39936
  s_add_u32 s87, s46, 39936
  buffer_load_dwordx4 v4, s[24:27], s87 offen sc1 lds
  s_waitcnt lgkmcnt(0)
  s_barrier
  s_add_u32 m0, s47, 73728
  s_add_u32 s87, s44, 204800
  buffer_load_dwordx4 v4, s[24:27], s87 offen sc1 lds
  s_add_u32 m0, s47, 74752
  s_add_u32 s87, s44, 205824
  buffer_load_dwordx4 v4, s[24:27], s87 offen sc1 lds
  s_add_u32 m0, s47, 75776
  s_add_u32 s87, s44, 206848
  buffer_load_dwordx4 v4, s[24:27], s87 offen sc1 lds
  s_add_u32 m0, s47, 76800
  s_add_u32 s87, s44, 207872
  buffer_load_dwordx4 v4, s[24:27], s87 offen sc1 lds
  s_add_u32 m0, s47, 77824
  s_add_u32 s87, s44, 208896
  buffer_load_dwordx4 v4, s[24:27], s87 offen sc1 lds
  s_add_u32 m0, s48, 73728
  s_add_u32 s87, s46, 40960
  buffer_load_dwordx4 v4, s[24:27], s87 offen sc1 lds
  s_add_u32 m0, s48, 74752
  s_add_u32 s87, s46, 41984
  buffer_load_dwordx4 v4, s[24:27], s87 offen sc1 lds
  s_add_u32 m0, s48, 75776
  s_add_u32 s87, s46, 43008
  buffer_load_dwordx4 v4, s[24:27], s87 offen sc1 lds
  s_add_u32 m0, s48, 76800
  s_add_u32 s87, s46, 44032
  buffer_load_dwordx4 v4, s[24:27], s87 offen sc1 lds
  s_waitcnt vmcnt(18)
  s_waitcnt lgkmcnt(0)
  s_barrier
  s_add_u32 m0, s47, 110592
  s_add_u32 s87, s44, 225280
  buffer_load_dwordx4 v4, s[24:27], s87 offen sc1 lds
  s_add_u32 m0, s47, 111616
  s_add_u32 s87, s44, 226304
  buffer_load_dwordx4 v4, s[24:27], s87 offen sc1 lds
  s_add_u32 m0, s47, 112640
  s_add_u32 s87, s44, 227328
  buffer_load_dwordx4 v4, s[24:27], s87 offen sc1 lds
  s_add_u32 m0, s47, 113664
  s_add_u32 s87, s44, 228352
  buffer_load_dwordx4 v4, s[24:27], s87 offen sc1 lds
  s_add_u32 m0, s47, 114688
  s_add_u32 s87, s44, 229376
  buffer_load_dwordx4 v4, s[24:27], s87 offen sc1 lds
  s_add_u32 m0, s48, 110592
  s_add_u32 s87, s46, 45056
  buffer_load_dwordx4 v4, s[24:27], s87 offen sc1 lds
  s_add_u32 m0, s48, 111616
  s_add_u32 s87, s46, 46080
  buffer_load_dwordx4 v4, s[24:27], s87 offen sc1 lds
  s_add_u32 m0, s48, 112640
  s_add_u32 s87, s46, 47104
  buffer_load_dwordx4 v4, s[24:27], s87 offen sc1 lds
  s_add_u32 m0, s48, 113664
  s_add_u32 s87, s46, 48128
  buffer_load_dwordx4 v4, s[24:27], s87 offen sc1 lds
  s_waitcnt vmcnt(18)
  s_waitcnt lgkmcnt(0)
  s_barrier
  s_add_u32 m0, s47, 0
  s_add_u32 s87, s44, 245760
  buffer_load_dwordx4 v4, s[24:27], s87 offen sc1 lds
  s_add_u32 m0, s47, 1024
  s_add_u32 s87, s44, 246784
  buffer_load_dwordx4 v4, s[24:27], s87 offen sc1 lds
  s_add_u32 m0, s47, 2048
  s_add_u32 s87, s44, 247808
  buffer_load_dwordx4 v4, s[24:27], s87 offen sc1 lds
  s_add_u32 m0, s47, 3072
  s_add_u32 s87, s44, 248832
  buffer_load_dwordx4 v4, s[24:27], s87 offen sc1 lds
  s_add_u32 m0, s47, 4096
  s_add_u32 s87, s44, 249856
  buffer_load_dwordx4 v4, s[24:27], s87 offen sc1 lds
  s_add_u32 m0, s48, 0
  s_add_u32 s87, s46, 49152
  buffer_load_dwordx4 v4, s[24:27], s87 offen sc1 lds
  s_add_u32 m0, s48, 1024
  s_add_u32 s87, s46, 50176
  buffer_load_dwordx4 v4, s[24:27], s87 offen sc1 lds
  s_add_u32 m0, s48, 2048
  s_add_u32 s87, s46, 51200
  buffer_load_dwordx4 v4, s[24:27], s87 offen sc1 lds
  s_add_u32 m0, s48, 3072
  s_add_u32 s87, s46, 52224
  buffer_load_dwordx4 v4, s[24:27], s87 offen sc1 lds
  s_waitcnt vmcnt(18)
  s_waitcnt lgkmcnt(0)
  s_barrier
  s_add_u32 m0, s47, 36864
  s_add_u32 s87, s44, 266240
  buffer_load_dwordx4 v4, s[24:27], s87 offen sc1 lds
  s_add_u32 m0, s47, 37888
  s_add_u32 s87, s44, 267264
  buffer_load_dwordx4 v4, s[24:27], s87 offen sc1 lds
  s_add_u32 m0, s47, 38912
  s_add_u32 s87, s44, 268288
  buffer_load_dwordx4 v4, s[24:27], s87 offen sc1 lds
  s_add_u32 m0, s47, 39936
  s_add_u32 s87, s44, 269312
  buffer_load_dwordx4 v4, s[24:27], s87 offen sc1 lds
  s_add_u32 m0, s47, 40960
  s_add_u32 s87, s44, 270336
  buffer_load_dwordx4 v4, s[24:27], s87 offen sc1 lds
  s_waitcnt vmcnt(14)
  s_waitcnt lgkmcnt(0)
  s_barrier
  s_add_u32 m0, s47, 73728
  s_add_u32 s87, s44, 286720
  buffer_load_dwordx4 v4, s[24:27], s87 offen sc1 lds
  s_add_u32 m0, s47, 74752
  s_add_u32 s87, s44, 287744
  buffer_load_dwordx4 v4, s[24:27], s87 offen sc1 lds
  s_add_u32 m0, s47, 75776
  s_add_u32 s87, s44, 288768
  buffer_load_dwordx4 v4, s[24:27], s87 offen sc1 lds
  s_add_u32 m0, s47, 76800
  s_add_u32 s87, s44, 289792
  buffer_load_dwordx4 v4, s[24:27], s87 offen sc1 lds
  s_add_u32 m0, s47, 77824
  s_add_u32 s87, s44, 290816
  buffer_load_dwordx4 v4, s[24:27], s87 offen sc1 lds
  s_waitcnt vmcnt(10)
  s_waitcnt lgkmcnt(0)
  s_barrier
  s_add_u32 m0, s47, 110592
  s_add_u32 s87, s44, 307200
  buffer_load_dwordx4 v4, s[24:27], s87 offen sc1 lds
  s_add_u32 m0, s47, 111616
  s_add_u32 s87, s44, 308224
  buffer_load_dwordx4 v4, s[24:27], s87 offen sc1 lds
  s_add_u32 m0, s47, 112640
  s_add_u32 s87, s44, 309248
  buffer_load_dwordx4 v4, s[24:27], s87 offen sc1 lds
  s_add_u32 m0, s47, 113664
  s_add_u32 s87, s44, 310272
  buffer_load_dwordx4 v4, s[24:27], s87 offen sc1 lds
  s_add_u32 m0, s47, 114688
  s_add_u32 s87, s44, 311296
  buffer_load_dwordx4 v4, s[24:27], s87 offen sc1 lds
  s_lshl_b32 s41, s86, 8
  s_add_u32 s41, s41, 21018624
  v_min_u32 v51, 1, v1
  v_lshlrev_b32 v51, 7, v51
  v_add_u32 v51, s41, v51
  buffer_load_dword v50, v51, s[24:27], 0 offen sc1
  s_waitcnt vmcnt(0)
  v_cmp_ne_u32 vcc, 0x01010101, v50
  s_nop 0
  s_cmp_eq_u64 vcc, 0
  s_cbranch_scc1 L_parallel_sum__linear_kernel_hedgehog__mixer_channel_mlp__prompt_kernel_k_po_ok
L_parallel_sum__linear_kernel_hedgehog__mixer_channel_mlp__prompt_kernel_k_po_sp:

  s_sleep 1
  buffer_load_dword v50, v51, s[24:27], 0 offen sc1
  s_waitcnt vmcnt(0)
  v_cmp_ne_u32 vcc, 0x01010101, v50
  s_nop 0
  s_cmp_eq_u64 vcc, 0
  s_cbranch_scc0 L_parallel_sum__linear_kernel_hedgehog__mixer_channel_mlp__prompt_kernel_k_po_sp
L_parallel_sum__linear_kernel_hedgehog__mixer_channel_mlp__prompt_kernel_k_po_ok:
  s_add_u32 m0, s48, 36864
  s_add_u32 s87, s46, 53248
  buffer_load_dwordx4 v4, s[24:27], s87 offen sc1 lds
  s_add_u32 m0, s48, 37888
  s_add_u32 s87, s46, 54272
  buffer_load_dwordx4 v4, s[24:27], s87 offen sc1 lds
  s_add_u32 m0, s48, 38912
  s_add_u32 s87, s46, 55296
  buffer_load_dwordx4 v4, s[24:27], s87 offen sc1 lds
  s_add_u32 m0, s48, 39936
  s_add_u32 s87, s46, 56320
  buffer_load_dwordx4 v4, s[24:27], s87 offen sc1 lds
  s_add_u32 m0, s48, 73728
  s_add_u32 s87, s46, 57344
  buffer_load_dwordx4 v4, s[24:27], s87 offen sc1 lds
  s_add_u32 m0, s48, 74752
  s_add_u32 s87, s46, 58368
  buffer_load_dwordx4 v4, s[24:27], s87 offen sc1 lds
  s_add_u32 m0, s48, 75776
  s_add_u32 s87, s46, 59392
  buffer_load_dwordx4 v4, s[24:27], s87 offen sc1 lds
  s_add_u32 m0, s48, 76800
  s_add_u32 s87, s46, 60416
  buffer_load_dwordx4 v4, s[24:27], s87 offen sc1 lds
  s_add_u32 m0, s48, 110592
  s_add_u32 s87, s46, 61440
  buffer_load_dwordx4 v4, s[24:27], s87 offen sc1 lds
  s_add_u32 m0, s48, 111616
  s_add_u32 s87, s46, 62464
  buffer_load_dwordx4 v4, s[24:27], s87 offen sc1 lds
  s_add_u32 m0, s48, 112640
  s_add_u32 s87, s46, 63488
  buffer_load_dwordx4 v4, s[24:27], s87 offen sc1 lds
  s_add_u32 m0, s48, 113664
  s_add_u32 s87, s46, 64512
  buffer_load_dwordx4 v4, s[24:27], s87 offen sc1 lds
  s_waitcnt vmcnt(8)
  s_waitcnt lgkmcnt(0)
  s_barrier
  s_add_u32 m0, s47, 0
  s_add_u32 s87, s44, 327680
  buffer_load_dwordx4 v4, s[24:27], s87 offen sc1 lds
  s_add_u32 m0, s47, 1024
  s_add_u32 s87, s44, 328704
  buffer_load_dwordx4 v4, s[24:27], s87 offen sc1 lds
  s_add_u32 m0, s47, 2048
  s_add_u32 s87, s44, 329728
  buffer_load_dwordx4 v4, s[24:27], s87 offen sc1 lds
  s_add_u32 m0, s47, 3072
  s_add_u32 s87, s44, 330752
  buffer_load_dwordx4 v4, s[24:27], s87 offen sc1 lds
  s_add_u32 m0, s47, 4096
  s_add_u32 s87, s44, 331776
  buffer_load_dwordx4 v4, s[24:27], s87 offen sc1 lds
  s_add_u32 m0, s48, 0
  s_add_u32 s87, s46, 65536
  buffer_load_dwordx4 v4, s[24:27], s87 offen sc1 lds
  s_add_u32 m0, s48, 1024
  s_add_u32 s87, s46, 66560
  buffer_load_dwordx4 v4, s[24:27], s87 offen sc1 lds
  s_add_u32 m0, s48, 2048
  s_add_u32 s87, s46, 67584
  buffer_load_dwordx4 v4, s[24:27], s87 offen sc1 lds
  s_add_u32 m0, s48, 3072
  s_add_u32 s87, s46, 68608
  buffer_load_dwordx4 v4, s[24:27], s87 offen sc1 lds
  s_waitcnt vmcnt(13)
  s_waitcnt lgkmcnt(0)
  s_barrier
  s_add_u32 m0, s47, 36864
  s_add_u32 s87, s44, 348160
  buffer_load_dwordx4 v4, s[24:27], s87 offen sc1 lds
  s_add_u32 m0, s47, 37888
  s_add_u32 s87, s44, 349184
  buffer_load_dwordx4 v4, s[24:27], s87 offen sc1 lds
  s_add_u32 m0, s47, 38912
  s_add_u32 s87, s44, 350208
  buffer_load_dwordx4 v4, s[24:27], s87 offen sc1 lds
  s_add_u32 m0, s47, 39936
  s_add_u32 s87, s44, 351232
  buffer_load_dwordx4 v4, s[24:27], s87 offen sc1 lds
  s_add_u32 m0, s47, 40960
  s_add_u32 s87, s44, 352256
  buffer_load_dwordx4 v4, s[24:27], s87 offen sc1 lds
  s_add_u32 m0, s48, 36864
  s_add_u32 s87, s46, 69632
  buffer_load_dwordx4 v4, s[24:27], s87 offen sc1 lds
  s_add_u32 m0, s48, 37888
  s_add_u32 s87, s46, 70656
  buffer_load_dwordx4 v4, s[24:27], s87 offen sc1 lds
  s_add_u32 m0, s48, 38912
  s_add_u32 s87, s46, 71680
  buffer_load_dwordx4 v4, s[24:27], s87 offen sc1 lds
  s_add_u32 m0, s48, 39936
  s_add_u32 s87, s46, 72704
  buffer_load_dwordx4 v4, s[24:27], s87 offen sc1 lds
  s_waitcnt vmcnt(18)
  s_waitcnt lgkmcnt(0)
  s_barrier
  s_add_u32 s87, s47, 73728
  s_cmp_lt_u32 s39, 2
  s_cselect_b32 m0, s87, 159232
  s_cselect_b32 s26, 21073920, 0
  s_add_u32 s87, s44, 368640
  buffer_load_dwordx4 v4, s[24:27], s87 offen sc1 lds
  s_mov_b32 s26, 21073920
  s_add_u32 s58, s39, 0
  s_lshl_b32 s59, s58, 6
  v_add_u32 v60, s59, v1
  v_mul_u32_u24 v61, 6554, v60
  v_lshrrev_b32 v61, 16, v61
  v_mul_u32_u24 v62, 10, v61
  v_sub_u32 v62, v60, v62
  s_lshl_b32 s59, s68, 6
  v_add_u32 v61, s59, v61
  v_mul_u32_u24 v61, 1280, v61
  v_lshl_add_u32 v61, v62, 4, v61
  s_mul_i32 s59, s69, 160
  v_add_u32 v61, s59, v61
  s_lshl_b32 s59, s58, 10
  s_add_u32 s59, s59, 83968
  s_cmp_lt_u32 s58, 10
  s_cselect_b32 s59, s59, 159232
  s_cselect_b32 s58, 0, 0x7fff0000
  v_or_b32 v61, s58, v61
  s_mov_b32 m0, s59
  s_nop 0
  buffer_load_dwordx4 v61, s[16:19], 0 offen lds
  s_add_u32 s87, s47, 74752
  s_cmp_lt_u32 s39, 2
  s_cselect_b32 m0, s87, 159232
  s_cselect_b32 s26, 21073920, 0
  s_add_u32 s87, s44, 369664
  buffer_load_dwordx4 v4, s[24:27], s87 offen sc1 lds
  s_mov_b32 s26, 21073920
  s_add_u32 s58, s39, 4
  s_lshl_b32 s59, s58, 6
  v_add_u32 v60, s59, v1
  v_mul_u32_u24 v61, 6554, v60
  v_lshrrev_b32 v61, 16, v61
  v_mul_u32_u24 v62, 10, v61
  v_sub_u32 v62, v60, v62
  s_lshl_b32 s59, s68, 6
  v_add_u32 v61, s59, v61
  v_mul_u32_u24 v61, 1280, v61
  v_lshl_add_u32 v61, v62, 4, v61
  s_mul_i32 s59, s69, 160
  v_add_u32 v61, s59, v61
  s_lshl_b32 s59, s58, 10
  s_add_u32 s59, s59, 83968
  s_cmp_lt_u32 s58, 10
  s_cselect_b32 s59, s59, 159232
  s_cselect_b32 s58, 0, 0x7fff0000
  v_or_b32 v61, s58, v61
  s_mov_b32 m0, s59
  s_nop 0
  buffer_load_dwordx4 v61, s[16:19], 0 offen lds
  s_add_u32 s87, s47, 75776
  s_cmp_lt_u32 s39, 2
  s_cselect_b32 m0, s87, 159232
  s_cselect_b32 s26, 21073920, 0
  s_add_u32 s87, s44, 370688
  buffer_load_dwordx4 v4, s[24:27], s87 offen sc1 lds
  s_mov_b32 s26, 21073920
  s_add_u32 s58, s39, 8
  s_lshl_b32 s59, s58, 6
  v_add_u32 v60, s59, v1
  v_mul_u32_u24 v61, 6554, v60
  v_lshrrev_b32 v61, 16, v61
  v_mul_u32_u24 v62, 10, v61
  v_sub_u32 v62, v60, v62
  s_lshl_b32 s59, s68, 6
  v_add_u32 v61, s59, v61
  v_mul_u32_u24 v61, 1280, v61
  v_lshl_add_u32 v61, v62, 4, v61
  s_mul_i32 s59, s69, 160
  v_add_u32 v61, s59, v61
  s_lshl_b32 s59, s58, 10
  s_add_u32 s59, s59, 83968
  s_cmp_lt_u32 s58, 10
  s_cselect_b32 s59, s59, 159232
  s_cselect_b32 s58, 0, 0x7fff0000
  v_or_b32 v61, s58, v61
  s_mov_b32 m0, s59
  s_nop 0
  buffer_load_dwordx4 v61, s[16:19], 0 offen lds
  s_add_u32 s87, s47, 76800
  s_cmp_lt_u32 s39, 2
  s_cselect_b32 m0, s87, 159232
  s_cselect_b32 s26, 21073920, 0
  s_add_u32 s87, s44, 371712
  buffer_load_dwordx4 v4, s[24:27], s87 offen sc1 lds
  s_mov_b32 s26, 21073920
  s_mul_i32 s58, s69, 160
  s_add_u32 s32, s80, s58
  s_addc_u32 s33, s81, 0
  s_and_b32 s33, s33, 0xffff
  s_mov_b32 s34, 160
  s_mov_b32 s35, 0x20000
  s_mov_b32 m0, 161280
  s_nop 0
  buffer_load_dwordx4 v4, s[32:35], 0 offen lds
  s_add_u32 s87, s47, 77824
  s_cmp_lt_u32 s39, 2
  s_cselect_b32 m0, s87, 159232
  s_cselect_b32 s26, 21073920, 0
  s_add_u32 s87, s44, 372736
  buffer_load_dwordx4 v4, s[24:27], s87 offen sc1 lds
  s_mov_b32 s26, 21073920
  s_add_u32 m0, s48, 73728
  s_add_u32 s87, s46, 73728
  buffer_load_dwordx4 v4, s[24:27], s87 offen sc1 lds
  s_add_u32 m0, s48, 74752
  s_add_u32 s87, s46, 74752
  buffer_load_dwordx4 v4, s[24:27], s87 offen sc1 lds
  s_waitcnt vmcnt(20)
  s_waitcnt lgkmcnt(0)
  s_barrier
  s_waitcnt vmcnt(11)
  s_waitcnt lgkmcnt(0)
  s_barrier
  s_waitcnt vmcnt(0)
  s_waitcnt lgkmcnt(0)
  s_barrier
  s_endpgm
L_parallel_sum__linear_kernel_hedgehog__mixer_channel_mlp__prompt_kernel_end:
  s_endpgm
L_parallel_sum__linear_kernel_hedgehog__mixer_channel_mlp__prompt_kernel_codeend:
.section .rodata,"a"
.p2align 6
.amdhsa_kernel parallel_sum__linear_kernel_hedgehog__mixer_channel_mlp__prompt_kernel
  .amdhsa_next_free_vgpr 256
  .amdhsa_next_free_sgpr 102
  .amdhsa_accum_offset 256
  .amdhsa_group_segment_fixed_size 0
  .amdhsa_kernarg_size 96
  .amdhsa_user_sgpr_count 2
  .amdhsa_user_sgpr_kernarg_segment_ptr 1
  .amdhsa_system_sgpr_workgroup_id_x 1
.end_amdhsa_kernel
```
